```python
import torch

def _softmax(x, axis=-1):
    return torch.softmax(x, dim=axis)
def _gelu(x):
    return torch.nn.functional.gelu(x, approximate="tanh")
def _silu(x):
    return torch.nn.functional.silu(x)
def _sigmoid(x):
    return torch.sigmoid(x)
def _layernorm(x, axis=-1, eps=1e-5):
    m = x.mean(dim=axis, keepdim=True)
    v = x.var(dim=axis, keepdim=True, unbiased=False)
    return (x - m) / torch.sqrt(v + eps)
def _scatter_add(tgt, idx, src, axis=0):
    return tgt.clone().index_add_(axis, idx, src)
def _segment_sum(src, seg, n):
    out = torch.zeros((n,) + src.shape[1:], dtype=src.dtype)
    return out.index_add_(0, seg, src)
def _pad(x, pw):
    flat = tuple(v for pair in reversed(pw) for v in pair)
    return torch.nn.functional.pad(x, flat)

kernel_name = 'standalone__modern_conv_block_convnext__vision'

def setup_inputs():

    _w = (lambda a: (lambda t: t.to(torch.bfloat16) if t.is_floating_point() else t)(torch.as_tensor(a)))
    H = W = 224
    C = 96
    K = 7
    return {
        "x": _w((lambda *s: torch.randn(*s, dtype=torch.bfloat16) * 0.05)(1, H, W, C)),
        "dw": _w((lambda *s: torch.randn(*s, dtype=torch.bfloat16) * 0.05)(K, K, C)),
        "w1": _w((lambda *s: torch.randn(*s, dtype=torch.bfloat16) * 0.05)(C, 4 * C)),
        "b1": _w((lambda *s: torch.randn(*s, dtype=torch.bfloat16) * 0.2)(4 * C)),
        "w2": _w((lambda *s: torch.randn(*s, dtype=torch.bfloat16) * 0.05)(4 * C, C)),
        "b2": _w((lambda *s: torch.randn(*s, dtype=torch.bfloat16) * 0.4)(C)),
        "gamma": _w((lambda *s: torch.randn(*s, dtype=torch.bfloat16) * 0.05)(C)),
    }

def reference(x, dw, w1, b1, w2, b2, gamma):
    B, H, W, C = x.shape
    K = dw.shape[0]
    pad = K // 2
    xp = _pad(x, ((0,0),(pad,pad),(pad,pad),(0,0)))
    out = torch.zeros_like(x)
    for i in range(K):
        for j in range(K):
            out = out + xp[:, i:i+H, j:j+W, :] * dw[i, j][None, None, None, :]
    h = _layernorm(out, axis=-1)
    h = torch.einsum('bhwc,ce->bhwe', h, w1) + b1
    h = _gelu(h)
    h = torch.einsum('bhwe,ec->bhwc', h, w2) + b2
    return x + gamma[None, None, None, :] * h
```

```asm
; @launch grid=(256,1,1) block=(512,1,1) lds=161472
.amdgcn_target "amdgcn-amd-amdhsa--gfx950"
.text
.globl standalone__modern_conv_block_convnext__vision_kernel
.p2align 8
.type standalone__modern_conv_block_convnext__vision_kernel,@function
standalone__modern_conv_block_convnext__vision_kernel:
    s_cmp_ge_u32 s2, 256
    s_cbranch_scc1 L_end
    s_load_dwordx16 s[4:19], s[0:1], 0
    v_lshrrev_b32 v1, 6, v0
    v_and_b32 v2, 63, v0
    v_readfirstlane_b32 s44, v1
    s_getpc_b64 s[96:97]
L_pc:
    s_mov_b32 s98, L_tab_end-L_pc
    s_mov_b32 s99, 0x20000
    s_bfe_u32 s47, s2, 0x30003
    s_mul_i32 s47, s47, ((L_code_end-L_pc)/1024+1)*128
    v_lshl_add_u32 v246, v0, 4, s47
    buffer_load_dwordx4 v[228:231], v246, s[96:99], 0 offen
    v_mov_b64 v[56:57], 0
    v_mov_b64 v[58:59], 0
    v_lshlrev_b32 v6, 4, v0
    v_add_u32 v204, 145088, v6
    ds_write_b128 v204, v[56:59]
    ds_write_b128 v204, v[56:59] offset:8192
    s_and_b32 s45, s2, 3
    s_lshl_b32 s45, s45, 2
    s_bfe_u32 s47, s2, 0x20003
    s_add_u32 s45, s45, s47
    s_bfe_u32 s46, s2, 0x10002
    s_lshl_b32 s46, s46, 3
    s_lshr_b32 s47, s2, 5
    s_add_u32 s46, s46, s47
    s_mul_i32 s45, s45, 14
    s_mul_i32 s46, s46, 14
    v_lshrrev_b32 v200, 2, v2
    v_min_u32 v200, 14, v200
    v_mul_u32_u24 v201, 52, v200
    v_lshrrev_b32 v201, 8, v201
    v_mul_u32_u24 v202, 5, v201
    v_sub_u32 v200, v200, v202
    s_and_b32 s56, s44, 3
    s_mul_i32 s47, s56, 5
    v_add_u32 v200, s47, v200
    v_and_b32 v202, 3, v2
    v_lshl_add_u32 v201, v201, 2, v202
    s_sub_u32 s47, s45, 3
    v_add_u32 v202, s47, v200
    v_cmp_gt_u32 vcc, 224, v202
    v_mov_b32 v3, 1073741824
    v_mul_u32_u24 v203, 192, v202
    v_lshl_add_u32 v203, v201, 4, v203
    v_cndmask_b32 v203, v3, v203, vcc
    s_sub_u32 s47, s46, 3
    s_mul_i32 s47, s47, 43008
    v_add_u32 v248, s47, v203
    s_waitcnt lgkmcnt(0)
    s_mov_b32 s20, s4
    s_mov_b32 s21, s5
    s_mov_b32 s22, 9633792
    s_mov_b32 s23, 0x20000
    s_barrier
    s_cmp_lt_u32 s44, 4
    s_cbranch_scc0 L_bdw
    v_add_u32 v208, 258048, v248
    buffer_load_dwordx4 v[104:107], v208, s[20:23], 0 offen
    v_add_u32 v209, 301056, v248
    buffer_load_dwordx4 v[108:111], v209, s[20:23], 0 offen
    v_add_u32 v208, 602112, v248
    buffer_load_dwordx4 v[112:115], v208, s[20:23], 0 offen
    v_add_u32 v209, 645120, v248
    buffer_load_dwordx4 v[116:119], v209, s[20:23], 0 offen
    v_add_u32 v208, 172032, v248
    buffer_load_dwordx4 v[120:123], v208, s[20:23], 0 offen
    v_add_u32 v209, 215040, v248
    buffer_load_dwordx4 v[124:127], v209, s[20:23], 0 offen
    v_add_u32 v208, 516096, v248
    buffer_load_dwordx4 v[128:131], v208, s[20:23], 0 offen
    v_add_u32 v209, 559104, v248
    buffer_load_dwordx4 v[132:135], v209, s[20:23], 0 offen
    v_add_u32 v208, 344064, v248
    buffer_load_dwordx4 v[136:139], v208, s[20:23], 0 offen
    v_add_u32 v209, 387072, v248
    buffer_load_dwordx4 v[140:143], v209, s[20:23], 0 offen
    s_branch L_adone
L_bdw:
    s_setprio 1
    v_and_b32 v6, 0xfff, v6
    s_mov_b32 s24, s6
    s_mov_b32 s25, s7
    s_mov_b32 s26, 9408
    s_mov_b32 s27, 0x20000
    buffer_load_dwordx4 v[152:155], v6, s[24:27], 0 offen
    v_add_u32 v6, 4096, v6
    buffer_load_dwordx4 v[156:159], v6, s[24:27], 0 offen
    v_add_u32 v6, 4096, v6
    buffer_load_dwordx4 v[160:163], v6, s[24:27], 0 offen
    s_setprio 0
L_adone:
    s_lshl_b32 s47, s44, 12
    s_add_u32 s47, s47, L_tab-L_pc
    v_lshl_add_u32 v1, v2, 4, s47
    s_lshl_b32 s47, s44, 2
    s_add_u32 s47, s47, 161440
    v_mov_b32 v244, s47
    v_mul_u32_u24 v201, 6944, v201
    v_lshl_add_u32 v201, v200, 3, v201
    v_add_u32 v252, 61760, v201
    v_mov_b32 v7, 0xffff0000
    v_mov_b32 v249, 0xffff
    v_and_b32 v200, 3, v2
    v_mul_u32_u24 v251, 0x5555, v200
    v_and_b32 v200, 7, v2
    v_lshlrev_b32 v200, 2, v200
    v_add_u32 v245, 161440, v200
    v_and_b32 v201, 1, v2
    v_bfe_u32 v202, v2, 1, 1
    v_bfe_u32 v203, v2, 4, 1
    v_lshrrev_b32 v205, 5, v2
    v_bfe_u32 v200, v2, 2, 2
    v_sub_u32 v207, v205, v202
    v_lshlrev_b32 v207, 6, v207
    v_lshl_add_u32 v206, v203, 2, v200
    v_sub_u32 v206, v206, v201
    v_lshl_add_u32 v207, v206, 3, v207
    s_mul_i32 s47, s44, 584
    s_add_u32 s47, s47, 145160
    v_add_u32 v254, s47, v207
    v_bfe_u32 v202, v2, 3, 1
    v_and_b32 v201, 7, v2
    v_lshrrev_b32 v206, 4, v2
    v_add_u32 v206, v201, v206
    v_mul_u32_u24 v207, 1408, v202
    v_lshl_add_u32 v206, v206, 4, v207
    s_mul_i32 s47, s44, 3472
    s_add_u32 s47, s47, 61760
    v_add_u32 v253, s47, v206
    v_mov_b64 v[60:61], 0
    v_mov_b64 v[62:63], 0
    v_mov_b64 v[64:65], 0
    v_mov_b64 v[66:67], 0
    v_mov_b64 v[68:69], 0
    v_mov_b64 v[70:71], 0
    v_mov_b64 v[72:73], 0
    v_mov_b64 v[74:75], 0
    v_mov_b64 v[76:77], 0
    v_mov_b64 v[78:79], 0
    v_mov_b64 v[80:81], 0
    v_mov_b64 v[82:83], 0
    v_mov_b64 v[84:85], 0
    v_mov_b64 v[86:87], 0
    v_mov_b64 v[88:89], 0
    v_mov_b64 v[90:91], 0
    v_mov_b64 v[92:93], 0
    v_mov_b64 v[94:95], 0
    v_mov_b64 v[96:97], 0
    v_mov_b64 v[98:99], 0
    v_mov_b64 v[100:101], 0
    v_mov_b64 v[102:103], 0
    v_mov_b64 v[216:217], 0
    v_mov_b64 v[218:219], 0
    v_mov_b64 v[220:221], 0
    v_mov_b64 v[222:223], 0
    v_mov_b64 v[224:225], 0
    v_mov_b64 v[226:227], 0
    s_mov_b32 s28, s8
    s_mov_b32 s29, s9
    s_mov_b32 s30, 73728
    s_mov_b32 s31, 0x20000
    s_mov_b32 s32, s12
    s_mov_b32 s33, s13
    s_mov_b32 s34, 73728
    s_mov_b32 s35, 0x20000
    s_mov_b32 s36, s18
    s_mov_b32 s37, s19
    s_mov_b32 s38, 9633792
    s_mov_b32 s39, 0x20000
    s_mul_i32 s57, s44, 768
    s_mul_i32 s58, s44, 776
    s_add_u32 s58, s58, 6144
    s_cmp_lt_u32 s44, 3
    s_cselect_b32 s40, s10, s14
    s_cselect_b32 s41, s11, s15
    s_movk_i32 s47, 192
    s_cselect_b32 s42, 768, s47
    s_cmp_lt_u32 s44, 4
    s_cselect_b32 s40, s40, s16
    s_cselect_b32 s41, s41, s17
    s_mov_b32 s43, 0x20000
    s_mov_b32 s47, 1055913304
    s_cselect_b32 s64, s47, 1074302617
    s_cmp_lt_u32 s44, 3
    s_cselect_b32 s47, s44, 0
    s_lshl_b32 s47, s47, 8
    v_lshl_add_u32 v204, v2, 2, s47
    s_min_u32 s47, s44, 4
    s_lshl_b32 s47, s47, 9
    s_add_u32 s47, s47, 148224
    v_lshl_add_u32 v250, v2, 3, s47
    v_lshl_add_u32 v242, v2, 4, s57
    s_lshr_b32 s47, s44, 2
    s_add_u32 s47, s47, 4
    v_lshrrev_b32 v240, s47, v2
    s_mov_b32 s47, 149760
    v_lshl_add_u32 v241, v240, 5, s47
    s_mov_b32 s47, 148224
    v_lshl_add_u32 v240, v240, 4, s47
    s_mul_i32 s47, s44, 3072
    s_add_u32 s47, s47, 24576
    s_mul_i32 s48, s56, 6144
    s_cmp_lt_u32 s44, 4
    s_cselect_b32 s47, s47, s48
    v_lshl_add_u32 v243, v2, 4, s47
    s_mov_b32 s60, 1084043516
    s_mov_b32 s61, 1084043516
    s_mov_b32 s62, 1.0
    s_mov_b32 s63, 1.0
    s_mul_i32 s55, s46, 43008
    s_mul_i32 s50, s45, 192
    s_add_u32 s55, s55, s50
    s_mov_b32 s52, 0x000f000f
    s_mov_b32 s53, 0x000f000f
    s_cmp_lt_u32 s44, 4
    s_cbranch_scc0 L_skip1
    v_mov_b32 v4, 1
    ds_write_b32 v244, v4
    s_waitcnt vmcnt(9)
    ds_write_b64 v252, v[104:105] offset:960
    ds_write_b64 v252, v[106:107] offset:4432
    s_waitcnt vmcnt(8)
    ds_write_b64 v252, v[108:109] offset:1120
    ds_write_b64 v252, v[110:111] offset:4592
L_skip1:
    s_cmp_lt_u32 s44, 4
    s_cbranch_scc1 L_skip2
    v_and_b32 v200, 255, v0
    v_mul_u32_u24 v201, 5462, v200
    v_lshrrev_b32 v201, 16, v201
    v_mul_u32_u24 v202, 12, v201
    v_sub_u32 v202, v200, v202
    v_mul_u32_u24 v203, 37, v201
    v_lshrrev_b32 v203, 8, v203
    v_add_u32 v201, v201, v203
    v_mul_u32_u24 v202, 1168, v202
    v_lshl_add_u32 v201, v201, 3, v202
    v_add_u32 v212, 145160, v201
    v_and_b32 v200, 255, v0
    v_add_u32 v200, 256, v200
    v_mul_u32_u24 v201, 5462, v200
    v_lshrrev_b32 v201, 16, v201
    v_mul_u32_u24 v202, 12, v201
    v_sub_u32 v202, v200, v202
    v_mul_u32_u24 v203, 37, v201
    v_lshrrev_b32 v203, 8, v203
    v_add_u32 v201, v201, v203
    v_mul_u32_u24 v202, 1168, v202
    v_lshl_add_u32 v201, v201, 3, v202
    v_add_u32 v213, 145160, v201
    v_and_b32 v200, 255, v0
    v_add_u32 v200, 512, v200
    v_mul_u32_u24 v201, 5462, v200
    v_lshrrev_b32 v201, 16, v201
    v_mul_u32_u24 v202, 12, v201
    v_sub_u32 v202, v200, v202
    v_min_u32 v201, 49, v201
    v_mul_u32_u24 v203, 37, v201
    v_lshrrev_b32 v203, 8, v203
    v_add_u32 v201, v201, v203
    v_mul_u32_u24 v202, 1168, v202
    v_lshl_add_u32 v201, v201, 3, v202
    v_add_u32 v214, 145160, v201
    s_waitcnt vmcnt(2)
    ds_write_b64 v212, v[152:153]
    ds_write_b64 v212, v[154:155] offset:584
    s_waitcnt vmcnt(1)
    ds_write_b64 v213, v[156:157]
    ds_write_b64 v213, v[158:159] offset:584
    s_waitcnt vmcnt(0)
    ds_write_b64 v214, v[160:161]
    ds_write_b64 v214, v[162:163] offset:584
    v_mov_b32_e64 v4, 2
    ds_write_b32 v244, v4
    v_add_u32 v208, 688128, v248
    buffer_load_dwordx4 v[104:107], v208, s[20:23], 0 offen
    v_add_u32 v209, 731136, v248
    buffer_load_dwordx4 v[108:111], v209, s[20:23], 0 offen
    v_add_u32 v208, 430080, v248
    buffer_load_dwordx4 v[112:115], v208, s[20:23], 0 offen
    v_add_u32 v209, 473088, v248
    buffer_load_dwordx4 v[116:119], v209, s[20:23], 0 offen
    v_add_u32 v208, 86016, v248
    v_min_u32_e64 v208, v208, v3
    buffer_load_dwordx4 v[120:123], v208, s[20:23], 0 offen
L_skip2:
L_poll1:
    ds_read_b32 v5, v245 offset:0
    s_waitcnt lgkmcnt(0)
    v_cmp_le_u32 vcc, 1, v5
    s_cmp_eq_u64 vcc, -1
    s_cbranch_scc0 L_poll1
    ds_read_b64_tr_b16 v[10:11], v254 offset:0
    ds_read_b64_tr_b16 v[14:15], v254 offset:128
    ds_read_b64_tr_b16 v[18:19], v254 offset:256
    ds_read_b64_tr_b16 v[22:23], v254 offset:384
    ds_read_b64_tr_b16 v[26:27], v254 offset:4672
    ds_read_b64_tr_b16 v[30:31], v254 offset:4800
    ds_read_b64_tr_b16 v[34:35], v254 offset:4928
    ds_read_b64_tr_b16 v[38:39], v254 offset:5056
    ds_read_b64_tr_b16 v[42:43], v254 offset:9344
    ds_read_b64_tr_b16 v[46:47], v254 offset:9472
    ds_read_b64_tr_b16 v[50:51], v254 offset:9600
    ds_read_b64_tr_b16 v[54:55], v254 offset:9728
    s_waitcnt lgkmcnt(8)
    v_and_b32 v8, v249, v10
    v_and_b32 v9, v7, v10
    v_and_b32 v10, v249, v11
    v_and_b32 v11, v7, v11
    v_and_b32 v12, v249, v14
    v_and_b32 v13, v7, v14
    v_and_b32 v14, v249, v15
    v_and_b32 v15, v7, v15
    v_and_b32 v16, v249, v18
    v_and_b32 v17, v7, v18
    v_and_b32 v18, v249, v19
    v_and_b32 v19, v7, v19
    v_and_b32 v20, v249, v22
    v_and_b32 v21, v7, v22
    v_and_b32 v22, v249, v23
    v_and_b32 v23, v7, v23
    s_waitcnt lgkmcnt(4)
    v_and_b32 v24, v249, v26
    v_and_b32 v25, v7, v26
    v_and_b32 v26, v249, v27
    v_and_b32 v27, v7, v27
    v_and_b32 v28, v249, v30
    v_and_b32 v29, v7, v30
    v_and_b32 v30, v249, v31
    v_and_b32 v31, v7, v31
    v_and_b32 v32, v249, v34
    v_and_b32 v33, v7, v34
    v_and_b32 v34, v249, v35
    v_and_b32 v35, v7, v35
    v_and_b32 v36, v249, v38
    v_and_b32 v37, v7, v38
    v_and_b32 v38, v249, v39
    v_and_b32 v39, v7, v39
    s_waitcnt lgkmcnt(0)
    v_and_b32 v40, v249, v42
    v_and_b32 v41, v7, v42
    v_and_b32 v42, v249, v43
    v_and_b32 v43, v7, v43
    v_and_b32 v44, v249, v46
    v_and_b32 v45, v7, v46
    v_and_b32 v46, v249, v47
    v_and_b32 v47, v7, v47
    v_and_b32 v48, v249, v50
    v_and_b32 v49, v7, v50
    v_and_b32 v50, v249, v51
    v_and_b32 v51, v7, v51
    v_and_b32 v52, v249, v54
    v_and_b32 v53, v7, v54
    v_and_b32 v54, v249, v55
    v_and_b32 v55, v7, v55
    s_cmp_lt_u32 s44, 4
    s_cbranch_scc1 L_skip3
    v_add_u32 v209, 129024, v248
    buffer_load_dwordx4 v[124:127], v209, s[20:23], 0 offen
    v_add_u32 v208, 774144, v248
    buffer_load_dwordx4 v[128:131], v208, s[20:23], 0 offen
    v_add_u32 v209, 817152, v248
    buffer_load_dwordx4 v[132:135], v209, s[20:23], 0 offen
    v_add_u32 v208, 0, v248
    v_min_u32 v208, v208, v3
    buffer_load_dwordx4 v[136:139], v208, s[20:23], 0 offen
    v_add_u32 v209, 43008, v248
    v_min_u32 v209, v209, v3
    buffer_load_dwordx4 v[140:143], v209, s[20:23], 0 offen
L_skip3:
    s_cmp_lt_u32 s44, 4
    s_cbranch_scc0 L_skip4
    s_waitcnt vmcnt(7)
    ds_write_b64 v252, v[112:113] offset:2368
    ds_write_b64 v252, v[114:115] offset:5840
    s_waitcnt vmcnt(6)
    ds_write_b64 v252, v[116:117] offset:2528
    ds_write_b64 v252, v[118:119] offset:6000
    s_waitcnt vmcnt(5)
    ds_write_b64 v252, v[120:121] offset:640
    ds_write_b64 v252, v[122:123] offset:4112
    s_waitcnt vmcnt(4)
    ds_write_b64 v252, v[124:125] offset:800
    ds_write_b64 v252, v[126:127] offset:4272
    s_waitcnt vmcnt(3)
    ds_write_b64 v252, v[128:129] offset:2048
    ds_write_b64 v252, v[130:131] offset:5520
    s_waitcnt vmcnt(2)
    ds_write_b64 v252, v[132:133] offset:2208
    ds_write_b64 v252, v[134:135] offset:5680
    v_mov_b32 v4, 2
    ds_write_b32 v244, v4
L_skip4:
L_poll2:
    ds_read_b32 v5, v245 offset:0
    s_waitcnt lgkmcnt(0)
    v_cmp_le_u32 vcc, 2, v5
    s_cmp_eq_u64 vcc, -1
    s_cbranch_scc0 L_poll2
    s_cmp_lt_u32 s44, 4
    s_cbranch_scc1 L_pa0
    s_nop 0
    ds_read_b128 v[152:155], v253 offset:960
    ds_read_b128 v[156:159], v253 offset:1120
    ds_read_b128 v[160:163], v253 offset:28736
    ds_read_b128 v[164:167], v253 offset:28896
    ds_read_b128 v[168:171], v253 offset:56512
    ds_read_b128 v[172:175], v253 offset:56672
    ds_read_b128 v[176:179], v253 offset:640
    ds_read_b128 v[180:183], v253 offset:800
    ds_read_b128 v[184:187], v253 offset:28416
    ds_read_b128 v[188:191], v253 offset:28576
    ds_read_b128 v[192:195], v253 offset:56192
    ds_read_b128 v[196:199], v253 offset:56352
    s_setprio 1
    buffer_load_dwordx4 v[232:235], v1, s[96:99], 0 offen offset:0
    buffer_load_dwordx4 v[236:239], v1, s[96:99], 0 offen offset:1024
    buffer_load_dword v6, v204, s[40:43], 0 offen
    s_waitcnt lgkmcnt(10)
    v_smfmac_f32_16x16x64_bf16 v[56:59], v[20:23], v[152:159], v251
    v_smfmac_f32_16x16x64_bf16 v[60:63], v[16:19], v[152:159], v251
    v_smfmac_f32_16x16x64_bf16 v[64:67], v[12:15], v[152:159], v251
    v_smfmac_f32_16x16x64_bf16 v[68:71], v[8:11], v[152:159], v251
    s_waitcnt vmcnt(12)
    ds_write_b64 v252, v[104:105] offset:2816
    ds_write_b64 v252, v[106:107] offset:6288
    s_waitcnt lgkmcnt(10)
    v_smfmac_f32_16x16x64_bf16 v[72:75], v[36:39], v[160:167], v251
    v_smfmac_f32_16x16x64_bf16 v[76:79], v[32:35], v[160:167], v251
    v_smfmac_f32_16x16x64_bf16 v[80:83], v[28:31], v[160:167], v251
    v_smfmac_f32_16x16x64_bf16 v[84:87], v[24:27], v[160:167], v251
    s_waitcnt vmcnt(11)
    ds_write_b64 v252, v[108:109] offset:2976
    ds_write_b64 v252, v[110:111] offset:6448
    s_waitcnt lgkmcnt(10)
    v_smfmac_f32_16x16x64_bf16 v[88:91], v[52:55], v[168:175], v251
    v_smfmac_f32_16x16x64_bf16 v[92:95], v[48:51], v[168:175], v251
    v_smfmac_f32_16x16x64_bf16 v[96:99], v[44:47], v[168:175], v251
    v_smfmac_f32_16x16x64_bf16 v[100:103], v[40:43], v[168:175], v251
    s_waitcnt vmcnt(10)
    ds_write_b64 v252, v[112:113] offset:1728
    ds_write_b64 v252, v[114:115] offset:5200
    s_waitcnt vmcnt(9)
    ds_write_b64 v252, v[116:117] offset:1888
    ds_write_b64 v252, v[118:119] offset:5360
    s_waitcnt lgkmcnt(12)
    v_smfmac_f32_16x16x64_bf16 v[56:59], v[16:19], v[176:183], v251
    v_smfmac_f32_16x16x64_bf16 v[60:63], v[12:15], v[176:183], v251
    v_smfmac_f32_16x16x64_bf16 v[64:67], v[8:11], v[176:183], v251
    v_smfmac_f32_16x16x64_bf16 v[216:219], v[20:23], v[176:183], v251
    s_waitcnt vmcnt(8)
    ds_write_b64 v252, v[120:121] offset:320
    ds_write_b64 v252, v[122:123] offset:3792
    s_waitcnt vmcnt(7)
    ds_write_b64 v252, v[124:125] offset:480
    ds_write_b64 v252, v[126:127] offset:3952
    s_waitcnt lgkmcnt(14)
    v_smfmac_f32_16x16x64_bf16 v[72:75], v[32:35], v[184:191], v251
    v_smfmac_f32_16x16x64_bf16 v[76:79], v[28:31], v[184:191], v251
    v_smfmac_f32_16x16x64_bf16 v[80:83], v[24:27], v[184:191], v251
    v_smfmac_f32_16x16x64_bf16 v[220:223], v[36:39], v[184:191], v251
    s_waitcnt vmcnt(6)
    ds_write_b64 v252, v[128:129] offset:3136
    ds_write_b64 v252, v[130:131] offset:6608
    s_waitcnt vmcnt(5)
    ds_write_b64 v252, v[132:133] offset:3296
    ds_write_b64 v252, v[134:135] offset:6768
    s_waitcnt lgkmcnt(15)
    v_smfmac_f32_16x16x64_bf16 v[88:91], v[48:51], v[192:199], v251
    v_smfmac_f32_16x16x64_bf16 v[92:95], v[44:47], v[192:199], v251
    v_smfmac_f32_16x16x64_bf16 v[96:99], v[40:43], v[192:199], v251
    v_smfmac_f32_16x16x64_bf16 v[224:227], v[52:55], v[192:199], v251
    s_waitcnt vmcnt(4)
    ds_write_b64 v252, v[136:137] offset:0
    ds_write_b64 v252, v[138:139] offset:3472
    s_waitcnt vmcnt(3)
    ds_write_b64 v252, v[140:141] offset:160
    ds_write_b64 v252, v[142:143] offset:3632
    s_setprio 0
    s_branch L_pe0
L_pa0:
    s_nop 0
    ds_read_b128 v[152:155], v253 offset:960
    ds_read_b128 v[156:159], v253 offset:1120
    ds_read_b128 v[160:163], v253 offset:28736
    ds_read_b128 v[164:167], v253 offset:28896
    ds_read_b128 v[168:171], v253 offset:56512
    ds_read_b128 v[172:175], v253 offset:56672
    ds_read_b128 v[176:179], v253 offset:640
    ds_read_b128 v[180:183], v253 offset:800
    ds_read_b128 v[184:187], v253 offset:28416
    ds_read_b128 v[188:191], v253 offset:28576
    ds_read_b128 v[192:195], v253 offset:56192
    ds_read_b128 v[196:199], v253 offset:56352
    s_waitcnt lgkmcnt(10)
    v_smfmac_f32_16x16x64_bf16 v[56:59], v[20:23], v[152:159], v251
    v_smfmac_f32_16x16x64_bf16 v[60:63], v[16:19], v[152:159], v251
    v_smfmac_f32_16x16x64_bf16 v[64:67], v[12:15], v[152:159], v251
    v_smfmac_f32_16x16x64_bf16 v[68:71], v[8:11], v[152:159], v251
    s_waitcnt vmcnt(1)
    ds_write_b64 v252, v[136:137] offset:1408
    ds_write_b64 v252, v[138:139] offset:4880
    s_waitcnt lgkmcnt(10)
    v_smfmac_f32_16x16x64_bf16 v[72:75], v[36:39], v[160:167], v251
    v_smfmac_f32_16x16x64_bf16 v[76:79], v[32:35], v[160:167], v251
    v_smfmac_f32_16x16x64_bf16 v[80:83], v[28:31], v[160:167], v251
    v_smfmac_f32_16x16x64_bf16 v[84:87], v[24:27], v[160:167], v251
    s_waitcnt vmcnt(0)
    ds_write_b64 v252, v[140:141] offset:1568
    ds_write_b64 v252, v[142:143] offset:5040
    s_waitcnt lgkmcnt(10)
    v_smfmac_f32_16x16x64_bf16 v[88:91], v[52:55], v[168:175], v251
    v_smfmac_f32_16x16x64_bf16 v[92:95], v[48:51], v[168:175], v251
    v_smfmac_f32_16x16x64_bf16 v[96:99], v[44:47], v[168:175], v251
    v_smfmac_f32_16x16x64_bf16 v[100:103], v[40:43], v[168:175], v251
    s_waitcnt lgkmcnt(8)
    v_smfmac_f32_16x16x64_bf16 v[56:59], v[16:19], v[176:183], v251
    v_smfmac_f32_16x16x64_bf16 v[60:63], v[12:15], v[176:183], v251
    v_smfmac_f32_16x16x64_bf16 v[64:67], v[8:11], v[176:183], v251
    v_smfmac_f32_16x16x64_bf16 v[216:219], v[20:23], v[176:183], v251
    s_waitcnt lgkmcnt(6)
    v_smfmac_f32_16x16x64_bf16 v[72:75], v[32:35], v[184:191], v251
    v_smfmac_f32_16x16x64_bf16 v[76:79], v[28:31], v[184:191], v251
    v_smfmac_f32_16x16x64_bf16 v[80:83], v[24:27], v[184:191], v251
    v_smfmac_f32_16x16x64_bf16 v[220:223], v[36:39], v[184:191], v251
    s_waitcnt lgkmcnt(4)
    v_smfmac_f32_16x16x64_bf16 v[88:91], v[48:51], v[192:199], v251
    v_smfmac_f32_16x16x64_bf16 v[92:95], v[44:47], v[192:199], v251
    v_smfmac_f32_16x16x64_bf16 v[96:99], v[40:43], v[192:199], v251
    v_smfmac_f32_16x16x64_bf16 v[224:227], v[52:55], v[192:199], v251
    buffer_load_dwordx4 v[232:235], v1, s[96:99], 0 offen offset:0
    buffer_load_dwordx4 v[236:239], v1, s[96:99], 0 offen offset:1024
    buffer_load_dword v6, v204, s[40:43], 0 offen
L_pe0:
    s_waitcnt lgkmcnt(0)
    s_barrier
    ds_read_b128 v[152:155], v253 offset:1408
    ds_read_b128 v[156:159], v253 offset:1568
    ds_read_b128 v[160:163], v253 offset:320
    ds_read_b128 v[164:167], v253 offset:480
    ds_read_b128 v[168:171], v253 offset:1728
    ds_read_b128 v[172:175], v253 offset:1888
    ds_read_b128 v[176:179], v253 offset:0
    ds_read_b128 v[180:183], v253 offset:160
    ds_read_b128 v[184:187], v253 offset:29184
    ds_read_b128 v[188:191], v253 offset:29344
    ds_read_b128 v[192:195], v253 offset:28096
    ds_read_b128 v[196:199], v253 offset:28256
    v_add_f32_dpp v68, v216, v68 row_ror:8 row_mask:0xf bank_mask:0xf
    v_add_f32_dpp v69, v217, v69 row_ror:8 row_mask:0xf bank_mask:0xf
    v_add_f32_dpp v70, v218, v70 row_ror:8 row_mask:0xf bank_mask:0xf
    v_add_f32_dpp v71, v219, v71 row_ror:8 row_mask:0xf bank_mask:0xf
    v_add_f32_dpp v84, v220, v84 row_ror:8 row_mask:0xf bank_mask:0xf
    v_add_f32_dpp v85, v221, v85 row_ror:8 row_mask:0xf bank_mask:0xf
    v_add_f32_dpp v86, v222, v86 row_ror:8 row_mask:0xf bank_mask:0xf
    v_add_f32_dpp v87, v223, v87 row_ror:8 row_mask:0xf bank_mask:0xf
    v_add_f32_dpp v100, v224, v100 row_ror:8 row_mask:0xf bank_mask:0xf
    v_add_f32_dpp v101, v225, v101 row_ror:8 row_mask:0xf bank_mask:0xf
    v_add_f32_dpp v102, v226, v102 row_ror:8 row_mask:0xf bank_mask:0xf
    v_add_f32_dpp v103, v227, v103 row_ror:8 row_mask:0xf bank_mask:0xf
    s_waitcnt lgkmcnt(10)
    v_smfmac_f32_16x16x64_bf16 v[60:63], v[20:23], v[152:159], v251
    v_smfmac_f32_16x16x64_bf16 v[64:67], v[16:19], v[152:159], v251
    v_smfmac_f32_16x16x64_bf16 v[68:71], v[12:15], v[152:159], v251
    ds_read_b128 v[152:155], v253 offset:29504
    ds_read_b128 v[156:159], v253 offset:29664
    s_waitcnt lgkmcnt(10)
    v_smfmac_f32_16x16x64_bf16 v[56:59], v[12:15], v[160:167], v251
    v_smfmac_f32_16x16x64_bf16 v[60:63], v[8:11], v[160:167], v251
    ds_read_b128 v[160:163], v253 offset:27776
    ds_read_b128 v[164:167], v253 offset:27936
    s_waitcnt lgkmcnt(10)
    v_smfmac_f32_16x16x64_bf16 v[64:67], v[20:23], v[168:175], v251
    v_smfmac_f32_16x16x64_bf16 v[68:71], v[16:19], v[168:175], v251
    ds_read_b128 v[168:171], v253 offset:56960
    ds_read_b128 v[172:175], v253 offset:57120
    s_waitcnt vmcnt(1)
    s_mov_b32 exec_hi, 0xffff
    s_add_u32 m0, s57, 0
    s_movk_i32 s59, 0
    buffer_load_dwordx4 v236, s[28:31], s59 offen lds
    s_mov_b32 exec_hi, -1
    s_waitcnt lgkmcnt(10)
    v_smfmac_f32_16x16x64_bf16 v[56:59], v[8:11], v[176:183], v251
    ds_read_b128 v[176:179], v253 offset:55872
    ds_read_b128 v[180:183], v253 offset:56032
    s_waitcnt lgkmcnt(10)
    v_smfmac_f32_16x16x64_bf16 v[76:79], v[36:39], v[184:191], v251
    v_smfmac_f32_16x16x64_bf16 v[80:83], v[32:35], v[184:191], v251
    v_smfmac_f32_16x16x64_bf16 v[84:87], v[28:31], v[184:191], v251
    ds_read_b128 v[184:187], v253 offset:57280
    ds_read_b128 v[188:191], v253 offset:57440
    s_waitcnt lgkmcnt(10)
    v_smfmac_f32_16x16x64_bf16 v[72:75], v[28:31], v[192:199], v251
    v_smfmac_f32_16x16x64_bf16 v[76:79], v[24:27], v[192:199], v251
    ds_read_b128 v[192:195], v253 offset:55552
    ds_read_b128 v[196:199], v253 offset:55712
    s_waitcnt lgkmcnt(10)
    v_smfmac_f32_16x16x64_bf16 v[80:83], v[36:39], v[152:159], v251
    v_smfmac_f32_16x16x64_bf16 v[84:87], v[32:35], v[152:159], v251
    s_waitcnt lgkmcnt(8)
    v_smfmac_f32_16x16x64_bf16 v[72:75], v[24:27], v[160:167], v251
    v_cvt_pk_bf16_f32 v106, v60, v61
    v_cvt_pk_bf16_f32 v107, v62, v63
    ds_write_b64 v239, v[106:107] offset:224
    v_cvt_pk_bf16_f32 v108, v64, v65
    v_cvt_pk_bf16_f32 v109, v66, v67
    ds_write_b64 v239, v[108:109] offset:448
    v_cvt_pk_bf16_f32 v110, v68, v69
    v_cvt_pk_bf16_f32 v111, v70, v71
    ds_write_b64 v239, v[110:111] offset:672
    v_cvt_pk_bf16_f32 v104, v56, v57
    v_cvt_pk_bf16_f32 v105, v58, v59
    ds_write_b64 v239, v[104:105] offset:0
    s_waitcnt lgkmcnt(10)
    v_smfmac_f32_16x16x64_bf16 v[92:95], v[52:55], v[168:175], v251
    v_smfmac_f32_16x16x64_bf16 v[96:99], v[48:51], v[168:175], v251
    v_smfmac_f32_16x16x64_bf16 v[100:103], v[44:47], v[168:175], v251
    s_waitcnt lgkmcnt(8)
    v_smfmac_f32_16x16x64_bf16 v[88:91], v[44:47], v[176:183], v251
    v_smfmac_f32_16x16x64_bf16 v[92:95], v[40:43], v[176:183], v251
    s_waitcnt lgkmcnt(6)
    v_smfmac_f32_16x16x64_bf16 v[96:99], v[52:55], v[184:191], v251
    v_smfmac_f32_16x16x64_bf16 v[100:103], v[48:51], v[184:191], v251
    s_waitcnt lgkmcnt(4)
    v_smfmac_f32_16x16x64_bf16 v[88:91], v[40:43], v[192:199], v251
    v_cvt_pk_bf16_f32 v114, v76, v77
    v_cvt_pk_bf16_f32 v115, v78, v79
    ds_write_b64 v239, v[114:115] offset:28000
    v_cvt_pk_bf16_f32 v116, v80, v81
    v_cvt_pk_bf16_f32 v117, v82, v83
    ds_write_b64 v239, v[116:117] offset:28224
    v_cvt_pk_bf16_f32 v118, v84, v85
    v_cvt_pk_bf16_f32 v119, v86, v87
    ds_write_b64 v239, v[118:119] offset:28448
    v_cvt_pk_bf16_f32 v112, v72, v73
    v_cvt_pk_bf16_f32 v113, v74, v75
    ds_write_b64 v239, v[112:113] offset:27776
    s_waitcnt vmcnt(1)
    v_lshlrev_b32 v4, 16, v6
    v_and_b32 v5, v7, v6
    v_mul_f32 v4, s64, v4
    v_mul_f32_e64 v5, s64, v5
    ds_write_b64 v250, v[4:5]
    v_cvt_pk_bf16_f32 v122, v92, v93
    v_cvt_pk_bf16_f32 v123, v94, v95
    ds_write_b64 v239, v[122:123] offset:55776
    v_cvt_pk_bf16_f32 v124, v96, v97
    v_cvt_pk_bf16_f32 v125, v98, v99
    ds_write_b64 v239, v[124:125] offset:56000
    v_cvt_pk_bf16_f32 v126, v100, v101
    v_cvt_pk_bf16_f32 v127, v102, v103
    ds_write_b64 v239, v[126:127] offset:56224
    v_cvt_pk_bf16_f32 v120, v88, v89
    v_cvt_pk_bf16_f32 v121, v90, v91
    ds_write_b64 v239, v[120:121] offset:55552
    s_mov_b32 exec_hi, 0xffff
    s_add_u32 m0, s57, 12352
    s_movk_i32 s59, 64
    buffer_load_dwordx4 v236, s[28:31], s59 offen lds
    s_mov_b32 exec_hi, -1
    s_waitcnt vmcnt(1)
    s_waitcnt lgkmcnt(0)
    s_barrier
    s_cmp_lt_u32 s44, 4
    s_cbranch_scc1 L_narrow
    s_nop 0
    ds_read_b64 v[160:161], v234 offset:0
    ds_read_b64 v[162:163], v234 offset:6944
    ds_read_b64 v[164:165], v234 offset:13888
    ds_read_b64 v[166:167], v234 offset:20832
    ds_read_b64 v[168:169], v234 offset:27776
    ds_read_b64 v[170:171], v234 offset:34720
    ds_read_b64 v[172:173], v235 offset:0
    ds_read_b64 v[174:175], v235 offset:6944
    ds_read_b64 v[176:177], v235 offset:13888
    ds_read_b64 v[178:179], v235 offset:20832
    ds_read_b64 v[180:181], v235 offset:27776
    ds_read_b64 v[182:183], v235 offset:34720
    s_mov_b32 exec_hi, 0xffff
    s_add_u32 m0, s57, 24704
    s_movk_i32 s59, 128
    buffer_load_dwordx4 v236, s[28:31], s59 offen lds
    s_add_u32 m0, s57, 37056
    s_movk_i32 s59, 192
    buffer_load_dwordx4 v236, s[28:31], s59 offen lds
    s_mov_b32 exec_hi, -1
    s_waitcnt lgkmcnt(10)
    v_lshlrev_b32 v24, 16, v160
    v_and_b32 v25, v7, v160
    v_lshlrev_b32 v26, 16, v161
    v_and_b32 v27, v7, v161
    v_lshlrev_b32 v28, 16, v162
    v_and_b32 v29, v7, v162
    v_lshlrev_b32 v30, 16, v163
    v_and_b32 v31, v7, v163
    s_waitcnt lgkmcnt(8)
    v_lshlrev_b32 v32, 16, v164
    v_and_b32 v33, v7, v164
    v_lshlrev_b32 v34, 16, v165
    v_and_b32 v35, v7, v165
    v_lshlrev_b32 v36, 16, v166
    v_and_b32 v37, v7, v166
    v_lshlrev_b32 v38, 16, v167
    v_and_b32 v39, v7, v167
    s_waitcnt lgkmcnt(6)
    v_lshlrev_b32 v40, 16, v168
    v_and_b32 v41, v7, v168
    v_lshlrev_b32 v42, 16, v169
    v_and_b32 v43, v7, v169
    v_lshlrev_b32 v44, 16, v170
    v_and_b32 v45, v7, v170
    v_lshlrev_b32 v46, 16, v171
    v_and_b32 v47, v7, v171
    s_waitcnt lgkmcnt(4)
    s_mov_b32 exec_hi, 0xffff
    s_add_u32 m0, s58, 0
    s_mov_b32 s59, 0
    buffer_load_dwordx4 v242, s[32:35], s59 offen lds
    s_add_u32 m0, s57, 49408
    s_movk_i32 s59, 256
    buffer_load_dwordx4 v236, s[28:31], s59 offen lds
    s_mov_b32 exec_hi, -1
    v_lshlrev_b32 v48, 16, v172
    v_and_b32 v49, v7, v172
    v_lshlrev_b32 v50, 16, v173
    v_and_b32 v51, v7, v173
    v_lshlrev_b32 v52, 16, v174
    v_and_b32 v53, v7, v174
    v_lshlrev_b32 v54, 16, v175
    v_and_b32 v55, v7, v175
    s_waitcnt lgkmcnt(2)
    v_lshlrev_b32 v56, 16, v176
    v_and_b32 v57, v7, v176
    v_lshlrev_b32 v58, 16, v177
    v_and_b32 v59, v7, v177
    v_lshlrev_b32 v60, 16, v178
    v_and_b32 v61, v7, v178
    v_lshlrev_b32 v62, 16, v179
    v_and_b32 v63, v7, v179
    s_waitcnt lgkmcnt(0)
    v_lshlrev_b32 v64, 16, v180
    v_and_b32 v65, v7, v180
    v_lshlrev_b32 v66, 16, v181
    v_and_b32 v67, v7, v181
    v_lshlrev_b32 v68, 16, v182
    v_and_b32 v69, v7, v182
    v_lshlrev_b32 v70, 16, v183
    v_and_b32 v71, v7, v183
    s_mov_b32 exec_hi, 0xffff
    s_add_u32 m0, s58, 12352
    s_mov_b32 s59, 6144
    buffer_load_dwordx4 v242, s[32:35], s59 offen lds
    s_mov_b32 exec_hi, -1
    ds_read_b128 v[8:11], v240 offset:0
    ds_read_b128 v[12:15], v240 offset:32
    ds_read_b128 v[16:19], v240 offset:64
    ds_read_b128 v[20:23], v240 offset:96
    ds_read_b64_tr_b16 v[184:185], v232 offset:0
    ds_read_b64_tr_b16 v[186:187], v232 offset:512
    ds_read_b64_tr_b16 v[188:189], v232 offset:1024
    ds_read_b64_tr_b16 v[190:191], v232 offset:1536
    ds_read_b64_tr_b16 v[192:193], v232 offset:2048
    ds_read_b64_tr_b16 v[194:195], v232 offset:2560
    ds_read_b64_tr_b16 v[196:197], v232 offset:3072
    ds_read_b64_tr_b16 v[198:199], v232 offset:3584
    ds_read_b64_tr_b16 v[200:201], v232 offset:4096
    ds_read_b64_tr_b16 v[202:203], v232 offset:4608
    v_mov_b32 v80, 1027751813
    v_pk_mul_f32 v[76:77], v[24:25], v[24:25]
    v_pk_mul_f32 v[78:79], v[26:27], v[26:27]
    v_pk_fma_f32 v[76:77], v[28:29], v[28:29], v[76:77]
    v_pk_fma_f32 v[78:79], v[30:31], v[30:31], v[78:79]
    v_pk_add_f32 v[72:73], v[24:25], v[28:29]
    v_pk_add_f32 v[74:75], v[26:27], v[30:31]
    v_pk_fma_f32 v[76:77], v[32:33], v[32:33], v[76:77]
    v_pk_fma_f32 v[78:79], v[34:35], v[34:35], v[78:79]
    v_pk_add_f32 v[72:73], v[72:73], v[32:33]
    v_pk_add_f32 v[74:75], v[74:75], v[34:35]
    v_pk_fma_f32 v[76:77], v[36:37], v[36:37], v[76:77]
    v_pk_fma_f32 v[78:79], v[38:39], v[38:39], v[78:79]
    v_pk_add_f32 v[72:73], v[72:73], v[36:37]
    v_pk_add_f32 v[74:75], v[74:75], v[38:39]
    v_pk_fma_f32 v[76:77], v[40:41], v[40:41], v[76:77]
    v_pk_fma_f32 v[78:79], v[42:43], v[42:43], v[78:79]
    v_pk_add_f32 v[72:73], v[72:73], v[40:41]
    v_pk_add_f32 v[74:75], v[74:75], v[42:43]
    v_pk_fma_f32 v[76:77], v[44:45], v[44:45], v[76:77]
    v_pk_fma_f32 v[78:79], v[46:47], v[46:47], v[78:79]
    v_pk_add_f32 v[72:73], v[72:73], v[44:45]
    v_pk_add_f32 v[74:75], v[74:75], v[46:47]
    v_pk_fma_f32 v[76:77], v[48:49], v[48:49], v[76:77]
    v_pk_fma_f32 v[78:79], v[50:51], v[50:51], v[78:79]
    v_pk_add_f32 v[72:73], v[72:73], v[48:49]
    v_pk_add_f32 v[74:75], v[74:75], v[50:51]
    v_pk_fma_f32 v[76:77], v[52:53], v[52:53], v[76:77]
    v_pk_fma_f32 v[78:79], v[54:55], v[54:55], v[78:79]
    v_pk_add_f32 v[72:73], v[72:73], v[52:53]
    v_pk_add_f32 v[74:75], v[74:75], v[54:55]
    v_pk_fma_f32 v[76:77], v[56:57], v[56:57], v[76:77]
    v_pk_fma_f32 v[78:79], v[58:59], v[58:59], v[78:79]
    v_pk_add_f32 v[72:73], v[72:73], v[56:57]
    v_pk_add_f32 v[74:75], v[74:75], v[58:59]
    v_pk_fma_f32 v[76:77], v[60:61], v[60:61], v[76:77]
    v_pk_fma_f32 v[78:79], v[62:63], v[62:63], v[78:79]
    v_pk_add_f32 v[72:73], v[72:73], v[60:61]
    v_pk_add_f32 v[74:75], v[74:75], v[62:63]
    v_pk_fma_f32 v[76:77], v[64:65], v[64:65], v[76:77]
    v_pk_fma_f32 v[78:79], v[66:67], v[66:67], v[78:79]
    v_pk_add_f32 v[72:73], v[72:73], v[64:65]
    v_pk_add_f32 v[74:75], v[74:75], v[66:67]
    v_pk_fma_f32 v[76:77], v[68:69], v[68:69], v[76:77]
    v_pk_fma_f32 v[78:79], v[70:71], v[70:71], v[78:79]
    v_pk_add_f32 v[72:73], v[72:73], v[68:69]
    v_pk_add_f32 v[74:75], v[74:75], v[70:71]
    v_pk_add_f32 v[72:73], v[72:73], v[74:75]
    v_pk_add_f32 v[76:77], v[76:77], v[78:79]
    v_add_f32 v74, v72, v73
    v_add_f32 v72, v72, v73
    v_add_f32 v78, v76, v77
    v_add_f32 v76, v76, v77
    v_permlane32_swap_b32 v72, v74
    ds_read_b64_tr_b16 v[204:205], v232 offset:5120
    v_permlane32_swap_b32 v76, v78
    v_add_f32 v72, v72, v74
    v_add_f32 v76, v76, v78
    v_mul_f32 v74, 1018565494, v72
    v_fmaak_f32 v76, v76, v80, 0x383ef424
    v_mul_f32 v72, 3156912811, v72
    v_fma_f32 v76, -v74, v74, v76
    v_max_f32 v76, 943649828, v76
    v_rsq_f32 v76, v76
    ds_read_b64_tr_b16 v[206:207], v232 offset:5632
    v_mul_f32 v72, v72, v76
    v_pk_fma_f32 v[24:25], v[24:25], v[76:77], v[72:73] op_sel_hi:[1,0,0]
    v_pk_fma_f32 v[26:27], v[26:27], v[76:77], v[72:73] op_sel_hi:[1,0,0]
    v_pk_fma_f32 v[28:29], v[28:29], v[76:77], v[72:73] op_sel_hi:[1,0,0]
    v_pk_fma_f32 v[30:31], v[30:31], v[76:77], v[72:73] op_sel_hi:[1,0,0]
    v_pk_fma_f32 v[32:33], v[32:33], v[76:77], v[72:73] op_sel_hi:[1,0,0]
    v_pk_fma_f32 v[34:35], v[34:35], v[76:77], v[72:73] op_sel_hi:[1,0,0]
    v_pk_fma_f32 v[36:37], v[36:37], v[76:77], v[72:73] op_sel_hi:[1,0,0]
    v_pk_fma_f32 v[38:39], v[38:39], v[76:77], v[72:73] op_sel_hi:[1,0,0]
    v_pk_fma_f32 v[40:41], v[40:41], v[76:77], v[72:73] op_sel_hi:[1,0,0]
    v_pk_fma_f32 v[42:43], v[42:43], v[76:77], v[72:73] op_sel_hi:[1,0,0]
    v_pk_fma_f32 v[44:45], v[44:45], v[76:77], v[72:73] op_sel_hi:[1,0,0]
    v_pk_fma_f32 v[46:47], v[46:47], v[76:77], v[72:73] op_sel_hi:[1,0,0]
    v_pk_fma_f32 v[48:49], v[48:49], v[76:77], v[72:73] op_sel_hi:[1,0,0]
    v_pk_fma_f32 v[50:51], v[50:51], v[76:77], v[72:73] op_sel_hi:[1,0,0]
    v_pk_fma_f32 v[52:53], v[52:53], v[76:77], v[72:73] op_sel_hi:[1,0,0]
    v_pk_fma_f32 v[54:55], v[54:55], v[76:77], v[72:73] op_sel_hi:[1,0,0]
    v_pk_fma_f32 v[56:57], v[56:57], v[76:77], v[72:73] op_sel_hi:[1,0,0]
    v_pk_fma_f32 v[58:59], v[58:59], v[76:77], v[72:73] op_sel_hi:[1,0,0]
    v_pk_fma_f32 v[60:61], v[60:61], v[76:77], v[72:73] op_sel_hi:[1,0,0]
    v_pk_fma_f32 v[62:63], v[62:63], v[76:77], v[72:73] op_sel_hi:[1,0,0]
    v_pk_fma_f32 v[64:65], v[64:65], v[76:77], v[72:73] op_sel_hi:[1,0,0]
    v_pk_fma_f32 v[66:67], v[66:67], v[76:77], v[72:73] op_sel_hi:[1,0,0]
    v_pk_fma_f32 v[68:69], v[68:69], v[76:77], v[72:73] op_sel_hi:[1,0,0]
    v_pk_fma_f32 v[70:71], v[70:71], v[76:77], v[72:73] op_sel_hi:[1,0,0]
    s_waitcnt vmcnt(0) lgkmcnt(0)
    s_barrier
    v_cvt_pk_bf16_f32 v160, v24, v25
    v_cvt_pk_bf16_f32 v161, v26, v27
    v_cvt_pk_bf16_f32 v162, v28, v29
    v_cvt_pk_bf16_f32 v163, v30, v31
    v_cvt_pk_bf16_f32 v164, v32, v33
    v_cvt_pk_bf16_f32 v165, v34, v35
    v_mfma_f32_32x32x16_bf16 v[8:23], v[184:187], v[160:163], v[8:23]
    v_cvt_pk_bf16_f32 v166, v36, v37
    v_cvt_pk_bf16_f32 v167, v38, v39
    v_cvt_pk_bf16_f32 v168, v40, v41
    v_cvt_pk_bf16_f32 v169, v42, v43
    v_mfma_f32_32x32x16_bf16 v[8:23], v[188:191], v[164:167], v[8:23]
    v_cvt_pk_bf16_f32 v170, v44, v45
    v_cvt_pk_bf16_f32 v171, v46, v47
    v_cvt_pk_bf16_f32 v172, v48, v49
    v_cvt_pk_bf16_f32 v173, v50, v51
    v_mfma_f32_32x32x16_bf16 v[8:23], v[192:195], v[168:171], v[8:23]
    v_cvt_pk_bf16_f32 v174, v52, v53
    v_cvt_pk_bf16_f32 v175, v54, v55
    v_cvt_pk_bf16_f32 v176, v56, v57
    v_cvt_pk_bf16_f32 v177, v58, v59
    v_mfma_f32_32x32x16_bf16 v[8:23], v[196:199], v[172:175], v[8:23]
    v_cvt_pk_bf16_f32 v178, v60, v61
    v_cvt_pk_bf16_f32 v179, v62, v63
    v_cvt_pk_bf16_f32 v180, v64, v65
    v_cvt_pk_bf16_f32 v181, v66, v67
    v_mfma_f32_32x32x16_bf16 v[8:23], v[200:203], v[176:179], v[8:23]
    v_cvt_pk_bf16_f32 v182, v68, v69
    v_cvt_pk_bf16_f32 v183, v70, v71
    s_nop 1
    v_mfma_f32_32x32x16_bf16 v[8:23], v[204:207], v[180:183], v[8:23]
    s_setprio 3
    s_nop 11
    s_nop 0
    v_pk_fma_f32 v[72:73], v[8:9], v[8:9], s[60:61]
    v_pk_fma_f32 v[74:75], v[10:11], v[10:11], s[60:61]
    v_pk_fma_f32 v[76:77], v[12:13], v[12:13], s[60:61]
    v_pk_fma_f32 v[78:79], v[14:15], v[14:15], s[60:61]
    v_pk_fma_f32 v[80:81], v[16:17], v[16:17], s[60:61]
    v_pk_fma_f32 v[82:83], v[18:19], v[18:19], s[60:61]
    v_pk_fma_f32 v[84:85], v[20:21], v[20:21], s[60:61]
    v_pk_fma_f32 v[86:87], v[22:23], v[22:23], s[60:61]
    v_pk_mul_f32 v[72:73], v[8:9], v[72:73] neg_lo:[1,0] neg_hi:[1,0]
    v_pk_mul_f32 v[74:75], v[10:11], v[74:75] neg_lo:[1,0] neg_hi:[1,0]
    v_pk_mul_f32 v[76:77], v[12:13], v[76:77] neg_lo:[1,0] neg_hi:[1,0]
    v_pk_mul_f32 v[78:79], v[14:15], v[78:79] neg_lo:[1,0] neg_hi:[1,0]
    v_pk_mul_f32 v[80:81], v[16:17], v[80:81] neg_lo:[1,0] neg_hi:[1,0]
    v_pk_mul_f32 v[82:83], v[18:19], v[82:83] neg_lo:[1,0] neg_hi:[1,0]
    v_pk_mul_f32 v[84:85], v[20:21], v[84:85] neg_lo:[1,0] neg_hi:[1,0]
    v_pk_mul_f32 v[86:87], v[22:23], v[86:87] neg_lo:[1,0] neg_hi:[1,0]
    s_setprio 1
    s_nop 0
    ds_read_b128 v[24:27], v240 offset:128
    ds_read_b128 v[28:31], v240 offset:160
    ds_read_b128 v[32:35], v240 offset:192
    ds_read_b128 v[36:39], v240 offset:224
    ds_read_b64_tr_b16 v[184:185], v232 offset:12352
    ds_read_b64_tr_b16 v[186:187], v232 offset:12864
    ds_read_b64_tr_b16 v[188:189], v232 offset:13376
    ds_read_b64_tr_b16 v[190:191], v232 offset:13888
    ds_read_b64_tr_b16 v[192:193], v232 offset:14400
    ds_read_b64_tr_b16 v[194:195], v232 offset:14912
    ds_read_b64_tr_b16 v[196:197], v232 offset:15424
    ds_read_b64_tr_b16 v[198:199], v232 offset:15936
    ds_read_b64_tr_b16 v[200:201], v232 offset:16448
    ds_read_b64_tr_b16 v[202:203], v232 offset:16960
    ds_read_b64_tr_b16 v[204:205], v232 offset:17472
    ds_read_b64_tr_b16 v[206:207], v232 offset:17984
    s_mov_b32 exec_hi, 0xffff
    s_add_u32 m0, s57, 61760
    s_movk_i32 s59, 320
    buffer_load_dwordx4 v236, s[28:31], s59 offen lds
    s_add_u32 m0, s58, 24704
    s_mov_b32 s59, 12288
    buffer_load_dwordx4 v242, s[32:35], s59 offen lds
    s_add_u32 m0, s57, 74112
    s_movk_i32 s59, 384
    buffer_load_dwordx4 v236, s[28:31], s59 offen lds
    s_mov_b32 exec_hi, -1
    s_waitcnt lgkmcnt(0)
    v_mfma_f32_32x32x16_bf16 v[24:39], v[184:187], v[160:163], v[24:39]
    v_exp_f32 v72, v72
    v_exp_f32 v73, v73
    v_exp_f32 v74, v74
    v_mfma_f32_32x32x16_bf16 v[24:39], v[188:191], v[164:167], v[24:39]
    v_exp_f32 v75, v75
    v_exp_f32 v76, v76
    s_setprio 0
    v_mfma_f32_32x32x16_bf16 v[24:39], v[192:195], v[168:171], v[24:39]
    v_exp_f32 v77, v77
    v_exp_f32 v78, v78
    v_exp_f32 v79, v79
    v_mfma_f32_32x32x16_bf16 v[24:39], v[196:199], v[172:175], v[24:39]
    v_exp_f32 v80, v80
    v_exp_f32 v81, v81
    v_exp_f32 v82, v82
    v_mfma_f32_32x32x16_bf16 v[24:39], v[200:203], v[176:179], v[24:39]
    v_exp_f32 v83, v83
    v_exp_f32 v84, v84
    v_mfma_f32_32x32x16_bf16 v[24:39], v[204:207], v[180:183], v[24:39]
    v_exp_f32 v85, v85
    v_exp_f32 v86, v86
    v_exp_f32_e64 v87, v87
    s_nop 1
    s_setprio 3
    v_pk_add_f32 v[72:73], v[72:73], s[62:63]
    v_pk_add_f32 v[74:75], v[74:75], s[62:63]
    v_pk_add_f32 v[76:77], v[76:77], s[62:63]
    v_pk_add_f32 v[78:79], v[78:79], s[62:63]
    v_pk_add_f32 v[80:81], v[80:81], s[62:63]
    v_pk_add_f32 v[82:83], v[82:83], s[62:63]
    v_pk_add_f32 v[84:85], v[84:85], s[62:63]
    v_pk_add_f32 v[86:87], v[86:87], s[62:63]
    v_pk_fma_f32 v[88:89], v[24:25], v[24:25], s[60:61]
    v_pk_fma_f32 v[90:91], v[26:27], v[26:27], s[60:61]
    v_pk_fma_f32 v[92:93], v[28:29], v[28:29], s[60:61]
    v_pk_fma_f32 v[94:95], v[30:31], v[30:31], s[60:61]
    v_pk_fma_f32 v[96:97], v[32:33], v[32:33], s[60:61]
    v_pk_fma_f32 v[98:99], v[34:35], v[34:35], s[60:61]
    v_pk_fma_f32 v[100:101], v[36:37], v[36:37], s[60:61]
    v_pk_fma_f32 v[102:103], v[38:39], v[38:39], s[60:61]
    v_pk_mul_f32 v[88:89], v[24:25], v[88:89] neg_lo:[1,0] neg_hi:[1,0]
    v_pk_mul_f32 v[90:91], v[26:27], v[90:91] neg_lo:[1,0] neg_hi:[1,0]
    v_pk_mul_f32 v[92:93], v[28:29], v[92:93] neg_lo:[1,0] neg_hi:[1,0]
    v_pk_mul_f32 v[94:95], v[30:31], v[94:95] neg_lo:[1,0] neg_hi:[1,0]
    v_pk_mul_f32 v[96:97], v[32:33], v[96:97] neg_lo:[1,0] neg_hi:[1,0]
    v_pk_mul_f32 v[98:99], v[34:35], v[98:99] neg_lo:[1,0] neg_hi:[1,0]
    v_pk_mul_f32 v[100:101], v[36:37], v[100:101] neg_lo:[1,0] neg_hi:[1,0]
    v_pk_mul_f32 v[102:103], v[38:39], v[102:103] neg_lo:[1,0] neg_hi:[1,0]
    s_setprio 1
    s_nop 0
    ds_read_b128 v[40:43], v240 offset:256
    ds_read_b128 v[44:47], v240 offset:288
    ds_read_b128 v[48:51], v240 offset:320
    ds_read_b128 v[52:55], v240 offset:352
    ds_read_b64_tr_b16 v[184:185], v232 offset:24704
    ds_read_b64_tr_b16 v[186:187], v232 offset:25216
    ds_read_b64_tr_b16 v[188:189], v232 offset:25728
    ds_read_b64_tr_b16 v[190:191], v232 offset:26240
    ds_read_b64_tr_b16 v[192:193], v232 offset:26752
    ds_read_b64_tr_b16 v[194:195], v232 offset:27264
    ds_read_b64_tr_b16 v[196:197], v232 offset:27776
    ds_read_b64_tr_b16 v[198:199], v232 offset:28288
    ds_read_b64_tr_b16 v[200:201], v232 offset:28800
    ds_read_b64_tr_b16 v[202:203], v232 offset:29312
    ds_read_b64_tr_b16 v[204:205], v232 offset:29824
    ds_read_b64_tr_b16 v[206:207], v232 offset:30336
    ds_read_b128 v[112:115], v241 offset:0
    ds_read_b128 v[116:119], v241 offset:16
    ds_read_b128 v[120:123], v241 offset:64
    ds_read_b128 v[124:127], v241 offset:80
    ds_read_b128 v[128:131], v241 offset:128
    ds_read_b128 v[132:135], v241 offset:144
    ds_read_b128 v[136:139], v241 offset:192
    ds_read_b128 v[140:143], v241 offset:208
    ds_read_b128 v[144:147], v241 offset:256
    ds_read_b128 v[148:151], v241 offset:272
    ds_read_b128 v[152:155], v241 offset:320
    ds_read_b128 v[156:159], v241 offset:336
    s_mov_b32 exec_hi, 0xffff
    s_add_u32 m0, s58, 37056
    s_mov_b32 s59, 18432
    buffer_load_dwordx4 v242, s[32:35], s59 offen lds
    s_add_u32 m0, s57, 86464
    s_movk_i32 s59, 448
    buffer_load_dwordx4 v236, s[28:31], s59 offen lds
    s_add_u32 m0, s58, 49408
    s_mov_b32 s59, 24576
    buffer_load_dwordx4 v242, s[32:35], s59 offen lds
    s_mov_b32 exec_hi, -1
    s_waitcnt lgkmcnt(12)
    v_mfma_f32_32x32x16_bf16 v[40:55], v[184:187], v[160:163], v[40:55]
    v_rcp_f32 v72, v72
    v_rcp_f32 v73, v73
    v_rcp_f32 v74, v74
    v_rcp_f32 v75, v75
    v_rcp_f32 v76, v76
    v_mfma_f32_32x32x16_bf16 v[40:55], v[188:191], v[164:167], v[40:55]
    v_rcp_f32 v77, v77
    v_rcp_f32 v78, v78
    v_rcp_f32 v79, v79
    v_rcp_f32 v80, v80
    v_rcp_f32 v81, v81
    v_rcp_f32 v82, v82
    s_setprio 0
    v_mfma_f32_32x32x16_bf16 v[40:55], v[192:195], v[168:171], v[40:55]
    v_rcp_f32 v83, v83
    v_rcp_f32 v84, v84
    v_rcp_f32 v85, v85
    v_rcp_f32 v86, v86
    v_rcp_f32 v87, v87
    v_mfma_f32_32x32x16_bf16 v[40:55], v[196:199], v[172:175], v[40:55]
    v_exp_f32 v88, v88
    v_exp_f32 v89, v89
    v_exp_f32 v90, v90
    v_exp_f32 v91, v91
    v_exp_f32 v92, v92
    v_mfma_f32_32x32x16_bf16 v[40:55], v[200:203], v[176:179], v[40:55]
    v_exp_f32 v93, v93
    v_exp_f32 v94, v94
    v_exp_f32 v95, v95
    v_exp_f32 v96, v96
    v_exp_f32 v97, v97
    v_exp_f32 v98, v98
    v_mfma_f32_32x32x16_bf16 v[40:55], v[204:207], v[180:183], v[40:55]
    v_exp_f32 v99, v99
    v_exp_f32 v100, v100
    v_exp_f32 v101, v101
    v_exp_f32 v102, v102
    v_exp_f32_e64 v103, v103
    s_setprio 3
    v_pk_mul_f32 v[8:9], v[8:9], v[72:73]
    v_pk_mul_f32 v[10:11], v[10:11], v[74:75]
    v_pk_mul_f32 v[12:13], v[12:13], v[76:77]
    v_pk_mul_f32 v[14:15], v[14:15], v[78:79]
    v_pk_mul_f32 v[16:17], v[16:17], v[80:81]
    v_pk_mul_f32 v[18:19], v[18:19], v[82:83]
    v_pk_mul_f32 v[20:21], v[20:21], v[84:85]
    v_pk_mul_f32 v[22:23], v[22:23], v[86:87]
    v_pk_add_f32 v[88:89], v[88:89], s[62:63]
    v_pk_add_f32 v[90:91], v[90:91], s[62:63]
    v_pk_add_f32 v[92:93], v[92:93], s[62:63]
    v_pk_add_f32 v[94:95], v[94:95], s[62:63]
    v_pk_add_f32 v[96:97], v[96:97], s[62:63]
    v_pk_add_f32 v[98:99], v[98:99], s[62:63]
    v_pk_add_f32 v[100:101], v[100:101], s[62:63]
    v_pk_add_f32 v[102:103], v[102:103], s[62:63]
    v_pk_fma_f32 v[72:73], v[40:41], v[40:41], s[60:61]
    v_pk_fma_f32 v[74:75], v[42:43], v[42:43], s[60:61]
    v_pk_fma_f32 v[76:77], v[44:45], v[44:45], s[60:61]
    v_pk_fma_f32 v[78:79], v[46:47], v[46:47], s[60:61]
    v_pk_fma_f32 v[80:81], v[48:49], v[48:49], s[60:61]
    v_pk_fma_f32 v[82:83], v[50:51], v[50:51], s[60:61]
    v_pk_fma_f32 v[84:85], v[52:53], v[52:53], s[60:61]
    v_pk_fma_f32 v[86:87], v[54:55], v[54:55], s[60:61]
    v_pk_mul_f32 v[72:73], v[40:41], v[72:73] neg_lo:[1,0] neg_hi:[1,0]
    v_pk_mul_f32 v[74:75], v[42:43], v[74:75] neg_lo:[1,0] neg_hi:[1,0]
    v_pk_mul_f32 v[76:77], v[44:45], v[76:77] neg_lo:[1,0] neg_hi:[1,0]
    v_pk_mul_f32 v[78:79], v[46:47], v[78:79] neg_lo:[1,0] neg_hi:[1,0]
    v_pk_mul_f32 v[80:81], v[48:49], v[80:81] neg_lo:[1,0] neg_hi:[1,0]
    v_pk_mul_f32 v[82:83], v[50:51], v[82:83] neg_lo:[1,0] neg_hi:[1,0]
    v_pk_mul_f32 v[84:85], v[52:53], v[84:85] neg_lo:[1,0] neg_hi:[1,0]
    v_pk_mul_f32 v[86:87], v[54:55], v[86:87] neg_lo:[1,0] neg_hi:[1,0]
    s_setprio 1
    s_nop 0
    ds_read_b128 v[56:59], v240 offset:384
    ds_read_b128 v[60:63], v240 offset:416
    ds_read_b128 v[64:67], v240 offset:448
    ds_read_b128 v[68:71], v240 offset:480
    ds_read_b64_tr_b16 v[184:185], v232 offset:37056
    ds_read_b64_tr_b16 v[186:187], v232 offset:37568
    ds_read_b64_tr_b16 v[188:189], v232 offset:38080
    ds_read_b64_tr_b16 v[190:191], v232 offset:38592
    ds_read_b64_tr_b16 v[192:193], v232 offset:39104
    ds_read_b64_tr_b16 v[194:195], v232 offset:39616
    ds_read_b64_tr_b16 v[196:197], v232 offset:40128
    ds_read_b64_tr_b16 v[198:199], v232 offset:40640
    ds_read_b64_tr_b16 v[200:201], v232 offset:41152
    ds_read_b64_tr_b16 v[202:203], v232 offset:41664
    ds_read_b64_tr_b16 v[204:205], v232 offset:42176
    ds_read_b64_tr_b16 v[206:207], v232 offset:42688
    ds_read_b64_tr_b16 v[208:209], v233 offset:0
    ds_read_b64_tr_b16 v[210:211], v233 offset:1552
    ds_read_b64_tr_b16 v[212:213], v233 offset:64
    ds_read_b64_tr_b16 v[214:215], v233 offset:1616
    ds_read_b64_tr_b16 v[216:217], v233 offset:128
    ds_read_b64_tr_b16 v[218:219], v233 offset:1680
    ds_read_b64_tr_b16 v[220:221], v233 offset:3104
    ds_read_b64_tr_b16 v[222:223], v233 offset:4656
    ds_read_b64_tr_b16 v[224:225], v233 offset:3168
    ds_read_b64_tr_b16 v[226:227], v233 offset:4720
    ds_read_b64_tr_b16 v[228:229], v233 offset:3232
    ds_read_b64_tr_b16 v[230:231], v233 offset:4784
    s_waitcnt vmcnt(0)
    v_mov_b32 v4, 5
    ds_write_b32 v244, v4
    s_mov_b32 exec_hi, 0xffff
    s_add_u32 m0, s57, 98816
    s_movk_i32 s59, 512
    buffer_load_dwordx4 v236, s[28:31], s59 offen lds
    s_add_u32 m0, s58, 61760
    s_mov_b32 s59, 30720
    buffer_load_dwordx4 v242, s[32:35], s59 offen lds
    s_mov_b32 exec_hi, -1
    s_waitcnt lgkmcnt(13)
    v_mfma_f32_32x32x16_bf16 v[56:71], v[184:187], v[160:163], v[56:71]
    v_cvt_pk_bf16_f32 v104, v8, v9
    v_cvt_pk_bf16_f32 v105, v10, v11
    v_rcp_f32 v88, v88
    v_rcp_f32 v89, v89
    v_mfma_f32_32x32x16_bf16 v[56:71], v[188:191], v[164:167], v[56:71]
    v_cvt_pk_bf16_f32 v106, v12, v13
    v_cvt_pk_bf16_f32 v107, v14, v15
    v_rcp_f32 v90, v90
    v_rcp_f32 v91, v91
    s_setprio 0
    v_mfma_f32_32x32x16_bf16 v[56:71], v[192:195], v[168:171], v[56:71]
    v_cvt_pk_bf16_f32 v108, v16, v17
    v_cvt_pk_bf16_f32 v109, v18, v19
    v_rcp_f32 v92, v92
    v_rcp_f32 v93, v93
    v_mfma_f32_32x32x16_bf16 v[56:71], v[196:199], v[172:175], v[56:71]
    v_cvt_pk_bf16_f32 v110, v20, v21
    v_cvt_pk_bf16_f32 v111, v22, v23
    v_rcp_f32 v94, v94
    v_rcp_f32 v95, v95
    v_mfma_f32_32x32x16_bf16 v[56:71], v[200:203], v[176:179], v[56:71]
    v_rcp_f32 v96, v96
    v_rcp_f32 v97, v97
    v_rcp_f32 v98, v98
    v_mfma_f32_32x32x16_bf16 v[56:71], v[204:207], v[180:183], v[56:71]
    v_rcp_f32 v99, v99
    v_rcp_f32 v100, v100
    v_rcp_f32 v101, v101
    s_waitcnt lgkmcnt(0)
    v_mfma_f32_32x32x16_bf16 v[112:127], v[208:211], v[104:107], v[112:127]
    v_rcp_f32 v102, v102
    v_rcp_f32 v103, v103
    v_exp_f32 v72, v72
    v_mfma_f32_32x32x16_bf16 v[128:143], v[212:215], v[104:107], v[128:143]
    v_exp_f32 v73, v73
    v_exp_f32 v74, v74
    v_exp_f32 v75, v75
    v_mfma_f32_32x32x16_bf16 v[144:159], v[216:219], v[104:107], v[144:159]
    v_exp_f32 v76, v76
    v_exp_f32 v77, v77
    v_exp_f32 v78, v78
    v_mfma_f32_32x32x16_bf16 v[112:127], v[220:223], v[108:111], v[112:127]
    v_exp_f32 v79, v79
    v_exp_f32 v80, v80
    v_exp_f32 v81, v81
    v_mfma_f32_32x32x16_bf16 v[128:143], v[224:227], v[108:111], v[128:143]
    v_exp_f32 v82, v82
    v_exp_f32 v83, v83
    v_exp_f32 v84, v84
    v_mfma_f32_32x32x16_bf16 v[144:159], v[228:231], v[108:111], v[144:159]
    v_exp_f32 v85, v85
    v_exp_f32 v86, v86
    v_exp_f32 v87, v87
    s_setprio 3
    v_pk_mul_f32 v[24:25], v[24:25], v[88:89]
    v_pk_mul_f32 v[26:27], v[26:27], v[90:91]
    v_pk_mul_f32 v[28:29], v[28:29], v[92:93]
    v_pk_mul_f32 v[30:31], v[30:31], v[94:95]
    v_pk_mul_f32 v[32:33], v[32:33], v[96:97]
    v_pk_mul_f32 v[34:35], v[34:35], v[98:99]
    v_pk_mul_f32 v[36:37], v[36:37], v[100:101]
    v_pk_mul_f32 v[38:39], v[38:39], v[102:103]
    v_pk_add_f32 v[72:73], v[72:73], s[62:63]
    v_pk_add_f32 v[74:75], v[74:75], s[62:63]
    v_pk_add_f32 v[76:77], v[76:77], s[62:63]
    v_pk_add_f32 v[78:79], v[78:79], s[62:63]
    v_pk_add_f32 v[80:81], v[80:81], s[62:63]
    v_pk_add_f32 v[82:83], v[82:83], s[62:63]
    v_pk_add_f32 v[84:85], v[84:85], s[62:63]
    v_pk_add_f32 v[86:87], v[86:87], s[62:63]
    v_pk_fma_f32 v[88:89], v[56:57], v[56:57], s[60:61]
    v_pk_fma_f32 v[90:91], v[58:59], v[58:59], s[60:61]
    v_pk_fma_f32 v[92:93], v[60:61], v[60:61], s[60:61]
    v_pk_fma_f32 v[94:95], v[62:63], v[62:63], s[60:61]
    v_pk_fma_f32 v[96:97], v[64:65], v[64:65], s[60:61]
    v_pk_fma_f32 v[98:99], v[66:67], v[66:67], s[60:61]
    v_pk_fma_f32 v[100:101], v[68:69], v[68:69], s[60:61]
    v_pk_fma_f32 v[102:103], v[70:71], v[70:71], s[60:61]
    v_pk_mul_f32 v[88:89], v[56:57], v[88:89] neg_lo:[1,0] neg_hi:[1,0]
    v_pk_mul_f32 v[90:91], v[58:59], v[90:91] neg_lo:[1,0] neg_hi:[1,0]
    v_pk_mul_f32 v[92:93], v[60:61], v[92:93] neg_lo:[1,0] neg_hi:[1,0]
    v_pk_mul_f32 v[94:95], v[62:63], v[94:95] neg_lo:[1,0] neg_hi:[1,0]
    v_pk_mul_f32 v[96:97], v[64:65], v[96:97] neg_lo:[1,0] neg_hi:[1,0]
    v_pk_mul_f32 v[98:99], v[66:67], v[98:99] neg_lo:[1,0] neg_hi:[1,0]
    v_pk_mul_f32 v[100:101], v[68:69], v[100:101] neg_lo:[1,0] neg_hi:[1,0]
    v_pk_mul_f32 v[102:103], v[70:71], v[102:103] neg_lo:[1,0] neg_hi:[1,0]
    s_setprio 2
    s_nop 0
    ds_read_b128 v[8:11], v240 offset:512
    ds_read_b128 v[12:15], v240 offset:544
    ds_read_b128 v[16:19], v240 offset:576
    ds_read_b128 v[20:23], v240 offset:608
    ds_read_b64_tr_b16 v[184:185], v232 offset:49408
    ds_read_b64_tr_b16 v[186:187], v232 offset:49920
    ds_read_b64_tr_b16 v[188:189], v232 offset:50432
    ds_read_b64_tr_b16 v[190:191], v232 offset:50944
    ds_read_b64_tr_b16 v[192:193], v232 offset:51456
    ds_read_b64_tr_b16 v[194:195], v232 offset:51968
    ds_read_b64_tr_b16 v[196:197], v232 offset:52480
    ds_read_b64_tr_b16 v[198:199], v232 offset:52992
    ds_read_b64_tr_b16 v[200:201], v232 offset:53504
    ds_read_b64_tr_b16 v[202:203], v232 offset:54016
    ds_read_b64_tr_b16 v[204:205], v232 offset:54528
    ds_read_b64_tr_b16 v[206:207], v232 offset:55040
    ds_read_b64_tr_b16 v[208:209], v233 offset:12352
    ds_read_b64_tr_b16 v[210:211], v233 offset:13904
    ds_read_b64_tr_b16 v[212:213], v233 offset:12416
    ds_read_b64_tr_b16 v[214:215], v233 offset:13968
    ds_read_b64_tr_b16 v[216:217], v233 offset:12480
    ds_read_b64_tr_b16 v[218:219], v233 offset:14032
    ds_read_b64_tr_b16 v[220:221], v233 offset:15456
    ds_read_b64_tr_b16 v[222:223], v233 offset:17008
    ds_read_b64_tr_b16 v[224:225], v233 offset:15520
    ds_read_b64_tr_b16 v[226:227], v233 offset:17072
    ds_read_b64_tr_b16 v[228:229], v233 offset:15584
    ds_read_b64_tr_b16 v[230:231], v233 offset:17136
    ds_read_b32 v5, v245
    s_mov_b32 exec_hi, 0xffff
    s_add_u32 m0, s57, 111168
    s_movk_i32 s59, 576
    buffer_load_dwordx4 v236, s[28:31], s59 offen lds
    s_add_u32 m0, s58, 74112
    s_mov_b32 s59, 36864
    buffer_load_dwordx4 v242, s[32:35], s59 offen lds
    s_mov_b32 exec_hi, -1
    s_waitcnt lgkmcnt(13)
    v_mfma_f32_32x32x16_bf16 v[8:23], v[184:187], v[160:163], v[8:23]
    v_cvt_pk_bf16_f32 v104, v24, v25
    v_cvt_pk_bf16_f32 v105, v26, v27
    v_rcp_f32 v72, v72
    v_rcp_f32 v73, v73
    v_mfma_f32_32x32x16_bf16 v[8:23], v[188:191], v[164:167], v[8:23]
    v_cvt_pk_bf16_f32 v106, v28, v29
    v_cvt_pk_bf16_f32 v107, v30, v31
    v_rcp_f32 v74, v74
    v_rcp_f32 v75, v75
    s_setprio 0
    v_mfma_f32_32x32x16_bf16 v[8:23], v[192:195], v[168:171], v[8:23]
    v_cvt_pk_bf16_f32 v108, v32, v33
    v_cvt_pk_bf16_f32 v109, v34, v35
    v_rcp_f32 v76, v76
    v_rcp_f32 v77, v77
    v_mfma_f32_32x32x16_bf16 v[8:23], v[196:199], v[172:175], v[8:23]
    v_cvt_pk_bf16_f32 v110, v36, v37
    v_cvt_pk_bf16_f32 v111, v38, v39
    v_rcp_f32 v78, v78
    v_rcp_f32 v79, v79
    v_mfma_f32_32x32x16_bf16 v[8:23], v[200:203], v[176:179], v[8:23]
    v_rcp_f32 v80, v80
    v_rcp_f32 v81, v81
    v_rcp_f32 v82, v82
    v_mfma_f32_32x32x16_bf16 v[8:23], v[204:207], v[180:183], v[8:23]
    v_rcp_f32 v83, v83
    v_rcp_f32 v84, v84
    v_rcp_f32 v85, v85
    s_waitcnt lgkmcnt(0)
    v_mfma_f32_32x32x16_bf16 v[112:127], v[208:211], v[104:107], v[112:127]
    v_rcp_f32 v86, v86
    v_rcp_f32 v87, v87
    v_exp_f32 v88, v88
    v_mfma_f32_32x32x16_bf16 v[128:143], v[212:215], v[104:107], v[128:143]
    v_exp_f32 v89, v89
    v_exp_f32 v90, v90
    v_exp_f32 v91, v91
    v_mfma_f32_32x32x16_bf16 v[144:159], v[216:219], v[104:107], v[144:159]
    v_exp_f32 v92, v92
    v_exp_f32 v93, v93
    v_exp_f32 v94, v94
    v_mfma_f32_32x32x16_bf16 v[112:127], v[220:223], v[108:111], v[112:127]
    v_exp_f32 v95, v95
    v_exp_f32 v96, v96
    v_exp_f32 v97, v97
    v_mfma_f32_32x32x16_bf16 v[128:143], v[224:227], v[108:111], v[128:143]
    v_exp_f32 v98, v98
    v_exp_f32 v99, v99
    v_exp_f32 v100, v100
    v_mfma_f32_32x32x16_bf16 v[144:159], v[228:231], v[108:111], v[144:159]
    v_exp_f32 v101, v101
    v_exp_f32 v102, v102
    v_exp_f32 v103, v103
    s_setprio 3
    v_pk_mul_f32 v[40:41], v[40:41], v[72:73]
    v_pk_mul_f32 v[42:43], v[42:43], v[74:75]
    v_pk_mul_f32 v[44:45], v[44:45], v[76:77]
    v_pk_mul_f32 v[46:47], v[46:47], v[78:79]
    v_pk_mul_f32 v[48:49], v[48:49], v[80:81]
    v_pk_mul_f32 v[50:51], v[50:51], v[82:83]
    v_pk_mul_f32 v[52:53], v[52:53], v[84:85]
    v_pk_mul_f32 v[54:55], v[54:55], v[86:87]
    v_pk_add_f32 v[88:89], v[88:89], s[62:63]
    v_pk_add_f32 v[90:91], v[90:91], s[62:63]
    v_pk_add_f32 v[92:93], v[92:93], s[62:63]
    v_pk_add_f32 v[94:95], v[94:95], s[62:63]
    v_pk_add_f32 v[96:97], v[96:97], s[62:63]
    v_pk_add_f32 v[98:99], v[98:99], s[62:63]
    v_pk_add_f32 v[100:101], v[100:101], s[62:63]
    v_pk_add_f32 v[102:103], v[102:103], s[62:63]
    v_pk_fma_f32 v[72:73], v[8:9], v[8:9], s[60:61]
    v_pk_fma_f32 v[74:75], v[10:11], v[10:11], s[60:61]
    v_pk_fma_f32 v[76:77], v[12:13], v[12:13], s[60:61]
    v_pk_fma_f32 v[78:79], v[14:15], v[14:15], s[60:61]
    v_pk_fma_f32 v[80:81], v[16:17], v[16:17], s[60:61]
    v_pk_fma_f32 v[82:83], v[18:19], v[18:19], s[60:61]
    v_pk_fma_f32 v[84:85], v[20:21], v[20:21], s[60:61]
    v_pk_fma_f32 v[86:87], v[22:23], v[22:23], s[60:61]
    v_pk_mul_f32 v[72:73], v[8:9], v[72:73] neg_lo:[1,0] neg_hi:[1,0]
    v_pk_mul_f32 v[74:75], v[10:11], v[74:75] neg_lo:[1,0] neg_hi:[1,0]
    v_pk_mul_f32 v[76:77], v[12:13], v[76:77] neg_lo:[1,0] neg_hi:[1,0]
    v_pk_mul_f32 v[78:79], v[14:15], v[78:79] neg_lo:[1,0] neg_hi:[1,0]
    v_pk_mul_f32 v[80:81], v[16:17], v[80:81] neg_lo:[1,0] neg_hi:[1,0]
    v_pk_mul_f32 v[82:83], v[18:19], v[82:83] neg_lo:[1,0] neg_hi:[1,0]
    v_pk_mul_f32 v[84:85], v[20:21], v[84:85] neg_lo:[1,0] neg_hi:[1,0]
    v_pk_mul_f32 v[86:87], v[22:23], v[86:87] neg_lo:[1,0] neg_hi:[1,0]
    s_setprio 2
    v_cmp_le_u32 vcc, 5, v5
    s_cmp_eq_u64 vcc, -1
    s_cbranch_scc1 L_gate_W_3_ok
L_gate_W_3:
    ds_read_b32 v5, v245
    s_waitcnt lgkmcnt(0)
    v_cmp_le_u32 vcc, 5, v5
    s_cmp_eq_u64 vcc, -1
    s_cbranch_scc0 L_gate_W_3
L_gate_W_3_ok:
    v_add_u32 v232, 61760, v232
    ds_read_b128 v[24:27], v240 offset:640
    ds_read_b128 v[28:31], v240 offset:672
    ds_read_b128 v[32:35], v240 offset:704
    ds_read_b128 v[36:39], v240 offset:736
    ds_read_b64_tr_b16 v[184:185], v232 offset:0
    ds_read_b64_tr_b16 v[186:187], v232 offset:512
    ds_read_b64_tr_b16 v[188:189], v232 offset:1024
    ds_read_b64_tr_b16 v[190:191], v232 offset:1536
    ds_read_b64_tr_b16 v[192:193], v232 offset:2048
    ds_read_b64_tr_b16 v[194:195], v232 offset:2560
    ds_read_b64_tr_b16 v[196:197], v232 offset:3072
    ds_read_b64_tr_b16 v[198:199], v232 offset:3584
    ds_read_b64_tr_b16 v[200:201], v232 offset:4096
    ds_read_b64_tr_b16 v[202:203], v232 offset:4608
    ds_read_b64_tr_b16 v[204:205], v232 offset:5120
    ds_read_b64_tr_b16 v[206:207], v232 offset:5632
    ds_read_b64_tr_b16 v[208:209], v233 offset:24704
    ds_read_b64_tr_b16 v[210:211], v233 offset:26256
    ds_read_b64_tr_b16 v[212:213], v233 offset:24768
    ds_read_b64_tr_b16 v[214:215], v233 offset:26320
    ds_read_b64_tr_b16 v[216:217], v233 offset:24832
    ds_read_b64_tr_b16 v[218:219], v233 offset:26384
    ds_read_b64_tr_b16 v[220:221], v233 offset:27808
    ds_read_b64_tr_b16 v[222:223], v233 offset:29360
    ds_read_b64_tr_b16 v[224:225], v233 offset:27872
    ds_read_b64_tr_b16 v[226:227], v233 offset:29424
    ds_read_b64_tr_b16 v[228:229], v233 offset:27936
    ds_read_b64_tr_b16 v[230:231], v233 offset:29488
    s_mov_b32 exec_hi, 0xffff
    s_add_u32 m0, s57, 123520
    s_movk_i32 s59, 640
    buffer_load_dwordx4 v236, s[28:31], s59 offen lds
    s_add_u32 m0, s58, 86464
    s_mov_b32 s59, 43008
    buffer_load_dwordx4 v242, s[32:35], s59 offen lds
    s_mov_b32 exec_hi, -1
    s_waitcnt lgkmcnt(12)
    v_mfma_f32_32x32x16_bf16 v[24:39], v[184:187], v[160:163], v[24:39]
    v_cvt_pk_bf16_f32 v104, v40, v41
    v_cvt_pk_bf16_f32 v105, v42, v43
    v_rcp_f32 v88, v88
    v_rcp_f32 v89, v89
    v_mfma_f32_32x32x16_bf16 v[24:39], v[188:191], v[164:167], v[24:39]
    v_cvt_pk_bf16_f32 v106, v44, v45
    v_cvt_pk_bf16_f32 v107, v46, v47
    v_rcp_f32 v90, v90
    v_rcp_f32 v91, v91
    s_setprio 0
    v_mfma_f32_32x32x16_bf16 v[24:39], v[192:195], v[168:171], v[24:39]
    v_cvt_pk_bf16_f32 v108, v48, v49
    v_cvt_pk_bf16_f32 v109, v50, v51
    v_rcp_f32 v92, v92
    v_rcp_f32 v93, v93
    v_mfma_f32_32x32x16_bf16 v[24:39], v[196:199], v[172:175], v[24:39]
    v_cvt_pk_bf16_f32 v110, v52, v53
    v_cvt_pk_bf16_f32 v111, v54, v55
    v_rcp_f32 v94, v94
    v_rcp_f32 v95, v95
    v_mfma_f32_32x32x16_bf16 v[24:39], v[200:203], v[176:179], v[24:39]
    v_rcp_f32 v96, v96
    v_rcp_f32 v97, v97
    v_rcp_f32 v98, v98
    v_mfma_f32_32x32x16_bf16 v[24:39], v[204:207], v[180:183], v[24:39]
    v_rcp_f32 v99, v99
    v_rcp_f32 v100, v100
    v_rcp_f32 v101, v101
    s_waitcnt lgkmcnt(0)
    v_mfma_f32_32x32x16_bf16 v[112:127], v[208:211], v[104:107], v[112:127]
    v_rcp_f32 v102, v102
    v_rcp_f32 v103, v103
    v_exp_f32 v72, v72
    v_mfma_f32_32x32x16_bf16 v[128:143], v[212:215], v[104:107], v[128:143]
    v_exp_f32 v73, v73
    v_exp_f32 v74, v74
    v_exp_f32 v75, v75
    v_mfma_f32_32x32x16_bf16 v[144:159], v[216:219], v[104:107], v[144:159]
    v_exp_f32 v76, v76
    v_exp_f32 v77, v77
    v_exp_f32 v78, v78
    v_mfma_f32_32x32x16_bf16 v[112:127], v[220:223], v[108:111], v[112:127]
    v_exp_f32 v79, v79
    v_exp_f32 v80, v80
    v_exp_f32 v81, v81
    v_mfma_f32_32x32x16_bf16 v[128:143], v[224:227], v[108:111], v[128:143]
    v_exp_f32 v82, v82
    v_exp_f32 v83, v83
    v_exp_f32 v84, v84
    v_mfma_f32_32x32x16_bf16 v[144:159], v[228:231], v[108:111], v[144:159]
    v_exp_f32 v85, v85
    v_exp_f32 v86, v86
    v_exp_f32 v87, v87
    s_setprio 3
    v_pk_mul_f32 v[56:57], v[56:57], v[88:89]
    v_pk_mul_f32 v[58:59], v[58:59], v[90:91]
    v_pk_mul_f32 v[60:61], v[60:61], v[92:93]
    v_pk_mul_f32 v[62:63], v[62:63], v[94:95]
    v_pk_mul_f32 v[64:65], v[64:65], v[96:97]
    v_pk_mul_f32 v[66:67], v[66:67], v[98:99]
    v_pk_mul_f32 v[68:69], v[68:69], v[100:101]
    v_pk_mul_f32 v[70:71], v[70:71], v[102:103]
    v_pk_add_f32 v[72:73], v[72:73], s[62:63]
    v_pk_add_f32 v[74:75], v[74:75], s[62:63]
    v_pk_add_f32 v[76:77], v[76:77], s[62:63]
    v_pk_add_f32 v[78:79], v[78:79], s[62:63]
    v_pk_add_f32 v[80:81], v[80:81], s[62:63]
    v_pk_add_f32 v[82:83], v[82:83], s[62:63]
    v_pk_add_f32 v[84:85], v[84:85], s[62:63]
    v_pk_add_f32 v[86:87], v[86:87], s[62:63]
    v_pk_fma_f32 v[88:89], v[24:25], v[24:25], s[60:61]
    v_pk_fma_f32 v[90:91], v[26:27], v[26:27], s[60:61]
    v_pk_fma_f32 v[92:93], v[28:29], v[28:29], s[60:61]
    v_pk_fma_f32 v[94:95], v[30:31], v[30:31], s[60:61]
    v_pk_fma_f32 v[96:97], v[32:33], v[32:33], s[60:61]
    v_pk_fma_f32 v[98:99], v[34:35], v[34:35], s[60:61]
    v_pk_fma_f32 v[100:101], v[36:37], v[36:37], s[60:61]
    v_pk_fma_f32 v[102:103], v[38:39], v[38:39], s[60:61]
    v_pk_mul_f32 v[88:89], v[24:25], v[88:89] neg_lo:[1,0] neg_hi:[1,0]
    v_pk_mul_f32 v[90:91], v[26:27], v[90:91] neg_lo:[1,0] neg_hi:[1,0]
    v_pk_mul_f32 v[92:93], v[28:29], v[92:93] neg_lo:[1,0] neg_hi:[1,0]
    v_pk_mul_f32 v[94:95], v[30:31], v[94:95] neg_lo:[1,0] neg_hi:[1,0]
    v_pk_mul_f32 v[96:97], v[32:33], v[96:97] neg_lo:[1,0] neg_hi:[1,0]
    v_pk_mul_f32 v[98:99], v[34:35], v[98:99] neg_lo:[1,0] neg_hi:[1,0]
    v_pk_mul_f32 v[100:101], v[36:37], v[100:101] neg_lo:[1,0] neg_hi:[1,0]
    v_pk_mul_f32 v[102:103], v[38:39], v[102:103] neg_lo:[1,0] neg_hi:[1,0]
    s_setprio 2
    s_nop 0
    ds_read_b128 v[40:43], v240 offset:768
    ds_read_b128 v[44:47], v240 offset:800
    ds_read_b128 v[48:51], v240 offset:832
    ds_read_b128 v[52:55], v240 offset:864
    ds_read_b64_tr_b16 v[184:185], v232 offset:12352
    ds_read_b64_tr_b16 v[186:187], v232 offset:12864
    ds_read_b64_tr_b16 v[188:189], v232 offset:13376
    ds_read_b64_tr_b16 v[190:191], v232 offset:13888
    ds_read_b64_tr_b16 v[192:193], v232 offset:14400
    ds_read_b64_tr_b16 v[194:195], v232 offset:14912
    ds_read_b64_tr_b16 v[196:197], v232 offset:15424
    ds_read_b64_tr_b16 v[198:199], v232 offset:15936
    ds_read_b64_tr_b16 v[200:201], v232 offset:16448
    ds_read_b64_tr_b16 v[202:203], v232 offset:16960
    ds_read_b64_tr_b16 v[204:205], v232 offset:17472
    ds_read_b64_tr_b16 v[206:207], v232 offset:17984
    ds_read_b64_tr_b16 v[208:209], v233 offset:37056
    ds_read_b64_tr_b16 v[210:211], v233 offset:38608
    ds_read_b64_tr_b16 v[212:213], v233 offset:37120
    ds_read_b64_tr_b16 v[214:215], v233 offset:38672
    ds_read_b64_tr_b16 v[216:217], v233 offset:37184
    ds_read_b64_tr_b16 v[218:219], v233 offset:38736
    ds_read_b64_tr_b16 v[220:221], v233 offset:40160
    ds_read_b64_tr_b16 v[222:223], v233 offset:41712
    ds_read_b64_tr_b16 v[224:225], v233 offset:40224
    ds_read_b64_tr_b16 v[226:227], v233 offset:41776
    ds_read_b64_tr_b16 v[228:229], v233 offset:40288
    ds_read_b64_tr_b16 v[230:231], v233 offset:41840
    s_waitcnt vmcnt(0)
    v_mov_b32 v4, 6
    ds_write_b32 v244, v4
    s_mov_b32 exec_hi, 0xffff
    s_add_u32 m0, s57, 135872
    s_movk_i32 s59, 704
    buffer_load_dwordx4 v236, s[28:31], s59 offen lds
    s_add_u32 m0, s58, 98816
    s_mov_b32 s59, 49152
    buffer_load_dwordx4 v242, s[32:35], s59 offen lds
    s_mov_b32 exec_hi, -1
    buffer_load_dwordx4 v[248:251], v1, s[96:99], 0 offen offset:2048
    buffer_load_dwordx4 v[252:255], v1, s[96:99], 0 offen offset:3072
    s_waitcnt lgkmcnt(13)
    v_mfma_f32_32x32x16_bf16 v[40:55], v[184:187], v[160:163], v[40:55]
    v_cvt_pk_bf16_f32 v104, v56, v57
    v_cvt_pk_bf16_f32 v105, v58, v59
    v_rcp_f32 v72, v72
    v_rcp_f32 v73, v73
    v_mfma_f32_32x32x16_bf16 v[40:55], v[188:191], v[164:167], v[40:55]
    v_cvt_pk_bf16_f32 v106, v60, v61
    v_cvt_pk_bf16_f32 v107, v62, v63
    v_rcp_f32 v74, v74
    v_rcp_f32 v75, v75
    s_setprio 0
    v_mfma_f32_32x32x16_bf16 v[40:55], v[192:195], v[168:171], v[40:55]
    v_cvt_pk_bf16_f32 v108, v64, v65
    v_cvt_pk_bf16_f32 v109, v66, v67
    v_rcp_f32 v76, v76
    v_rcp_f32 v77, v77
    v_mfma_f32_32x32x16_bf16 v[40:55], v[196:199], v[172:175], v[40:55]
    v_cvt_pk_bf16_f32 v110, v68, v69
    v_cvt_pk_bf16_f32 v111, v70, v71
    v_rcp_f32 v78, v78
    v_rcp_f32 v79, v79
    v_mfma_f32_32x32x16_bf16 v[40:55], v[200:203], v[176:179], v[40:55]
    v_rcp_f32 v80, v80
    v_rcp_f32 v81, v81
    v_rcp_f32 v82, v82
    v_mfma_f32_32x32x16_bf16 v[40:55], v[204:207], v[180:183], v[40:55]
    v_rcp_f32 v83, v83
    v_rcp_f32 v84, v84
    v_rcp_f32 v85, v85
    s_waitcnt lgkmcnt(0)
    v_mfma_f32_32x32x16_bf16 v[112:127], v[208:211], v[104:107], v[112:127]
    v_rcp_f32 v86, v86
    v_rcp_f32 v87, v87
    v_exp_f32 v88, v88
    v_mfma_f32_32x32x16_bf16 v[128:143], v[212:215], v[104:107], v[128:143]
    v_exp_f32 v89, v89
    v_exp_f32 v90, v90
    v_exp_f32 v91, v91
    v_mfma_f32_32x32x16_bf16 v[144:159], v[216:219], v[104:107], v[144:159]
    v_exp_f32 v92, v92
    v_exp_f32 v93, v93
    v_exp_f32 v94, v94
    v_mfma_f32_32x32x16_bf16 v[112:127], v[220:223], v[108:111], v[112:127]
    v_exp_f32 v95, v95
    v_exp_f32 v96, v96
    v_exp_f32 v97, v97
    v_mfma_f32_32x32x16_bf16 v[128:143], v[224:227], v[108:111], v[128:143]
    v_exp_f32 v98, v98
    v_exp_f32 v99, v99
    v_exp_f32 v100, v100
    v_mfma_f32_32x32x16_bf16 v[144:159], v[228:231], v[108:111], v[144:159]
    v_exp_f32 v101, v101
    v_exp_f32 v102, v102
    v_exp_f32 v103, v103
    s_setprio 3
    v_pk_mul_f32 v[8:9], v[8:9], v[72:73]
    v_pk_mul_f32 v[10:11], v[10:11], v[74:75]
    v_pk_mul_f32 v[12:13], v[12:13], v[76:77]
    v_pk_mul_f32 v[14:15], v[14:15], v[78:79]
    v_pk_mul_f32 v[16:17], v[16:17], v[80:81]
    v_pk_mul_f32 v[18:19], v[18:19], v[82:83]
    v_pk_mul_f32 v[20:21], v[20:21], v[84:85]
    v_pk_mul_f32 v[22:23], v[22:23], v[86:87]
    v_pk_add_f32 v[88:89], v[88:89], s[62:63]
    v_pk_add_f32 v[90:91], v[90:91], s[62:63]
    v_pk_add_f32 v[92:93], v[92:93], s[62:63]
    v_pk_add_f32 v[94:95], v[94:95], s[62:63]
    v_pk_add_f32 v[96:97], v[96:97], s[62:63]
    v_pk_add_f32 v[98:99], v[98:99], s[62:63]
    v_pk_add_f32 v[100:101], v[100:101], s[62:63]
    v_pk_add_f32 v[102:103], v[102:103], s[62:63]
    v_pk_fma_f32 v[72:73], v[40:41], v[40:41], s[60:61]
    v_pk_fma_f32 v[74:75], v[42:43], v[42:43], s[60:61]
    v_pk_fma_f32 v[76:77], v[44:45], v[44:45], s[60:61]
    v_pk_fma_f32 v[78:79], v[46:47], v[46:47], s[60:61]
    v_pk_fma_f32 v[80:81], v[48:49], v[48:49], s[60:61]
    v_pk_fma_f32 v[82:83], v[50:51], v[50:51], s[60:61]
    v_pk_fma_f32 v[84:85], v[52:53], v[52:53], s[60:61]
    v_pk_fma_f32 v[86:87], v[54:55], v[54:55], s[60:61]
    v_pk_mul_f32 v[72:73], v[40:41], v[72:73] neg_lo:[1,0] neg_hi:[1,0]
    v_pk_mul_f32 v[74:75], v[42:43], v[74:75] neg_lo:[1,0] neg_hi:[1,0]
    v_pk_mul_f32 v[76:77], v[44:45], v[76:77] neg_lo:[1,0] neg_hi:[1,0]
    v_pk_mul_f32 v[78:79], v[46:47], v[78:79] neg_lo:[1,0] neg_hi:[1,0]
    v_pk_mul_f32 v[80:81], v[48:49], v[80:81] neg_lo:[1,0] neg_hi:[1,0]
    v_pk_mul_f32 v[82:83], v[50:51], v[82:83] neg_lo:[1,0] neg_hi:[1,0]
    v_pk_mul_f32 v[84:85], v[52:53], v[84:85] neg_lo:[1,0] neg_hi:[1,0]
    v_pk_mul_f32 v[86:87], v[54:55], v[86:87] neg_lo:[1,0] neg_hi:[1,0]
    s_setprio 2
    s_nop 0
    ds_read_b128 v[56:59], v240 offset:896
    ds_read_b128 v[60:63], v240 offset:928
    ds_read_b128 v[64:67], v240 offset:960
    ds_read_b128 v[68:71], v240 offset:992
    ds_read_b64_tr_b16 v[184:185], v232 offset:24704
    ds_read_b64_tr_b16 v[186:187], v232 offset:25216
    ds_read_b64_tr_b16 v[188:189], v232 offset:25728
    ds_read_b64_tr_b16 v[190:191], v232 offset:26240
    ds_read_b64_tr_b16 v[192:193], v232 offset:26752
    ds_read_b64_tr_b16 v[194:195], v232 offset:27264
    ds_read_b64_tr_b16 v[196:197], v232 offset:27776
    ds_read_b64_tr_b16 v[198:199], v232 offset:28288
    ds_read_b64_tr_b16 v[200:201], v232 offset:28800
    ds_read_b64_tr_b16 v[202:203], v232 offset:29312
    ds_read_b64_tr_b16 v[204:205], v232 offset:29824
    ds_read_b64_tr_b16 v[206:207], v232 offset:30336
    ds_read_b64_tr_b16 v[208:209], v233 offset:49408
    ds_read_b64_tr_b16 v[210:211], v233 offset:50960
    ds_read_b64_tr_b16 v[212:213], v233 offset:49472
    ds_read_b64_tr_b16 v[214:215], v233 offset:51024
    ds_read_b64_tr_b16 v[216:217], v233 offset:49536
    ds_read_b64_tr_b16 v[218:219], v233 offset:51088
    ds_read_b64_tr_b16 v[220:221], v233 offset:52512
    ds_read_b64_tr_b16 v[222:223], v233 offset:54064
    ds_read_b64_tr_b16 v[224:225], v233 offset:52576
    ds_read_b64_tr_b16 v[226:227], v233 offset:54128
    ds_read_b64_tr_b16 v[228:229], v233 offset:52640
    ds_read_b64_tr_b16 v[230:231], v233 offset:54192
    ds_read_b32 v5, v245
    s_mov_b32 exec_hi, 0xffff
    s_add_u32 m0, s58, 111168
    s_mov_b32 s59, 55296
    buffer_load_dwordx4 v242, s[32:35], s59 offen lds
    s_add_u32 m0, s58, 123520
    s_mov_b32 s59, 61440
    buffer_load_dwordx4 v242, s[32:35], s59 offen lds
    s_mov_b32 exec_hi, -1
    s_waitcnt lgkmcnt(13)
    v_mfma_f32_32x32x16_bf16 v[56:71], v[184:187], v[160:163], v[56:71]
    v_cvt_pk_bf16_f32 v104, v8, v9
    v_cvt_pk_bf16_f32 v105, v10, v11
    v_rcp_f32 v88, v88
    v_rcp_f32 v89, v89
    v_mfma_f32_32x32x16_bf16 v[56:71], v[188:191], v[164:167], v[56:71]
    v_cvt_pk_bf16_f32 v106, v12, v13
    v_cvt_pk_bf16_f32 v107, v14, v15
    v_rcp_f32 v90, v90
    v_rcp_f32 v91, v91
    s_setprio 0
    v_mfma_f32_32x32x16_bf16 v[56:71], v[192:195], v[168:171], v[56:71]
    v_cvt_pk_bf16_f32 v108, v16, v17
    v_cvt_pk_bf16_f32 v109, v18, v19
    v_rcp_f32 v92, v92
    v_rcp_f32 v93, v93
    v_mfma_f32_32x32x16_bf16 v[56:71], v[196:199], v[172:175], v[56:71]
    v_cvt_pk_bf16_f32 v110, v20, v21
    v_cvt_pk_bf16_f32 v111, v22, v23
    v_rcp_f32 v94, v94
    v_rcp_f32 v95, v95
    v_mfma_f32_32x32x16_bf16 v[56:71], v[200:203], v[176:179], v[56:71]
    v_rcp_f32 v96, v96
    v_rcp_f32 v97, v97
    v_rcp_f32 v98, v98
    v_mfma_f32_32x32x16_bf16 v[56:71], v[204:207], v[180:183], v[56:71]
    v_rcp_f32 v99, v99
    v_rcp_f32 v100, v100
    v_rcp_f32 v101, v101
    s_waitcnt lgkmcnt(0)
    v_mfma_f32_32x32x16_bf16 v[112:127], v[208:211], v[104:107], v[112:127]
    v_rcp_f32 v102, v102
    v_rcp_f32 v103, v103
    v_exp_f32 v72, v72
    v_mfma_f32_32x32x16_bf16 v[128:143], v[212:215], v[104:107], v[128:143]
    v_exp_f32 v73, v73
    v_exp_f32 v74, v74
    v_exp_f32 v75, v75
    v_mfma_f32_32x32x16_bf16 v[144:159], v[216:219], v[104:107], v[144:159]
    v_exp_f32 v76, v76
    v_exp_f32 v77, v77
    v_exp_f32 v78, v78
    v_mfma_f32_32x32x16_bf16 v[112:127], v[220:223], v[108:111], v[112:127]
    v_exp_f32 v79, v79
    v_exp_f32 v80, v80
    v_exp_f32 v81, v81
    v_mfma_f32_32x32x16_bf16 v[128:143], v[224:227], v[108:111], v[128:143]
    v_exp_f32 v82, v82
    v_exp_f32 v83, v83
    v_exp_f32 v84, v84
    v_mfma_f32_32x32x16_bf16 v[144:159], v[228:231], v[108:111], v[144:159]
    v_exp_f32 v85, v85
    v_exp_f32 v86, v86
    v_exp_f32_e64 v87, v87
    s_setprio 3
    v_pk_mul_f32 v[24:25], v[24:25], v[88:89]
    v_pk_mul_f32 v[26:27], v[26:27], v[90:91]
    v_pk_mul_f32 v[28:29], v[28:29], v[92:93]
    v_pk_mul_f32 v[30:31], v[30:31], v[94:95]
    v_pk_mul_f32 v[32:33], v[32:33], v[96:97]
    v_pk_mul_f32 v[34:35], v[34:35], v[98:99]
    v_pk_mul_f32 v[36:37], v[36:37], v[100:101]
    v_pk_mul_f32 v[38:39], v[38:39], v[102:103]
    v_pk_add_f32 v[72:73], v[72:73], s[62:63]
    v_pk_add_f32 v[74:75], v[74:75], s[62:63]
    v_pk_add_f32 v[76:77], v[76:77], s[62:63]
    v_pk_add_f32 v[78:79], v[78:79], s[62:63]
    v_pk_add_f32 v[80:81], v[80:81], s[62:63]
    v_pk_add_f32 v[82:83], v[82:83], s[62:63]
    v_pk_add_f32 v[84:85], v[84:85], s[62:63]
    v_pk_add_f32 v[86:87], v[86:87], s[62:63]
    v_pk_fma_f32 v[88:89], v[56:57], v[56:57], s[60:61]
    v_pk_fma_f32 v[90:91], v[58:59], v[58:59], s[60:61]
    v_pk_fma_f32 v[92:93], v[60:61], v[60:61], s[60:61]
    v_pk_fma_f32 v[94:95], v[62:63], v[62:63], s[60:61]
    v_pk_fma_f32 v[96:97], v[64:65], v[64:65], s[60:61]
    v_pk_fma_f32 v[98:99], v[66:67], v[66:67], s[60:61]
    v_pk_fma_f32 v[100:101], v[68:69], v[68:69], s[60:61]
    v_pk_fma_f32 v[102:103], v[70:71], v[70:71], s[60:61]
    v_pk_mul_f32 v[88:89], v[56:57], v[88:89] neg_lo:[1,0] neg_hi:[1,0]
    v_pk_mul_f32 v[90:91], v[58:59], v[90:91] neg_lo:[1,0] neg_hi:[1,0]
    v_pk_mul_f32 v[92:93], v[60:61], v[92:93] neg_lo:[1,0] neg_hi:[1,0]
    v_pk_mul_f32 v[94:95], v[62:63], v[94:95] neg_lo:[1,0] neg_hi:[1,0]
    v_pk_mul_f32 v[96:97], v[64:65], v[96:97] neg_lo:[1,0] neg_hi:[1,0]
    v_pk_mul_f32 v[98:99], v[66:67], v[98:99] neg_lo:[1,0] neg_hi:[1,0]
    v_pk_mul_f32 v[100:101], v[68:69], v[100:101] neg_lo:[1,0] neg_hi:[1,0]
    v_pk_mul_f32 v[102:103], v[70:71], v[102:103] neg_lo:[1,0] neg_hi:[1,0]
    s_setprio 2
    v_cmp_le_u32 vcc, 6, v5
    s_cmp_eq_u64 vcc, -1
    s_cbranch_scc1 L_gate_W_6_ok
L_gate_W_6:
    ds_read_b32 v5, v245
    s_waitcnt lgkmcnt(0)
    v_cmp_le_u32 vcc, 6, v5
    s_cmp_eq_u64 vcc, -1
    s_cbranch_scc0 L_gate_W_6
L_gate_W_6_ok:
    ds_read_b128 v[8:11], v240 offset:1024
    ds_read_b128 v[12:15], v240 offset:1056
    ds_read_b128 v[16:19], v240 offset:1088
    ds_read_b128 v[20:23], v240 offset:1120
    ds_read_b64_tr_b16 v[184:185], v232 offset:37056
    ds_read_b64_tr_b16 v[186:187], v232 offset:37568
    ds_read_b64_tr_b16 v[188:189], v232 offset:38080
    ds_read_b64_tr_b16 v[190:191], v232 offset:38592
    ds_read_b64_tr_b16 v[192:193], v232 offset:39104
    ds_read_b64_tr_b16 v[194:195], v232 offset:39616
    ds_read_b64_tr_b16 v[196:197], v232 offset:40128
    ds_read_b64_tr_b16 v[198:199], v232 offset:40640
    ds_read_b64_tr_b16 v[200:201], v232 offset:41152
    ds_read_b64_tr_b16 v[202:203], v232 offset:41664
    ds_read_b64_tr_b16 v[204:205], v232 offset:42176
    ds_read_b64_tr_b16 v[206:207], v232 offset:42688
    v_add_u32 v233, 61760, v233
    ds_read_b64_tr_b16 v[208:209], v233 offset:0
    ds_read_b64_tr_b16 v[210:211], v233 offset:1552
    ds_read_b64_tr_b16 v[212:213], v233 offset:64
    ds_read_b64_tr_b16 v[214:215], v233 offset:1616
    ds_read_b64_tr_b16 v[216:217], v233 offset:128
    ds_read_b64_tr_b16 v[218:219], v233 offset:1680
    ds_read_b64_tr_b16 v[220:221], v233 offset:3104
    ds_read_b64_tr_b16 v[222:223], v233 offset:4656
    ds_read_b64_tr_b16 v[224:225], v233 offset:3168
    ds_read_b64_tr_b16 v[226:227], v233 offset:4720
    ds_read_b64_tr_b16 v[228:229], v233 offset:3232
    ds_read_b64_tr_b16 v[230:231], v233 offset:4784
    s_mov_b32 exec_hi, 0xffff
    s_add_u32 m0, s58, 135872
    s_mov_b32 s59, 67584
    buffer_load_dwordx4 v242, s[32:35], s59 offen lds
    s_mov_b32 exec_hi, -1
    s_waitcnt lgkmcnt(12)
    v_mfma_f32_32x32x16_bf16 v[8:23], v[184:187], v[160:163], v[8:23]
    v_cvt_pk_bf16_f32 v104, v24, v25
    v_cvt_pk_bf16_f32 v105, v26, v27
    v_rcp_f32 v72, v72
    v_rcp_f32 v73, v73
    v_mfma_f32_32x32x16_bf16 v[8:23], v[188:191], v[164:167], v[8:23]
    v_cvt_pk_bf16_f32 v106, v28, v29
    v_cvt_pk_bf16_f32 v107, v30, v31
    v_rcp_f32 v74, v74
    v_rcp_f32 v75, v75
    s_setprio 0
    v_mfma_f32_32x32x16_bf16 v[8:23], v[192:195], v[168:171], v[8:23]
    v_cvt_pk_bf16_f32 v108, v32, v33
    v_cvt_pk_bf16_f32 v109, v34, v35
    v_rcp_f32 v76, v76
    v_rcp_f32 v77, v77
    v_mfma_f32_32x32x16_bf16 v[8:23], v[196:199], v[172:175], v[8:23]
    v_cvt_pk_bf16_f32 v110, v36, v37
    v_cvt_pk_bf16_f32 v111, v38, v39
    v_rcp_f32 v78, v78
    v_rcp_f32 v79, v79
    v_mfma_f32_32x32x16_bf16 v[8:23], v[200:203], v[176:179], v[8:23]
    v_rcp_f32 v80, v80
    v_rcp_f32 v81, v81
    v_rcp_f32 v82, v82
    v_mfma_f32_32x32x16_bf16 v[8:23], v[204:207], v[180:183], v[8:23]
    v_rcp_f32 v83, v83
    v_rcp_f32 v84, v84
    v_rcp_f32 v85, v85
    s_waitcnt lgkmcnt(0)
    v_mfma_f32_32x32x16_bf16 v[112:127], v[208:211], v[104:107], v[112:127]
    v_rcp_f32 v86, v86
    v_rcp_f32 v87, v87
    v_exp_f32 v88, v88
    v_mfma_f32_32x32x16_bf16 v[128:143], v[212:215], v[104:107], v[128:143]
    v_exp_f32 v89, v89
    v_exp_f32 v90, v90
    v_exp_f32 v91, v91
    v_mfma_f32_32x32x16_bf16 v[144:159], v[216:219], v[104:107], v[144:159]
    v_exp_f32 v92, v92
    v_exp_f32 v93, v93
    v_exp_f32 v94, v94
    v_mfma_f32_32x32x16_bf16 v[112:127], v[220:223], v[108:111], v[112:127]
    v_exp_f32 v95, v95
    v_exp_f32 v96, v96
    v_exp_f32 v97, v97
    v_mfma_f32_32x32x16_bf16 v[128:143], v[224:227], v[108:111], v[128:143]
    v_exp_f32 v98, v98
    v_exp_f32 v99, v99
    v_exp_f32 v100, v100
    v_mfma_f32_32x32x16_bf16 v[144:159], v[228:231], v[108:111], v[144:159]
    v_exp_f32 v101, v101
    v_exp_f32 v102, v102
    v_exp_f32_e64 v103, v103
    s_setprio 3
    v_pk_mul_f32 v[40:41], v[40:41], v[72:73]
    v_pk_mul_f32 v[42:43], v[42:43], v[74:75]
    v_pk_mul_f32 v[44:45], v[44:45], v[76:77]
    v_pk_mul_f32 v[46:47], v[46:47], v[78:79]
    v_pk_mul_f32 v[48:49], v[48:49], v[80:81]
    v_pk_mul_f32 v[50:51], v[50:51], v[82:83]
    v_pk_mul_f32 v[52:53], v[52:53], v[84:85]
    v_pk_mul_f32 v[54:55], v[54:55], v[86:87]
    v_pk_add_f32 v[88:89], v[88:89], s[62:63]
    v_pk_add_f32 v[90:91], v[90:91], s[62:63]
    v_pk_add_f32 v[92:93], v[92:93], s[62:63]
    v_pk_add_f32 v[94:95], v[94:95], s[62:63]
    v_pk_add_f32 v[96:97], v[96:97], s[62:63]
    v_pk_add_f32 v[98:99], v[98:99], s[62:63]
    v_pk_add_f32 v[100:101], v[100:101], s[62:63]
    v_pk_add_f32 v[102:103], v[102:103], s[62:63]
    v_pk_fma_f32 v[72:73], v[8:9], v[8:9], s[60:61]
    v_pk_fma_f32 v[74:75], v[10:11], v[10:11], s[60:61]
    v_pk_fma_f32 v[76:77], v[12:13], v[12:13], s[60:61]
    v_pk_fma_f32 v[78:79], v[14:15], v[14:15], s[60:61]
    v_pk_fma_f32 v[80:81], v[16:17], v[16:17], s[60:61]
    v_pk_fma_f32 v[82:83], v[18:19], v[18:19], s[60:61]
    v_pk_fma_f32 v[84:85], v[20:21], v[20:21], s[60:61]
    v_pk_fma_f32 v[86:87], v[22:23], v[22:23], s[60:61]
    v_pk_mul_f32 v[72:73], v[8:9], v[72:73] neg_lo:[1,0] neg_hi:[1,0]
    v_pk_mul_f32 v[74:75], v[10:11], v[74:75] neg_lo:[1,0] neg_hi:[1,0]
    v_pk_mul_f32 v[76:77], v[12:13], v[76:77] neg_lo:[1,0] neg_hi:[1,0]
    v_pk_mul_f32 v[78:79], v[14:15], v[78:79] neg_lo:[1,0] neg_hi:[1,0]
    v_pk_mul_f32 v[80:81], v[16:17], v[80:81] neg_lo:[1,0] neg_hi:[1,0]
    v_pk_mul_f32 v[82:83], v[18:19], v[82:83] neg_lo:[1,0] neg_hi:[1,0]
    v_pk_mul_f32 v[84:85], v[20:21], v[84:85] neg_lo:[1,0] neg_hi:[1,0]
    v_pk_mul_f32 v[86:87], v[22:23], v[86:87] neg_lo:[1,0] neg_hi:[1,0]
    s_setprio 2
    s_nop 0
    ds_read_b128 v[24:27], v240 offset:1152
    ds_read_b128 v[28:31], v240 offset:1184
    ds_read_b128 v[32:35], v240 offset:1216
    ds_read_b128 v[36:39], v240 offset:1248
    ds_read_b64_tr_b16 v[184:185], v232 offset:49408
    ds_read_b64_tr_b16 v[186:187], v232 offset:49920
    ds_read_b64_tr_b16 v[188:189], v232 offset:50432
    ds_read_b64_tr_b16 v[190:191], v232 offset:50944
    ds_read_b64_tr_b16 v[192:193], v232 offset:51456
    ds_read_b64_tr_b16 v[194:195], v232 offset:51968
    ds_read_b64_tr_b16 v[196:197], v232 offset:52480
    ds_read_b64_tr_b16 v[198:199], v232 offset:52992
    ds_read_b64_tr_b16 v[200:201], v232 offset:53504
    ds_read_b64_tr_b16 v[202:203], v232 offset:54016
    ds_read_b64_tr_b16 v[204:205], v232 offset:54528
    ds_read_b64_tr_b16 v[206:207], v232 offset:55040
    ds_read_b64_tr_b16 v[208:209], v233 offset:12352
    ds_read_b64_tr_b16 v[210:211], v233 offset:13904
    ds_read_b64_tr_b16 v[212:213], v233 offset:12416
    ds_read_b64_tr_b16 v[214:215], v233 offset:13968
    ds_read_b64_tr_b16 v[216:217], v233 offset:12480
    ds_read_b64_tr_b16 v[218:219], v233 offset:14032
    ds_read_b64_tr_b16 v[220:221], v233 offset:15456
    ds_read_b64_tr_b16 v[222:223], v233 offset:17008
    ds_read_b64_tr_b16 v[224:225], v233 offset:15520
    ds_read_b64_tr_b16 v[226:227], v233 offset:17072
    ds_read_b64_tr_b16 v[228:229], v233 offset:15584
    ds_read_b64_tr_b16 v[230:231], v233 offset:17136
    s_waitcnt vmcnt(0)
    v_mov_b32 v4, 7
    ds_write_b32 v244, v4
    s_waitcnt lgkmcnt(13)
    v_mfma_f32_32x32x16_bf16 v[24:39], v[184:187], v[160:163], v[24:39]
    v_cvt_pk_bf16_f32 v104, v40, v41
    v_cvt_pk_bf16_f32 v105, v42, v43
    v_rcp_f32 v88, v88
    v_rcp_f32 v89, v89
    v_mfma_f32_32x32x16_bf16 v[24:39], v[188:191], v[164:167], v[24:39]
    v_cvt_pk_bf16_f32 v106, v44, v45
    v_cvt_pk_bf16_f32 v107, v46, v47
    v_rcp_f32 v90, v90
    v_rcp_f32 v91, v91
    s_setprio 0
    v_mfma_f32_32x32x16_bf16 v[24:39], v[192:195], v[168:171], v[24:39]
    v_cvt_pk_bf16_f32 v108, v48, v49
    v_cvt_pk_bf16_f32 v109, v50, v51
    v_rcp_f32 v92, v92
    v_rcp_f32 v93, v93
    v_mfma_f32_32x32x16_bf16 v[24:39], v[196:199], v[172:175], v[24:39]
    v_cvt_pk_bf16_f32 v110, v52, v53
    v_cvt_pk_bf16_f32 v111, v54, v55
    v_rcp_f32 v94, v94
    v_rcp_f32 v95, v95
    v_mfma_f32_32x32x16_bf16 v[24:39], v[200:203], v[176:179], v[24:39]
    v_rcp_f32 v96, v96
    v_rcp_f32 v97, v97
    v_rcp_f32 v98, v98
    v_mfma_f32_32x32x16_bf16 v[24:39], v[204:207], v[180:183], v[24:39]
    v_rcp_f32 v99, v99
    v_rcp_f32 v100, v100
    v_rcp_f32 v101, v101
    s_waitcnt lgkmcnt(0)
    v_mfma_f32_32x32x16_bf16 v[112:127], v[208:211], v[104:107], v[112:127]
    v_rcp_f32 v102, v102
    v_rcp_f32 v103, v103
    v_exp_f32 v72, v72
    v_mfma_f32_32x32x16_bf16 v[128:143], v[212:215], v[104:107], v[128:143]
    v_exp_f32 v73, v73
    v_exp_f32 v74, v74
    v_exp_f32 v75, v75
    v_mfma_f32_32x32x16_bf16 v[144:159], v[216:219], v[104:107], v[144:159]
    v_exp_f32 v76, v76
    v_exp_f32 v77, v77
    v_exp_f32 v78, v78
    v_mfma_f32_32x32x16_bf16 v[112:127], v[220:223], v[108:111], v[112:127]
    v_exp_f32 v79, v79
    v_exp_f32 v80, v80
    v_exp_f32 v81, v81
    v_mfma_f32_32x32x16_bf16 v[128:143], v[224:227], v[108:111], v[128:143]
    v_exp_f32 v82, v82
    v_exp_f32 v83, v83
    v_exp_f32 v84, v84
    v_mfma_f32_32x32x16_bf16 v[144:159], v[228:231], v[108:111], v[144:159]
    v_exp_f32 v85, v85
    v_exp_f32 v86, v86
    v_exp_f32 v87, v87
    s_setprio 3
    v_pk_mul_f32 v[56:57], v[56:57], v[88:89]
    v_pk_mul_f32 v[58:59], v[58:59], v[90:91]
    v_pk_mul_f32 v[60:61], v[60:61], v[92:93]
    v_pk_mul_f32 v[62:63], v[62:63], v[94:95]
    v_pk_mul_f32 v[64:65], v[64:65], v[96:97]
    v_pk_mul_f32 v[66:67], v[66:67], v[98:99]
    v_pk_mul_f32 v[68:69], v[68:69], v[100:101]
    v_pk_mul_f32 v[70:71], v[70:71], v[102:103]
    v_pk_add_f32 v[72:73], v[72:73], s[62:63]
    v_pk_add_f32 v[74:75], v[74:75], s[62:63]
    v_pk_add_f32 v[76:77], v[76:77], s[62:63]
    v_pk_add_f32 v[78:79], v[78:79], s[62:63]
    v_pk_add_f32 v[80:81], v[80:81], s[62:63]
    v_pk_add_f32 v[82:83], v[82:83], s[62:63]
    v_pk_add_f32 v[84:85], v[84:85], s[62:63]
    v_pk_add_f32 v[86:87], v[86:87], s[62:63]
    v_pk_fma_f32 v[88:89], v[24:25], v[24:25], s[60:61]
    v_pk_fma_f32 v[90:91], v[26:27], v[26:27], s[60:61]
    v_pk_fma_f32 v[92:93], v[28:29], v[28:29], s[60:61]
    v_pk_fma_f32 v[94:95], v[30:31], v[30:31], s[60:61]
    v_pk_fma_f32 v[96:97], v[32:33], v[32:33], s[60:61]
    v_pk_fma_f32 v[98:99], v[34:35], v[34:35], s[60:61]
    v_pk_fma_f32 v[100:101], v[36:37], v[36:37], s[60:61]
    v_pk_fma_f32 v[102:103], v[38:39], v[38:39], s[60:61]
    v_pk_mul_f32 v[88:89], v[24:25], v[88:89] neg_lo:[1,0] neg_hi:[1,0]
    v_pk_mul_f32 v[90:91], v[26:27], v[90:91] neg_lo:[1,0] neg_hi:[1,0]
    v_pk_mul_f32 v[92:93], v[28:29], v[92:93] neg_lo:[1,0] neg_hi:[1,0]
    v_pk_mul_f32 v[94:95], v[30:31], v[94:95] neg_lo:[1,0] neg_hi:[1,0]
    v_pk_mul_f32 v[96:97], v[32:33], v[96:97] neg_lo:[1,0] neg_hi:[1,0]
    v_pk_mul_f32 v[98:99], v[34:35], v[98:99] neg_lo:[1,0] neg_hi:[1,0]
    v_pk_mul_f32 v[100:101], v[36:37], v[100:101] neg_lo:[1,0] neg_hi:[1,0]
    v_pk_mul_f32 v[102:103], v[38:39], v[102:103] neg_lo:[1,0] neg_hi:[1,0]
    s_setprio 2
    s_nop 0
    v_add_u32 v232, 61760, v232
    ds_read_b128 v[40:43], v240 offset:1280
    ds_read_b128 v[44:47], v240 offset:1312
    ds_read_b128 v[48:51], v240 offset:1344
    ds_read_b128 v[52:55], v240 offset:1376
    ds_read_b64_tr_b16 v[184:185], v232 offset:0
    ds_read_b64_tr_b16 v[186:187], v232 offset:512
    ds_read_b64_tr_b16 v[188:189], v232 offset:1024
    ds_read_b64_tr_b16 v[190:191], v232 offset:1536
    ds_read_b64_tr_b16 v[192:193], v232 offset:2048
    ds_read_b64_tr_b16 v[194:195], v232 offset:2560
    ds_read_b64_tr_b16 v[196:197], v232 offset:3072
    ds_read_b64_tr_b16 v[198:199], v232 offset:3584
    ds_read_b64_tr_b16 v[200:201], v232 offset:4096
    ds_read_b64_tr_b16 v[202:203], v232 offset:4608
    ds_read_b64_tr_b16 v[204:205], v232 offset:5120
    ds_read_b64_tr_b16 v[206:207], v232 offset:5632
    ds_read_b64_tr_b16 v[208:209], v233 offset:24704
    ds_read_b64_tr_b16 v[210:211], v233 offset:26256
    ds_read_b64_tr_b16 v[212:213], v233 offset:24768
    ds_read_b64_tr_b16 v[214:215], v233 offset:26320
    ds_read_b64_tr_b16 v[216:217], v233 offset:24832
    ds_read_b64_tr_b16 v[218:219], v233 offset:26384
    ds_read_b64_tr_b16 v[220:221], v233 offset:27808
    ds_read_b64_tr_b16 v[222:223], v233 offset:29360
    ds_read_b64_tr_b16 v[224:225], v233 offset:27872
    ds_read_b64_tr_b16 v[226:227], v233 offset:29424
    ds_read_b64_tr_b16 v[228:229], v233 offset:27936
    ds_read_b64_tr_b16 v[230:231], v233 offset:29488
    ds_read_b32 v5, v245
    s_waitcnt lgkmcnt(13)
    v_mfma_f32_32x32x16_bf16 v[40:55], v[184:187], v[160:163], v[40:55]
    v_cvt_pk_bf16_f32 v104, v56, v57
    v_cvt_pk_bf16_f32 v105, v58, v59
    v_rcp_f32 v72, v72
    v_rcp_f32 v73, v73
    v_mfma_f32_32x32x16_bf16 v[40:55], v[188:191], v[164:167], v[40:55]
    v_cvt_pk_bf16_f32 v106, v60, v61
    v_cvt_pk_bf16_f32 v107, v62, v63
    v_rcp_f32 v74, v74
    v_rcp_f32 v75, v75
    s_setprio 0
    v_mfma_f32_32x32x16_bf16 v[40:55], v[192:195], v[168:171], v[40:55]
    v_cvt_pk_bf16_f32 v108, v64, v65
    v_cvt_pk_bf16_f32 v109, v66, v67
    v_rcp_f32 v76, v76
    v_rcp_f32 v77, v77
    v_mfma_f32_32x32x16_bf16 v[40:55], v[196:199], v[172:175], v[40:55]
    v_cvt_pk_bf16_f32 v110, v68, v69
    v_cvt_pk_bf16_f32 v111, v70, v71
    v_rcp_f32 v78, v78
    v_rcp_f32 v79, v79
    v_mfma_f32_32x32x16_bf16 v[40:55], v[200:203], v[176:179], v[40:55]
    v_rcp_f32 v80, v80
    v_rcp_f32 v81, v81
    v_rcp_f32 v82, v82
    v_mfma_f32_32x32x16_bf16 v[40:55], v[204:207], v[180:183], v[40:55]
    v_rcp_f32 v83, v83
    v_rcp_f32 v84, v84
    v_rcp_f32 v85, v85
    s_waitcnt lgkmcnt(0)
    v_mfma_f32_32x32x16_bf16 v[112:127], v[208:211], v[104:107], v[112:127]
    v_rcp_f32 v86, v86
    v_rcp_f32 v87, v87
    v_exp_f32 v88, v88
    v_mfma_f32_32x32x16_bf16 v[128:143], v[212:215], v[104:107], v[128:143]
    v_exp_f32 v89, v89
    v_exp_f32 v90, v90
    v_exp_f32 v91, v91
    v_mfma_f32_32x32x16_bf16 v[144:159], v[216:219], v[104:107], v[144:159]
    v_exp_f32 v92, v92
    v_exp_f32 v93, v93
    v_exp_f32 v94, v94
    v_mfma_f32_32x32x16_bf16 v[112:127], v[220:223], v[108:111], v[112:127]
    v_exp_f32 v95, v95
    v_exp_f32 v96, v96
    v_exp_f32 v97, v97
    v_mfma_f32_32x32x16_bf16 v[128:143], v[224:227], v[108:111], v[128:143]
    v_exp_f32 v98, v98
    v_exp_f32 v99, v99
    v_exp_f32 v100, v100
    v_mfma_f32_32x32x16_bf16 v[144:159], v[228:231], v[108:111], v[144:159]
    v_exp_f32 v101, v101
    v_exp_f32 v102, v102
    v_exp_f32 v103, v103
    s_setprio 3
    v_pk_mul_f32 v[8:9], v[8:9], v[72:73]
    v_pk_mul_f32 v[10:11], v[10:11], v[74:75]
    v_pk_mul_f32 v[12:13], v[12:13], v[76:77]
    v_pk_mul_f32 v[14:15], v[14:15], v[78:79]
    v_pk_mul_f32 v[16:17], v[16:17], v[80:81]
    v_pk_mul_f32 v[18:19], v[18:19], v[82:83]
    v_pk_mul_f32 v[20:21], v[20:21], v[84:85]
    v_pk_mul_f32 v[22:23], v[22:23], v[86:87]
    v_pk_add_f32 v[88:89], v[88:89], s[62:63]
    v_pk_add_f32 v[90:91], v[90:91], s[62:63]
    v_pk_add_f32 v[92:93], v[92:93], s[62:63]
    v_pk_add_f32 v[94:95], v[94:95], s[62:63]
    v_pk_add_f32 v[96:97], v[96:97], s[62:63]
    v_pk_add_f32 v[98:99], v[98:99], s[62:63]
    v_pk_add_f32 v[100:101], v[100:101], s[62:63]
    v_pk_add_f32 v[102:103], v[102:103], s[62:63]
    v_pk_fma_f32 v[72:73], v[40:41], v[40:41], s[60:61]
    v_pk_fma_f32 v[74:75], v[42:43], v[42:43], s[60:61]
    v_pk_fma_f32 v[76:77], v[44:45], v[44:45], s[60:61]
    v_pk_fma_f32 v[78:79], v[46:47], v[46:47], s[60:61]
    v_pk_fma_f32 v[80:81], v[48:49], v[48:49], s[60:61]
    v_pk_fma_f32 v[82:83], v[50:51], v[50:51], s[60:61]
    v_pk_fma_f32 v[84:85], v[52:53], v[52:53], s[60:61]
    v_pk_fma_f32 v[86:87], v[54:55], v[54:55], s[60:61]
    v_pk_mul_f32 v[72:73], v[40:41], v[72:73] neg_lo:[1,0] neg_hi:[1,0]
    v_pk_mul_f32 v[74:75], v[42:43], v[74:75] neg_lo:[1,0] neg_hi:[1,0]
    v_pk_mul_f32 v[76:77], v[44:45], v[76:77] neg_lo:[1,0] neg_hi:[1,0]
    v_pk_mul_f32 v[78:79], v[46:47], v[78:79] neg_lo:[1,0] neg_hi:[1,0]
    v_pk_mul_f32 v[80:81], v[48:49], v[80:81] neg_lo:[1,0] neg_hi:[1,0]
    v_pk_mul_f32 v[82:83], v[50:51], v[82:83] neg_lo:[1,0] neg_hi:[1,0]
    v_pk_mul_f32 v[84:85], v[52:53], v[84:85] neg_lo:[1,0] neg_hi:[1,0]
    v_pk_mul_f32 v[86:87], v[54:55], v[86:87] neg_lo:[1,0] neg_hi:[1,0]
    s_setprio 2
    v_cmp_le_u32 vcc, 7, v5
    s_cmp_eq_u64 vcc, -1
    s_cbranch_scc1 L_gate_W_9_ok
L_gate_W_9:
    ds_read_b32 v5, v245
    s_waitcnt lgkmcnt(0)
    v_cmp_le_u32 vcc, 7, v5
    s_cmp_eq_u64 vcc, -1
    s_cbranch_scc0 L_gate_W_9
L_gate_W_9_ok:
    ds_read_b128 v[56:59], v240 offset:1408
    ds_read_b128 v[60:63], v240 offset:1440
    ds_read_b128 v[64:67], v240 offset:1472
    ds_read_b128 v[68:71], v240 offset:1504
    ds_read_b64_tr_b16 v[184:185], v232 offset:12352
    ds_read_b64_tr_b16 v[186:187], v232 offset:12864
    ds_read_b64_tr_b16 v[188:189], v232 offset:13376
    ds_read_b64_tr_b16 v[190:191], v232 offset:13888
    ds_read_b64_tr_b16 v[192:193], v232 offset:14400
    ds_read_b64_tr_b16 v[194:195], v232 offset:14912
    ds_read_b64_tr_b16 v[196:197], v232 offset:15424
    ds_read_b64_tr_b16 v[198:199], v232 offset:15936
    ds_read_b64_tr_b16 v[200:201], v232 offset:16448
    ds_read_b64_tr_b16 v[202:203], v232 offset:16960
    ds_read_b64_tr_b16 v[204:205], v232 offset:17472
    ds_read_b64_tr_b16 v[206:207], v232 offset:17984
    ds_read_b64_tr_b16 v[208:209], v233 offset:37056
    ds_read_b64_tr_b16 v[210:211], v233 offset:38608
    ds_read_b64_tr_b16 v[212:213], v233 offset:37120
    ds_read_b64_tr_b16 v[214:215], v233 offset:38672
    ds_read_b64_tr_b16 v[216:217], v233 offset:37184
    ds_read_b64_tr_b16 v[218:219], v233 offset:38736
    ds_read_b64_tr_b16 v[220:221], v233 offset:40160
    ds_read_b64_tr_b16 v[222:223], v233 offset:41712
    ds_read_b64_tr_b16 v[224:225], v233 offset:40224
    ds_read_b64_tr_b16 v[226:227], v233 offset:41776
    ds_read_b64_tr_b16 v[228:229], v233 offset:40288
    ds_read_b64_tr_b16 v[230:231], v233 offset:41840
    s_waitcnt lgkmcnt(12)
    v_mfma_f32_32x32x16_bf16 v[56:71], v[184:187], v[160:163], v[56:71]
    v_cvt_pk_bf16_f32 v104, v8, v9
    v_cvt_pk_bf16_f32 v105, v10, v11
    v_rcp_f32 v88, v88
    v_rcp_f32 v89, v89
    v_mfma_f32_32x32x16_bf16 v[56:71], v[188:191], v[164:167], v[56:71]
    v_cvt_pk_bf16_f32 v106, v12, v13
    v_cvt_pk_bf16_f32 v107, v14, v15
    v_rcp_f32 v90, v90
    v_rcp_f32 v91, v91
    s_setprio 0
    v_mfma_f32_32x32x16_bf16 v[56:71], v[192:195], v[168:171], v[56:71]
    v_cvt_pk_bf16_f32 v108, v16, v17
    v_cvt_pk_bf16_f32 v109, v18, v19
    v_rcp_f32 v92, v92
    v_rcp_f32 v93, v93
    v_mfma_f32_32x32x16_bf16 v[56:71], v[196:199], v[172:175], v[56:71]
    v_cvt_pk_bf16_f32 v110, v20, v21
    v_cvt_pk_bf16_f32 v111, v22, v23
    v_rcp_f32 v94, v94
    v_rcp_f32 v95, v95
    v_mfma_f32_32x32x16_bf16 v[56:71], v[200:203], v[176:179], v[56:71]
    v_rcp_f32 v96, v96
    v_rcp_f32 v97, v97
    v_rcp_f32 v98, v98
    v_mfma_f32_32x32x16_bf16 v[56:71], v[204:207], v[180:183], v[56:71]
    v_rcp_f32 v99, v99
    v_rcp_f32 v100, v100
    v_rcp_f32 v101, v101
    s_waitcnt lgkmcnt(0)
    v_mfma_f32_32x32x16_bf16 v[112:127], v[208:211], v[104:107], v[112:127]
    v_rcp_f32 v102, v102
    v_rcp_f32 v103, v103
    v_exp_f32 v72, v72
    v_mfma_f32_32x32x16_bf16 v[128:143], v[212:215], v[104:107], v[128:143]
    v_exp_f32 v73, v73
    v_exp_f32 v74, v74
    v_exp_f32 v75, v75
    v_mfma_f32_32x32x16_bf16 v[144:159], v[216:219], v[104:107], v[144:159]
    v_exp_f32 v76, v76
    v_exp_f32 v77, v77
    v_exp_f32 v78, v78
    v_mfma_f32_32x32x16_bf16 v[112:127], v[220:223], v[108:111], v[112:127]
    v_exp_f32 v79, v79
    v_exp_f32 v80, v80
    v_exp_f32 v81, v81
    v_mfma_f32_32x32x16_bf16 v[128:143], v[224:227], v[108:111], v[128:143]
    v_exp_f32 v82, v82
    v_exp_f32 v83, v83
    v_exp_f32 v84, v84
    v_mfma_f32_32x32x16_bf16 v[144:159], v[228:231], v[108:111], v[144:159]
    v_exp_f32 v85, v85
    v_exp_f32 v86, v86
    v_exp_f32_e64 v87, v87
    ds_read_b64_tr_b16 v[208:209], v233 offset:49408
    ds_read_b64_tr_b16 v[210:211], v233 offset:50960
    ds_read_b64_tr_b16 v[212:213], v233 offset:49472
    ds_read_b64_tr_b16 v[214:215], v233 offset:51024
    ds_read_b64_tr_b16 v[216:217], v233 offset:49536
    ds_read_b64_tr_b16 v[218:219], v233 offset:51088
    ds_read_b64_tr_b16 v[220:221], v233 offset:52512
    ds_read_b64_tr_b16 v[222:223], v233 offset:54064
    ds_read_b64_tr_b16 v[224:225], v233 offset:52576
    ds_read_b64_tr_b16 v[226:227], v233 offset:54128
    ds_read_b64_tr_b16 v[228:229], v233 offset:52640
    ds_read_b64_tr_b16 v[230:231], v233 offset:54192
    s_setprio 2
    s_nop 0
    buffer_load_dwordx4 v[184:187], v255, s[20:23], s55 offen offset:0
    buffer_load_dwordx4 v[188:191], v255, s[20:23], s55 offen offset:32
    buffer_load_dwordx4 v[192:195], v255, s[20:23], s55 offen offset:64
    buffer_load_dwordx4 v[196:199], v255, s[20:23], s55 offen offset:96
    buffer_load_dwordx4 v[200:203], v255, s[20:23], s55 offen offset:128
    buffer_load_dwordx4 v[204:207], v255, s[20:23], s55 offen offset:160
    v_pk_mul_f32 v[24:25], v[24:25], v[88:89]
    v_pk_mul_f32 v[26:27], v[26:27], v[90:91]
    v_pk_mul_f32 v[28:29], v[28:29], v[92:93]
    v_pk_mul_f32 v[30:31], v[30:31], v[94:95]
    v_pk_mul_f32 v[32:33], v[32:33], v[96:97]
    v_pk_mul_f32 v[34:35], v[34:35], v[98:99]
    v_pk_mul_f32 v[36:37], v[36:37], v[100:101]
    v_pk_mul_f32 v[38:39], v[38:39], v[102:103]
    v_pk_add_f32 v[72:73], v[72:73], s[62:63]
    v_pk_add_f32 v[74:75], v[74:75], s[62:63]
    v_pk_add_f32 v[76:77], v[76:77], s[62:63]
    v_pk_add_f32 v[78:79], v[78:79], s[62:63]
    v_pk_add_f32 v[80:81], v[80:81], s[62:63]
    v_pk_add_f32 v[82:83], v[82:83], s[62:63]
    v_pk_add_f32 v[84:85], v[84:85], s[62:63]
    v_pk_add_f32 v[86:87], v[86:87], s[62:63]
    v_pk_fma_f32 v[88:89], v[56:57], v[56:57], s[60:61]
    v_pk_fma_f32 v[90:91], v[58:59], v[58:59], s[60:61]
    v_pk_fma_f32 v[92:93], v[60:61], v[60:61], s[60:61]
    v_pk_fma_f32 v[94:95], v[62:63], v[62:63], s[60:61]
    v_pk_fma_f32 v[96:97], v[64:65], v[64:65], s[60:61]
    v_pk_fma_f32 v[98:99], v[66:67], v[66:67], s[60:61]
    v_pk_fma_f32 v[100:101], v[68:69], v[68:69], s[60:61]
    v_pk_fma_f32 v[102:103], v[70:71], v[70:71], s[60:61]
    v_pk_mul_f32 v[88:89], v[56:57], v[88:89] neg_lo:[1,0] neg_hi:[1,0]
    v_pk_mul_f32 v[90:91], v[58:59], v[90:91] neg_lo:[1,0] neg_hi:[1,0]
    v_pk_mul_f32 v[92:93], v[60:61], v[92:93] neg_lo:[1,0] neg_hi:[1,0]
    v_pk_mul_f32 v[94:95], v[62:63], v[94:95] neg_lo:[1,0] neg_hi:[1,0]
    v_pk_mul_f32 v[96:97], v[64:65], v[96:97] neg_lo:[1,0] neg_hi:[1,0]
    v_pk_mul_f32 v[98:99], v[66:67], v[98:99] neg_lo:[1,0] neg_hi:[1,0]
    v_pk_mul_f32 v[100:101], v[68:69], v[100:101] neg_lo:[1,0] neg_hi:[1,0]
    v_pk_mul_f32 v[102:103], v[70:71], v[102:103] neg_lo:[1,0] neg_hi:[1,0]
    s_setprio 0
    v_cvt_pk_bf16_f32 v104, v24, v25
    v_cvt_pk_bf16_f32 v105, v26, v27
    v_cvt_pk_bf16_f32 v106, v28, v29
    v_cvt_pk_bf16_f32 v107, v30, v31
    v_cvt_pk_bf16_f32 v108, v32, v33
    v_cvt_pk_bf16_f32 v109, v34, v35
    v_cvt_pk_bf16_f32 v110, v36, v37
    v_cvt_pk_bf16_f32 v111, v38, v39
    v_rcp_f32 v72, v72
    v_rcp_f32 v73, v73
    s_waitcnt lgkmcnt(0)
    v_mfma_f32_32x32x16_bf16 v[112:127], v[208:211], v[104:107], v[112:127]
    v_rcp_f32 v74, v74
    v_rcp_f32 v75, v75
    v_rcp_f32 v76, v76
    v_rcp_f32 v77, v77
    v_rcp_f32 v78, v78
    v_mfma_f32_32x32x16_bf16 v[128:143], v[212:215], v[104:107], v[128:143]
    v_rcp_f32 v79, v79
    v_rcp_f32 v80, v80
    v_rcp_f32 v81, v81
    v_rcp_f32 v82, v82
    v_rcp_f32 v83, v83
    v_mfma_f32_32x32x16_bf16 v[144:159], v[216:219], v[104:107], v[144:159]
    v_rcp_f32 v84, v84
    v_rcp_f32 v85, v85
    v_rcp_f32 v86, v86
    v_rcp_f32 v87, v87
    v_exp_f32 v88, v88
    v_mfma_f32_32x32x16_bf16 v[112:127], v[220:223], v[108:111], v[112:127]
    v_exp_f32 v89, v89
    v_exp_f32 v90, v90
    v_exp_f32 v91, v91
    v_exp_f32 v92, v92
    v_exp_f32 v93, v93
    v_mfma_f32_32x32x16_bf16 v[128:143], v[224:227], v[108:111], v[128:143]
    v_exp_f32 v94, v94
    v_exp_f32 v95, v95
    v_exp_f32 v96, v96
    v_exp_f32 v97, v97
    v_exp_f32 v98, v98
    v_mfma_f32_32x32x16_bf16 v[144:159], v[228:231], v[108:111], v[144:159]
    v_exp_f32 v99, v99
    v_exp_f32 v100, v100
    v_exp_f32 v101, v101
    v_exp_f32 v102, v102
    v_exp_f32 v103, v103
    v_add_u32 v233, 61760, v233
    ds_read_b64_tr_b16 v[208:209], v233 offset:0
    ds_read_b64_tr_b16 v[210:211], v233 offset:1552
    ds_read_b64_tr_b16 v[212:213], v233 offset:64
    ds_read_b64_tr_b16 v[214:215], v233 offset:1616
    ds_read_b64_tr_b16 v[216:217], v233 offset:128
    ds_read_b64_tr_b16 v[218:219], v233 offset:1680
    ds_read_b64_tr_b16 v[220:221], v233 offset:3104
    ds_read_b64_tr_b16 v[222:223], v233 offset:4656
    ds_read_b64_tr_b16 v[224:225], v233 offset:3168
    ds_read_b64_tr_b16 v[226:227], v233 offset:4720
    ds_read_b64_tr_b16 v[228:229], v233 offset:3232
    ds_read_b64_tr_b16 v[230:231], v233 offset:4784
    s_setprio 2
    s_nop 0
    v_pk_mul_f32 v[40:41], v[40:41], v[72:73]
    v_pk_mul_f32 v[42:43], v[42:43], v[74:75]
    v_pk_mul_f32 v[44:45], v[44:45], v[76:77]
    v_pk_mul_f32 v[46:47], v[46:47], v[78:79]
    v_pk_mul_f32 v[48:49], v[48:49], v[80:81]
    v_pk_mul_f32 v[50:51], v[50:51], v[82:83]
    v_pk_mul_f32 v[52:53], v[52:53], v[84:85]
    v_pk_mul_f32 v[54:55], v[54:55], v[86:87]
    v_pk_add_f32 v[88:89], v[88:89], s[62:63]
    v_pk_add_f32 v[90:91], v[90:91], s[62:63]
    v_pk_add_f32 v[92:93], v[92:93], s[62:63]
    v_pk_add_f32 v[94:95], v[94:95], s[62:63]
    v_pk_add_f32 v[96:97], v[96:97], s[62:63]
    v_pk_add_f32 v[98:99], v[98:99], s[62:63]
    v_pk_add_f32 v[100:101], v[100:101], s[62:63]
    v_pk_add_f32 v[102:103], v[102:103], s[62:63]
    s_setprio 0
    v_cvt_pk_bf16_f32 v104, v40, v41
    v_cvt_pk_bf16_f32 v105, v42, v43
    v_cvt_pk_bf16_f32 v106, v44, v45
    v_cvt_pk_bf16_f32 v107, v46, v47
    v_cvt_pk_bf16_f32 v108, v48, v49
    v_cvt_pk_bf16_f32 v109, v50, v51
    v_cvt_pk_bf16_f32 v110, v52, v53
    v_cvt_pk_bf16_f32 v111, v54, v55
    v_rcp_f32 v88, v88
    v_rcp_f32 v89, v89
    s_waitcnt lgkmcnt(0)
    v_mfma_f32_32x32x16_bf16 v[112:127], v[208:211], v[104:107], v[112:127]
    v_rcp_f32 v90, v90
    v_rcp_f32 v91, v91
    v_mfma_f32_32x32x16_bf16 v[128:143], v[212:215], v[104:107], v[128:143]
    v_rcp_f32 v92, v92
    v_rcp_f32 v93, v93
    v_rcp_f32 v94, v94
    v_mfma_f32_32x32x16_bf16 v[144:159], v[216:219], v[104:107], v[144:159]
    v_rcp_f32 v95, v95
    v_rcp_f32 v96, v96
    v_mfma_f32_32x32x16_bf16 v[112:127], v[220:223], v[108:111], v[112:127]
    v_rcp_f32 v97, v97
    v_rcp_f32 v98, v98
    v_mfma_f32_32x32x16_bf16 v[128:143], v[224:227], v[108:111], v[128:143]
    v_rcp_f32 v99, v99
    v_rcp_f32 v100, v100
    v_rcp_f32 v101, v101
    v_mfma_f32_32x32x16_bf16 v[144:159], v[228:231], v[108:111], v[144:159]
    v_rcp_f32 v102, v102
    v_rcp_f32 v103, v103
    ds_read_b64_tr_b16 v[208:209], v233 offset:12352
    ds_read_b64_tr_b16 v[210:211], v233 offset:13904
    ds_read_b64_tr_b16 v[212:213], v233 offset:12416
    ds_read_b64_tr_b16 v[214:215], v233 offset:13968
    ds_read_b64_tr_b16 v[216:217], v233 offset:12480
    ds_read_b64_tr_b16 v[218:219], v233 offset:14032
    ds_read_b64_tr_b16 v[220:221], v233 offset:15456
    ds_read_b64_tr_b16 v[222:223], v233 offset:17008
    ds_read_b64_tr_b16 v[224:225], v233 offset:15520
    ds_read_b64_tr_b16 v[226:227], v233 offset:17072
    ds_read_b64_tr_b16 v[228:229], v233 offset:15584
    ds_read_b64_tr_b16 v[230:231], v233 offset:17136
    ds_read_b128 v[24:27], v241 offset:512
    ds_read_b128 v[28:31], v241 offset:528
    ds_read_b128 v[32:35], v241 offset:576
    ds_read_b128 v[36:39], v241 offset:592
    ds_read_b128 v[40:43], v241 offset:640
    ds_read_b128 v[44:47], v241 offset:656
    ds_read_b128 v[48:51], v241 offset:704
    ds_read_b128 v[52:55], v241 offset:720
    ds_read_b128 v[80:83], v241 offset:768
    ds_read_b128 v[84:87], v241 offset:784
    s_setprio 2
    v_pk_mul_f32 v[56:57], v[56:57], v[88:89]
    v_pk_mul_f32 v[58:59], v[58:59], v[90:91]
    v_pk_mul_f32 v[60:61], v[60:61], v[92:93]
    v_pk_mul_f32 v[62:63], v[62:63], v[94:95]
    v_pk_mul_f32 v[64:65], v[64:65], v[96:97]
    v_pk_mul_f32 v[66:67], v[66:67], v[98:99]
    v_pk_mul_f32 v[68:69], v[68:69], v[100:101]
    v_pk_mul_f32 v[70:71], v[70:71], v[102:103]
    v_xor_b32 v246, 32, v254
    s_setprio 0
    ds_read_b128 v[88:91], v241 offset:832
    ds_read_b128 v[92:95], v241 offset:848
    s_waitcnt vmcnt(0)
    v_cvt_pk_bf16_f32 v104, v56, v57
    v_cvt_pk_bf16_f32 v105, v58, v59
    v_cvt_pk_bf16_f32 v106, v60, v61
    v_cvt_pk_bf16_f32 v107, v62, v63
    v_cvt_pk_bf16_f32 v108, v64, v65
    v_cvt_pk_bf16_f32 v109, v66, v67
    v_cvt_pk_bf16_f32 v110, v68, v69
    v_cvt_pk_bf16_f32 v111, v70, v71
    v_lshlrev_b32 v160, 16, v184
    v_and_b32 v161, v7, v184
    s_waitcnt lgkmcnt(12)
    v_mfma_f32_32x32x16_bf16 v[112:127], v[208:211], v[104:107], v[112:127]
    v_lshlrev_b32 v162, 16, v185
    v_and_b32 v163, v7, v185
    v_lshlrev_b32 v164, 16, v186
    v_and_b32 v165, v7, v186
    v_lshlrev_b32 v166, 16, v187
    v_and_b32 v167, v7, v187
    v_lshlrev_b32 v168, 16, v188
    v_and_b32 v169, v7, v188
    v_mfma_f32_32x32x16_bf16 v[112:127], v[220:223], v[108:111], v[112:127]
    v_lshlrev_b32 v170, 16, v189
    v_and_b32 v171, v7, v189
    v_lshlrev_b32 v172, 16, v190
    v_and_b32 v173, v7, v190
    v_lshlrev_b32 v174, 16, v191
    v_and_b32 v175, v7, v191
    v_lshlrev_b32 v176, 16, v192
    v_mfma_f32_32x32x16_bf16 v[128:143], v[212:215], v[104:107], v[128:143]
    v_and_b32 v177, v7, v192
    v_lshlrev_b32 v178, 16, v193
    v_and_b32 v179, v7, v193
    v_lshlrev_b32 v180, 16, v194
    v_and_b32 v181, v7, v194
    v_lshlrev_b32 v182, 16, v195
    v_and_b32 v183, v7, v195
    v_lshlrev_b32 v8, 16, v196
    v_mfma_f32_32x32x16_bf16 v[128:143], v[224:227], v[108:111], v[128:143]
    v_and_b32 v9, v7, v196
    v_lshlrev_b32 v10, 16, v197
    v_and_b32 v11, v7, v197
    v_lshlrev_b32 v12, 16, v198
    v_and_b32 v13, v7, v198
    v_lshlrev_b32 v14, 16, v199
    v_and_b32 v15, v7, v199
    v_lshlrev_b32 v16, 16, v200
    v_mfma_f32_32x32x16_bf16 v[144:159], v[216:219], v[104:107], v[144:159]
    v_and_b32 v17, v7, v200
    v_lshlrev_b32 v18, 16, v201
    v_and_b32 v19, v7, v201
    v_lshlrev_b32 v20, 16, v202
    v_and_b32 v21, v7, v202
    v_lshlrev_b32 v22, 16, v203
    v_and_b32 v23, v7, v203
    v_mfma_f32_32x32x16_bf16 v[144:159], v[228:231], v[108:111], v[144:159]
    v_lshlrev_b32 v72, 16, v204
    v_and_b32 v73, v7, v204
    v_lshlrev_b32 v74, 16, v205
    v_and_b32 v75, v7, v205
    v_lshlrev_b32 v76, 16, v206
    v_and_b32 v77, v7, v206
    v_lshlrev_b32 v78, 16, v207
    v_and_b32 v79, v7, v207
    s_waitcnt lgkmcnt(0)
    v_pk_fma_f32 v[160:161], v[112:113], v[24:25], v[160:161]
    v_pk_fma_f32 v[162:163], v[114:115], v[26:27], v[162:163]
    v_pk_fma_f32 v[164:165], v[116:117], v[28:29], v[164:165]
    v_pk_fma_f32 v[166:167], v[118:119], v[30:31], v[166:167]
    v_cvt_pk_bf16_f32 v208, v160, v161
    v_cvt_pk_bf16_f32 v209, v162, v163
    v_cvt_pk_bf16_f32 v210, v164, v165
    v_cvt_pk_bf16_f32 v211, v166, v167
    ds_write_b128 v254, v[208:211] offset:0
    v_pk_fma_f32 v[168:169], v[120:121], v[32:33], v[168:169]
    v_pk_fma_f32 v[170:171], v[122:123], v[34:35], v[170:171]
    v_pk_fma_f32 v[172:173], v[124:125], v[36:37], v[172:173]
    v_pk_fma_f32 v[174:175], v[126:127], v[38:39], v[174:175]
    v_cvt_pk_bf16_f32 v212, v168, v169
    v_cvt_pk_bf16_f32 v213, v170, v171
    v_cvt_pk_bf16_f32 v214, v172, v173
    v_cvt_pk_bf16_f32 v215, v174, v175
    ds_write_b128 v246, v[212:215] offset:0
    v_pk_fma_f32 v[176:177], v[128:129], v[40:41], v[176:177]
    v_pk_fma_f32 v[178:179], v[130:131], v[42:43], v[178:179]
    v_pk_fma_f32 v[180:181], v[132:133], v[44:45], v[180:181]
    v_pk_fma_f32 v[182:183], v[134:135], v[46:47], v[182:183]
    v_cvt_pk_bf16_f32 v216, v176, v177
    v_cvt_pk_bf16_f32 v217, v178, v179
    v_cvt_pk_bf16_f32 v218, v180, v181
    v_cvt_pk_bf16_f32 v219, v182, v183
    ds_write_b128 v254, v[216:219] offset:64
    v_pk_fma_f32 v[8:9], v[136:137], v[48:49], v[8:9]
    v_pk_fma_f32 v[10:11], v[138:139], v[50:51], v[10:11]
    v_pk_fma_f32 v[12:13], v[140:141], v[52:53], v[12:13]
    v_pk_fma_f32 v[14:15], v[142:143], v[54:55], v[14:15]
    v_cvt_pk_bf16_f32 v220, v8, v9
    v_cvt_pk_bf16_f32 v221, v10, v11
    v_cvt_pk_bf16_f32 v222, v12, v13
    v_cvt_pk_bf16_f32 v223, v14, v15
    ds_write_b128 v246, v[220:223] offset:64
    v_pk_fma_f32 v[16:17], v[144:145], v[80:81], v[16:17]
    v_pk_fma_f32 v[18:19], v[146:147], v[82:83], v[18:19]
    v_pk_fma_f32 v[20:21], v[148:149], v[84:85], v[20:21]
    v_pk_fma_f32 v[22:23], v[150:151], v[86:87], v[22:23]
    v_cvt_pk_bf16_f32 v224, v16, v17
    v_cvt_pk_bf16_f32 v225, v18, v19
    v_cvt_pk_bf16_f32 v226, v20, v21
    v_cvt_pk_bf16_f32 v227, v22, v23
    ds_write_b128 v254, v[224:227] offset:128
    v_pk_fma_f32 v[72:73], v[152:153], v[88:89], v[72:73]
    v_pk_fma_f32 v[74:75], v[154:155], v[90:91], v[74:75]
    v_pk_fma_f32 v[76:77], v[156:157], v[92:93], v[76:77]
    v_pk_fma_f32 v[78:79], v[158:159], v[94:95], v[78:79]
    v_cvt_pk_bf16_f32 v228, v72, v73
    v_cvt_pk_bf16_f32 v229, v74, v75
    v_cvt_pk_bf16_f32 v230, v76, v77
    v_cvt_pk_bf16_f32 v231, v78, v79
    ds_write_b128 v246, v[228:231] offset:128
    s_waitcnt lgkmcnt(0)
    ds_read_b128 v[184:187], v243 offset:0
    ds_read_b128 v[188:191], v243 offset:1024
    ds_read_b128 v[192:195], v243 offset:2048
    ds_read_b128 v[196:199], v243 offset:3072
    ds_read_b128 v[200:203], v243 offset:4096
    ds_read_b128 v[204:207], v243 offset:5120
    s_waitcnt lgkmcnt(5)
    buffer_store_dwordx4 v[184:187], v248, s[36:39], s55 offen sc1
    s_waitcnt lgkmcnt(4)
    buffer_store_dwordx4 v[188:191], v249, s[36:39], s55 offen sc1
    s_waitcnt lgkmcnt(3)
    buffer_store_dwordx4 v[192:195], v250, s[36:39], s55 offen sc1
    s_waitcnt lgkmcnt(2)
    buffer_store_dwordx4 v[196:199], v251, s[36:39], s55 offen sc1
    s_waitcnt lgkmcnt(1)
    buffer_store_dwordx4 v[200:203], v252, s[36:39], s55 offen sc1
    s_waitcnt lgkmcnt(0)
    buffer_store_dwordx4 v[204:207], v253, s[36:39], s55 offen sc1
    s_endpgm
L_narrow:
    s_lshl_b32 s47, s56, 7
    s_sub_u32 s47, 512, s47
    v_add_u32 v182, s47, v234
    v_add_u32_e64 v183, s47, v235
    ds_read_b64 v[84:85], v234 offset:0
    ds_read_b64 v[86:87], v234 offset:13888
    ds_read_b64 v[88:89], v234 offset:27776
    ds_read_b64 v[90:91], v234 offset:41664
    ds_read_b64 v[92:93], v235 offset:0
    ds_read_b64 v[94:95], v235 offset:13888
    ds_read_b64 v[156:157], v182 offset:0
    ds_read_b64 v[158:159], v182 offset:13888
    ds_read_b64 v[160:161], v182 offset:27776
    ds_read_b64 v[162:163], v182 offset:41664
    ds_read_b64 v[164:165], v183 offset:0
    ds_read_b64 v[166:167], v183 offset:13888
    s_mov_b32 exec_hi, 0xffff
    s_add_u32 m0, s57, 24704
    s_movk_i32 s59, 128
    buffer_load_dwordx4 v236, s[28:31], s59 offen lds
    s_add_u32 m0, s57, 37056
    s_movk_i32 s59, 192
    buffer_load_dwordx4 v236, s[28:31], s59 offen lds
    s_mov_b32 exec_hi, -1
    s_waitcnt lgkmcnt(10)
    v_lshlrev_b32 v16, 16, v84
    v_and_b32 v17, v7, v84
    v_lshlrev_b32 v18, 16, v85
    v_and_b32 v19, v7, v85
    v_lshlrev_b32 v20, 16, v86
    v_and_b32 v21, v7, v86
    v_lshlrev_b32 v22, 16, v87
    v_and_b32 v23, v7, v87
    s_waitcnt lgkmcnt(8)
    v_lshlrev_b32 v24, 16, v88
    v_and_b32 v25, v7, v88
    v_lshlrev_b32 v26, 16, v89
    v_and_b32 v27, v7, v89
    v_lshlrev_b32 v28, 16, v90
    v_and_b32 v29, v7, v90
    v_lshlrev_b32 v30, 16, v91
    v_and_b32 v31, v7, v91
    s_waitcnt lgkmcnt(6)
    v_lshlrev_b32 v32, 16, v92
    v_and_b32 v33, v7, v92
    v_lshlrev_b32 v34, 16, v93
    v_and_b32 v35, v7, v93
    v_lshlrev_b32 v36, 16, v94
    v_and_b32 v37, v7, v94
    v_lshlrev_b32 v38, 16, v95
    v_and_b32 v39, v7, v95
    s_waitcnt lgkmcnt(4)
    s_mov_b32 exec_hi, 0xffff
    s_add_u32 m0, s58, 0
    s_mov_b32 s59, 0
    buffer_load_dwordx4 v242, s[32:35], s59 offen lds
    s_add_u32 m0, s57, 49408
    s_movk_i32 s59, 256
    buffer_load_dwordx4 v236, s[28:31], s59 offen lds
    s_mov_b32 exec_hi, -1
    v_lshlrev_b32 v104, 16, v156
    v_and_b32 v105, v7, v156
    v_lshlrev_b32 v106, 16, v157
    v_and_b32 v107, v7, v157
    v_lshlrev_b32 v108, 16, v158
    v_and_b32 v109, v7, v158
    v_lshlrev_b32 v110, 16, v159
    v_and_b32 v111, v7, v159
    s_waitcnt lgkmcnt(2)
    v_lshlrev_b32 v112, 16, v160
    v_and_b32 v113, v7, v160
    v_lshlrev_b32 v114, 16, v161
    v_and_b32 v115, v7, v161
    v_lshlrev_b32 v116, 16, v162
    v_and_b32 v117, v7, v162
    v_lshlrev_b32 v118, 16, v163
    v_and_b32 v119, v7, v163
    s_waitcnt lgkmcnt(0)
    v_lshlrev_b32 v120, 16, v164
    v_and_b32 v121, v7, v164
    v_lshlrev_b32 v122, 16, v165
    v_and_b32 v123, v7, v165
    v_lshlrev_b32 v124, 16, v166
    v_and_b32 v125, v7, v166
    v_lshlrev_b32 v126, 16, v167
    v_and_b32 v127, v7, v167
    s_mov_b32 exec_hi, 0xffff
    s_add_u32 m0, s58, 12352
    s_mov_b32 s59, 6144
    buffer_load_dwordx4 v242, s[32:35], s59 offen lds
    s_mov_b32 exec_hi, -1
    v_mov_b32 v176, 1027751813
    v_pk_mul_f32 v[172:173], v[16:17], v[16:17]
    v_pk_mul_f32 v[174:175], v[104:105], v[104:105]
    v_pk_fma_f32 v[172:173], v[18:19], v[18:19], v[172:173]
    v_pk_fma_f32 v[174:175], v[106:107], v[106:107], v[174:175]
    v_pk_add_f32 v[168:169], v[16:17], v[18:19]
    v_pk_add_f32 v[170:171], v[104:105], v[106:107]
    v_pk_fma_f32 v[172:173], v[20:21], v[20:21], v[172:173]
    v_pk_fma_f32 v[174:175], v[108:109], v[108:109], v[174:175]
    v_pk_add_f32 v[168:169], v[168:169], v[20:21]
    v_pk_add_f32 v[170:171], v[170:171], v[108:109]
    v_pk_fma_f32 v[172:173], v[22:23], v[22:23], v[172:173]
    v_pk_fma_f32 v[174:175], v[110:111], v[110:111], v[174:175]
    v_pk_add_f32 v[168:169], v[168:169], v[22:23]
    v_pk_add_f32 v[170:171], v[170:171], v[110:111]
    v_pk_fma_f32 v[172:173], v[24:25], v[24:25], v[172:173]
    v_pk_fma_f32 v[174:175], v[112:113], v[112:113], v[174:175]
    v_pk_add_f32 v[168:169], v[168:169], v[24:25]
    v_pk_add_f32 v[170:171], v[170:171], v[112:113]
    v_pk_fma_f32 v[172:173], v[26:27], v[26:27], v[172:173]
    v_pk_fma_f32 v[174:175], v[114:115], v[114:115], v[174:175]
    v_pk_add_f32 v[168:169], v[168:169], v[26:27]
    v_pk_add_f32 v[170:171], v[170:171], v[114:115]
    v_pk_fma_f32 v[172:173], v[28:29], v[28:29], v[172:173]
    v_pk_fma_f32 v[174:175], v[116:117], v[116:117], v[174:175]
    v_pk_add_f32 v[168:169], v[168:169], v[28:29]
    v_pk_add_f32 v[170:171], v[170:171], v[116:117]
    v_pk_fma_f32 v[172:173], v[30:31], v[30:31], v[172:173]
    v_pk_fma_f32 v[174:175], v[118:119], v[118:119], v[174:175]
    v_pk_add_f32 v[168:169], v[168:169], v[30:31]
    v_pk_add_f32 v[170:171], v[170:171], v[118:119]
    v_pk_fma_f32 v[172:173], v[32:33], v[32:33], v[172:173]
    v_pk_fma_f32 v[174:175], v[120:121], v[120:121], v[174:175]
    v_pk_add_f32 v[168:169], v[168:169], v[32:33]
    v_pk_add_f32 v[170:171], v[170:171], v[120:121]
    v_pk_fma_f32 v[172:173], v[34:35], v[34:35], v[172:173]
    v_pk_fma_f32 v[174:175], v[122:123], v[122:123], v[174:175]
    v_pk_add_f32 v[168:169], v[168:169], v[34:35]
    v_pk_add_f32 v[170:171], v[170:171], v[122:123]
    v_pk_fma_f32 v[172:173], v[36:37], v[36:37], v[172:173]
    v_pk_fma_f32 v[174:175], v[124:125], v[124:125], v[174:175]
    v_pk_add_f32 v[168:169], v[168:169], v[36:37]
    v_pk_add_f32 v[170:171], v[170:171], v[124:125]
    v_pk_fma_f32 v[172:173], v[38:39], v[38:39], v[172:173]
    v_pk_fma_f32 v[174:175], v[126:127], v[126:127], v[174:175]
    v_pk_add_f32 v[168:169], v[168:169], v[38:39]
    v_pk_add_f32 v[170:171], v[170:171], v[126:127]
    v_add_f32 v168, v168, v169
    v_add_f32 v172, v172, v173
    v_add_f32 v170, v170, v171
    v_add_f32 v174, v174, v175
    v_permlane32_swap_b32 v168, v172
    ds_read_b128 v[8:11], v240 offset:0
    v_permlane32_swap_b32 v170, v174
    v_add_f32 v168, v168, v172
    v_add_f32 v170, v170, v174
    ds_read_b128 v[12:15], v240 offset:64
    ds_read_b64_tr_b16 v[184:185], v232 offset:0
    v_permlane16_swap_b32 v168, v170
    v_add_f32 v172, v168, v170
    v_add_f32 v168, v168, v170
    ds_read_b64_tr_b16 v[186:187], v232 offset:1024
    ds_read_b64_tr_b16 v[188:189], v232 offset:2048
    v_permlane32_swap_b32 v168, v172
    v_mul_f32 v170, 1018565494, v168
    v_fmaak_f32 v172, v172, v176, 0x383ef424
    v_mul_f32 v168, 3156912811, v168
    v_fma_f32 v172, -v170, v170, v172
    v_max_f32 v172, 943649828, v172
    v_rsq_f32 v172, v172
    ds_read_b64_tr_b16 v[190:191], v232 offset:3072
    v_mov_b32 v174, v172
    v_mul_f32 v170, v168, v172
    v_mul_f32 v168, v168, v172
    v_permlane16_swap_b32 v172, v174
    ds_read_b64_tr_b16 v[192:193], v232 offset:4096
    v_permlane16_swap_b32 v168, v170
    v_cndmask_b32 v174, 0, v174, s[52:53]
    v_cndmask_b32 v170, 0, v170, s[52:53]
    v_pk_fma_f32 v[16:17], v[16:17], v[172:173], v[168:169] op_sel_hi:[1,0,0]
    v_pk_fma_f32 v[18:19], v[18:19], v[172:173], v[168:169] op_sel_hi:[1,0,0]
    v_pk_fma_f32 v[20:21], v[20:21], v[172:173], v[168:169] op_sel_hi:[1,0,0]
    v_pk_fma_f32 v[22:23], v[22:23], v[172:173], v[168:169] op_sel_hi:[1,0,0]
    v_pk_fma_f32 v[24:25], v[24:25], v[172:173], v[168:169] op_sel_hi:[1,0,0]
    v_pk_fma_f32 v[26:27], v[26:27], v[172:173], v[168:169] op_sel_hi:[1,0,0]
    v_pk_fma_f32 v[28:29], v[28:29], v[172:173], v[168:169] op_sel_hi:[1,0,0]
    v_pk_fma_f32 v[30:31], v[30:31], v[172:173], v[168:169] op_sel_hi:[1,0,0]
    v_pk_fma_f32 v[32:33], v[32:33], v[172:173], v[168:169] op_sel_hi:[1,0,0]
    v_pk_fma_f32 v[34:35], v[34:35], v[172:173], v[168:169] op_sel_hi:[1,0,0]
    v_pk_fma_f32 v[36:37], v[36:37], v[172:173], v[168:169] op_sel_hi:[1,0,0]
    v_pk_fma_f32 v[38:39], v[38:39], v[172:173], v[168:169] op_sel_hi:[1,0,0]
    v_pk_fma_f32 v[104:105], v[104:105], v[174:175], v[170:171] op_sel_hi:[1,0,0]
    v_pk_fma_f32 v[106:107], v[106:107], v[174:175], v[170:171] op_sel_hi:[1,0,0]
    v_pk_fma_f32 v[108:109], v[108:109], v[174:175], v[170:171] op_sel_hi:[1,0,0]
    v_pk_fma_f32 v[110:111], v[110:111], v[174:175], v[170:171] op_sel_hi:[1,0,0]
    v_pk_fma_f32 v[112:113], v[112:113], v[174:175], v[170:171] op_sel_hi:[1,0,0]
    v_pk_fma_f32 v[114:115], v[114:115], v[174:175], v[170:171] op_sel_hi:[1,0,0]
    v_pk_fma_f32 v[116:117], v[116:117], v[174:175], v[170:171] op_sel_hi:[1,0,0]
    v_pk_fma_f32 v[118:119], v[118:119], v[174:175], v[170:171] op_sel_hi:[1,0,0]
    v_pk_fma_f32 v[120:121], v[120:121], v[174:175], v[170:171] op_sel_hi:[1,0,0]
    v_pk_fma_f32 v[122:123], v[122:123], v[174:175], v[170:171] op_sel_hi:[1,0,0]
    v_pk_fma_f32 v[124:125], v[124:125], v[174:175], v[170:171] op_sel_hi:[1,0,0]
    v_pk_fma_f32 v[126:127], v[126:127], v[174:175], v[170:171] op_sel_hi:[1,0,0]
    ds_read_b64_tr_b16 v[194:195], v232 offset:5120
    ds_read_b64_tr_b16 v[196:197], v237 offset:0
    ds_read_b64_tr_b16 v[198:199], v237 offset:1024
    ds_read_b64_tr_b16 v[200:201], v237 offset:2048
    ds_read_b64_tr_b16 v[202:203], v237 offset:3072
    ds_read_b64_tr_b16 v[204:205], v237 offset:4096
    ds_read_b64_tr_b16 v[206:207], v237 offset:5120
    ds_read_b128 v[96:99], v240 offset:0
    ds_read_b128 v[100:103], v240 offset:64
    s_waitcnt vmcnt(0) lgkmcnt(0)
    s_barrier
    v_cvt_pk_bf16_f32 v84, v16, v17
    v_cvt_pk_bf16_f32 v85, v18, v19
    v_cvt_pk_bf16_f32 v86, v20, v21
    v_cvt_pk_bf16_f32 v87, v22, v23
    v_cvt_pk_bf16_f32 v88, v24, v25
    v_cvt_pk_bf16_f32 v89, v26, v27
    v_mfma_f32_16x16x32_bf16 v[8:11], v[184:187], v[84:87], v[8:11]
    v_cvt_pk_bf16_f32 v90, v28, v29
    v_cvt_pk_bf16_f32 v91, v30, v31
    v_cvt_pk_bf16_f32 v92, v32, v33
    v_cvt_pk_bf16_f32 v93, v34, v35
    v_mfma_f32_16x16x32_bf16 v[8:11], v[188:191], v[88:91], v[8:11]
    v_cvt_pk_bf16_f32 v94, v36, v37
    v_cvt_pk_bf16_f32 v95, v38, v39
    v_cvt_pk_bf16_f32 v156, v104, v105
    v_cvt_pk_bf16_f32 v157, v106, v107
    v_mfma_f32_16x16x32_bf16 v[8:11], v[192:195], v[92:95], v[8:11]
    v_cvt_pk_bf16_f32 v158, v108, v109
    v_cvt_pk_bf16_f32 v159, v110, v111
    v_cvt_pk_bf16_f32 v160, v112, v113
    v_cvt_pk_bf16_f32 v161, v114, v115
    v_mfma_f32_16x16x32_bf16 v[12:15], v[196:199], v[84:87], v[12:15]
    v_cvt_pk_bf16_f32 v162, v116, v117
    v_cvt_pk_bf16_f32 v163, v118, v119
    v_cvt_pk_bf16_f32 v164, v120, v121
    v_cvt_pk_bf16_f32 v165, v122, v123
    v_mfma_f32_16x16x32_bf16 v[12:15], v[200:203], v[88:91], v[12:15]
    v_cvt_pk_bf16_f32 v166, v124, v125
    v_cvt_pk_bf16_f32 v167, v126, v127
    v_mfma_f32_16x16x32_bf16 v[12:15], v[204:207], v[92:95], v[12:15]
    s_cmp_eq_u32 s44, 1
    s_cbranch_scc1 L_n1
    s_cmp_eq_u32 s44, 2
    s_cbranch_scc1 L_n2
    s_cmp_eq_u32 s44, 3
    s_cbranch_scc1 L_n3
    v_mfma_f32_16x16x32_bf16 v[96:99], v[184:187], v[156:159], v[96:99]
    v_mfma_f32_16x16x32_bf16 v[96:99], v[188:191], v[160:163], v[96:99]
    v_mfma_f32_16x16x32_bf16 v[96:99], v[192:195], v[164:167], v[96:99]
    v_mfma_f32_16x16x32_bf16 v[100:103], v[196:199], v[156:159], v[100:103]
    v_mfma_f32_16x16x32_bf16 v[100:103], v[200:203], v[160:163], v[100:103]
    v_mfma_f32_16x16x32_bf16 v[100:103], v[204:207], v[164:167], v[100:103]
    ds_read_b128 v[16:19], v240 offset:128
    ds_read_b128 v[20:23], v240 offset:192
    ds_read_b64_tr_b16 v[184:185], v232 offset:12352
    ds_read_b64_tr_b16 v[186:187], v232 offset:13376
    ds_read_b64_tr_b16 v[188:189], v232 offset:14400
    ds_read_b64_tr_b16 v[190:191], v232 offset:15424
    ds_read_b64_tr_b16 v[192:193], v232 offset:16448
    ds_read_b64_tr_b16 v[194:195], v232 offset:17472
    ds_read_b64_tr_b16 v[196:197], v237 offset:12352
    ds_read_b64_tr_b16 v[198:199], v237 offset:13376
    ds_read_b64_tr_b16 v[200:201], v237 offset:14400
    ds_read_b64_tr_b16 v[202:203], v237 offset:15424
    ds_read_b64_tr_b16 v[204:205], v237 offset:16448
    ds_read_b64_tr_b16 v[206:207], v237 offset:17472
    s_mov_b32 exec_hi, 0xffff
    s_add_u32 m0, s57, 61760
    s_movk_i32 s59, 320
    buffer_load_dwordx4 v236, s[28:31], s59 offen lds
    s_add_u32 m0, s58, 24704
    s_mov_b32 s59, 12288
    buffer_load_dwordx4 v242, s[32:35], s59 offen lds
    s_add_u32 m0, s57, 74112
    s_movk_i32 s59, 384
    buffer_load_dwordx4 v236, s[28:31], s59 offen lds
    s_mov_b32 exec_hi, -1
    s_setprio 2
    v_pk_fma_f32 v[40:41], v[8:9], v[8:9], s[60:61]
    v_pk_fma_f32 v[42:43], v[10:11], v[10:11], s[60:61]
    v_pk_fma_f32 v[44:45], v[12:13], v[12:13], s[60:61]
    v_pk_fma_f32 v[46:47], v[14:15], v[14:15], s[60:61]
    v_pk_mul_f32 v[40:41], v[8:9], v[40:41] neg_lo:[1,0] neg_hi:[1,0]
    v_pk_mul_f32 v[42:43], v[10:11], v[42:43] neg_lo:[1,0] neg_hi:[1,0]
    v_pk_mul_f32 v[44:45], v[12:13], v[44:45] neg_lo:[1,0] neg_hi:[1,0]
    v_pk_mul_f32 v[46:47], v[14:15], v[46:47] neg_lo:[1,0] neg_hi:[1,0]
    v_pk_fma_f32 v[112:113], v[96:97], v[96:97], s[60:61]
    v_pk_fma_f32 v[114:115], v[98:99], v[98:99], s[60:61]
    v_pk_fma_f32 v[116:117], v[100:101], v[100:101], s[60:61]
    v_pk_fma_f32 v[118:119], v[102:103], v[102:103], s[60:61]
    v_pk_mul_f32 v[112:113], v[96:97], v[112:113] neg_lo:[1,0] neg_hi:[1,0]
    v_pk_mul_f32 v[114:115], v[98:99], v[114:115] neg_lo:[1,0] neg_hi:[1,0]
    v_pk_mul_f32 v[116:117], v[100:101], v[116:117] neg_lo:[1,0] neg_hi:[1,0]
    v_pk_mul_f32 v[118:119], v[102:103], v[118:119] neg_lo:[1,0] neg_hi:[1,0]
    v_exp_f32 v40, v40
    s_waitcnt lgkmcnt(0)
    v_mfma_f32_16x16x32_bf16 v[16:19], v[184:187], v[84:87], v[16:19]
    v_exp_f32 v41, v41
    v_exp_f32 v42, v42
    v_exp_f32 v43, v43
    v_mfma_f32_16x16x32_bf16 v[16:19], v[188:191], v[88:91], v[16:19]
    v_exp_f32 v44, v44
    v_exp_f32 v45, v45
    v_mfma_f32_16x16x32_bf16 v[16:19], v[192:195], v[92:95], v[16:19]
    v_exp_f32 v46, v46
    v_exp_f32 v47, v47
    v_exp_f32 v112, v112
    v_mfma_f32_16x16x32_bf16 v[20:23], v[196:199], v[84:87], v[20:23]
    v_exp_f32 v113, v113
    v_exp_f32 v114, v114
    v_mfma_f32_16x16x32_bf16 v[20:23], v[200:203], v[88:91], v[20:23]
    v_exp_f32 v115, v115
    v_exp_f32 v116, v116
    v_exp_f32 v117, v117
    v_mfma_f32_16x16x32_bf16 v[20:23], v[204:207], v[92:95], v[20:23]
    v_exp_f32 v118, v118
    v_exp_f32_e64 v119, v119
    ds_read_b128 v[24:27], v240 offset:256
    ds_read_b128 v[28:31], v240 offset:320
    ds_read_b64_tr_b16 v[184:185], v232 offset:24704
    ds_read_b64_tr_b16 v[186:187], v232 offset:25728
    ds_read_b64_tr_b16 v[188:189], v232 offset:26752
    ds_read_b64_tr_b16 v[190:191], v232 offset:27776
    ds_read_b64_tr_b16 v[192:193], v232 offset:28800
    ds_read_b64_tr_b16 v[194:195], v232 offset:29824
    ds_read_b64_tr_b16 v[196:197], v237 offset:24704
    ds_read_b64_tr_b16 v[198:199], v237 offset:25728
    ds_read_b64_tr_b16 v[200:201], v237 offset:26752
    ds_read_b64_tr_b16 v[202:203], v237 offset:27776
    ds_read_b64_tr_b16 v[204:205], v237 offset:28800
    ds_read_b64_tr_b16 v[206:207], v237 offset:29824
    ds_read_b128 v[60:63], v241 offset:0
    ds_read_b128 v[64:67], v241 offset:16
    ds_read_b128 v[68:71], v241 offset:128
    ds_read_b128 v[72:75], v241 offset:144
    ds_read_b128 v[76:79], v241 offset:256
    ds_read_b128 v[80:83], v241 offset:272
    ds_read_b128 v[132:135], v241 offset:0
    ds_read_b128 v[136:139], v241 offset:16
    ds_read_b128 v[140:143], v241 offset:128
    ds_read_b128 v[144:147], v241 offset:144
    ds_read_b128 v[148:151], v241 offset:256
    ds_read_b128 v[152:155], v241 offset:272
    s_mov_b32 exec_hi, 0xffff
    s_add_u32 m0, s58, 37056
    s_mov_b32 s59, 18432
    buffer_load_dwordx4 v242, s[32:35], s59 offen lds
    s_add_u32 m0, s57, 86464
    s_movk_i32 s59, 448
    buffer_load_dwordx4 v236, s[28:31], s59 offen lds
    s_add_u32 m0, s58, 49408
    s_mov_b32 s59, 24576
    buffer_load_dwordx4 v242, s[32:35], s59 offen lds
    s_mov_b32 exec_hi, -1
    v_pk_add_f32 v[40:41], v[40:41], s[62:63]
    v_pk_add_f32 v[42:43], v[42:43], s[62:63]
    v_pk_add_f32 v[44:45], v[44:45], s[62:63]
    v_pk_add_f32 v[46:47], v[46:47], s[62:63]
    v_pk_add_f32 v[112:113], v[112:113], s[62:63]
    v_pk_add_f32 v[114:115], v[114:115], s[62:63]
    v_pk_add_f32 v[116:117], v[116:117], s[62:63]
    v_pk_add_f32 v[118:119], v[118:119], s[62:63]
    v_pk_fma_f32 v[48:49], v[16:17], v[16:17], s[60:61]
    v_pk_fma_f32 v[50:51], v[18:19], v[18:19], s[60:61]
    v_pk_fma_f32 v[52:53], v[20:21], v[20:21], s[60:61]
    v_pk_fma_f32 v[54:55], v[22:23], v[22:23], s[60:61]
    v_pk_mul_f32 v[48:49], v[16:17], v[48:49] neg_lo:[1,0] neg_hi:[1,0]
    v_pk_mul_f32 v[50:51], v[18:19], v[50:51] neg_lo:[1,0] neg_hi:[1,0]
    v_pk_mul_f32 v[52:53], v[20:21], v[52:53] neg_lo:[1,0] neg_hi:[1,0]
    v_pk_mul_f32 v[54:55], v[22:23], v[54:55] neg_lo:[1,0] neg_hi:[1,0]
    v_rcp_f32 v40, v40
    s_waitcnt lgkmcnt(12)
    v_mfma_f32_16x16x32_bf16 v[24:27], v[184:187], v[84:87], v[24:27]
    v_rcp_f32 v41, v41
    v_rcp_f32 v42, v42
    v_rcp_f32 v43, v43
    v_rcp_f32 v44, v44
    v_mfma_f32_16x16x32_bf16 v[24:27], v[188:191], v[88:91], v[24:27]
    v_rcp_f32 v45, v45
    v_rcp_f32 v46, v46
    v_rcp_f32 v47, v47
    v_exp_f32 v48, v48
    v_mfma_f32_16x16x32_bf16 v[24:27], v[192:195], v[92:95], v[24:27]
    v_exp_f32 v49, v49
    v_exp_f32 v50, v50
    v_exp_f32 v51, v51
    v_exp_f32 v52, v52
    v_mfma_f32_16x16x32_bf16 v[28:31], v[196:199], v[84:87], v[28:31]
    v_exp_f32 v53, v53
    v_exp_f32 v54, v54
    v_exp_f32 v55, v55
    v_mfma_f32_16x16x32_bf16 v[28:31], v[200:203], v[88:91], v[28:31]
    v_rcp_f32 v112, v112
    v_rcp_f32 v113, v113
    v_rcp_f32 v114, v114
    v_rcp_f32 v115, v115
    v_mfma_f32_16x16x32_bf16 v[28:31], v[204:207], v[92:95], v[28:31]
    v_rcp_f32 v116, v116
    v_rcp_f32 v117, v117
    v_rcp_f32 v118, v118
    v_rcp_f32_e64 v119, v119
    ds_read_b128 v[32:35], v240 offset:384
    ds_read_b128 v[36:39], v240 offset:448
    ds_read_b64_tr_b16 v[184:185], v232 offset:37056
    ds_read_b64_tr_b16 v[186:187], v232 offset:38080
    ds_read_b64_tr_b16 v[188:189], v232 offset:39104
    ds_read_b64_tr_b16 v[190:191], v232 offset:40128
    ds_read_b64_tr_b16 v[192:193], v232 offset:41152
    ds_read_b64_tr_b16 v[194:195], v232 offset:42176
    ds_read_b64_tr_b16 v[196:197], v237 offset:37056
    ds_read_b64_tr_b16 v[198:199], v237 offset:38080
    ds_read_b64_tr_b16 v[200:201], v237 offset:39104
    ds_read_b64_tr_b16 v[202:203], v237 offset:40128
    ds_read_b64_tr_b16 v[204:205], v237 offset:41152
    ds_read_b64_tr_b16 v[206:207], v237 offset:42176
    ds_read_b64_tr_b16 v[208:209], v233 offset:0
    ds_read_b64_tr_b16 v[210:211], v233 offset:3104
    ds_read_b64_tr_b16 v[212:213], v233 offset:8
    ds_read_b64_tr_b16 v[214:215], v233 offset:3112
    ds_read_b64_tr_b16 v[216:217], v233 offset:64
    ds_read_b64_tr_b16 v[218:219], v233 offset:3168
    ds_read_b64_tr_b16 v[220:221], v233 offset:72
    ds_read_b64_tr_b16 v[222:223], v233 offset:3176
    ds_read_b64_tr_b16 v[224:225], v233 offset:128
    ds_read_b64_tr_b16 v[226:227], v233 offset:3232
    ds_read_b64_tr_b16 v[228:229], v233 offset:136
    ds_read_b64_tr_b16 v[230:231], v233 offset:3240
    s_waitcnt vmcnt(0)
    v_mov_b32 v4, 5
    ds_write_b32 v244, v4
    s_mov_b32 exec_hi, 0xffff
    s_add_u32 m0, s57, 98816
    s_movk_i32 s59, 512
    buffer_load_dwordx4 v236, s[28:31], s59 offen lds
    s_add_u32 m0, s58, 61760
    s_mov_b32 s59, 30720
    buffer_load_dwordx4 v242, s[32:35], s59 offen lds
    s_mov_b32 exec_hi, -1
    v_pk_mul_f32 v[8:9], v[8:9], v[40:41]
    v_pk_mul_f32 v[10:11], v[10:11], v[42:43]
    v_pk_mul_f32 v[12:13], v[12:13], v[44:45]
    v_pk_mul_f32 v[14:15], v[14:15], v[46:47]
    v_pk_add_f32 v[48:49], v[48:49], s[62:63]
    v_pk_add_f32 v[50:51], v[50:51], s[62:63]
    v_pk_add_f32 v[52:53], v[52:53], s[62:63]
    v_pk_add_f32 v[54:55], v[54:55], s[62:63]
    v_pk_mul_f32 v[96:97], v[96:97], v[112:113]
    v_pk_mul_f32 v[98:99], v[98:99], v[114:115]
    v_pk_mul_f32 v[100:101], v[100:101], v[116:117]
    v_pk_mul_f32 v[102:103], v[102:103], v[118:119]
    v_pk_fma_f32 v[40:41], v[24:25], v[24:25], s[60:61]
    v_pk_fma_f32 v[42:43], v[26:27], v[26:27], s[60:61]
    v_pk_fma_f32 v[44:45], v[28:29], v[28:29], s[60:61]
    v_pk_fma_f32 v[46:47], v[30:31], v[30:31], s[60:61]
    v_pk_mul_f32 v[40:41], v[24:25], v[40:41] neg_lo:[1,0] neg_hi:[1,0]
    v_pk_mul_f32 v[42:43], v[26:27], v[42:43] neg_lo:[1,0] neg_hi:[1,0]
    v_pk_mul_f32 v[44:45], v[28:29], v[44:45] neg_lo:[1,0] neg_hi:[1,0]
    v_pk_mul_f32 v[46:47], v[30:31], v[46:47] neg_lo:[1,0] neg_hi:[1,0]
    v_rcp_f32 v48, v48
    s_waitcnt lgkmcnt(13)
    v_mfma_f32_16x16x32_bf16 v[32:35], v[184:187], v[84:87], v[32:35]
    v_cvt_pk_bf16_f32 v56, v8, v9
    v_cvt_pk_bf16_f32 v57, v10, v11
    v_mfma_f32_16x16x32_bf16 v[32:35], v[188:191], v[88:91], v[32:35]
    v_rcp_f32 v49, v49
    v_mfma_f32_16x16x32_bf16 v[32:35], v[192:195], v[92:95], v[32:35]
    v_cvt_pk_bf16_f32 v58, v12, v13
    v_cvt_pk_bf16_f32 v59, v14, v15
    v_mfma_f32_16x16x32_bf16 v[36:39], v[196:199], v[84:87], v[36:39]
    v_rcp_f32 v50, v50
    v_mfma_f32_16x16x32_bf16 v[36:39], v[200:203], v[88:91], v[36:39]
    v_cvt_pk_bf16_f32 v120, v96, v97
    v_cvt_pk_bf16_f32 v121, v98, v99
    v_mfma_f32_16x16x32_bf16 v[36:39], v[204:207], v[92:95], v[36:39]
    v_rcp_f32 v51, v51
    v_cvt_pk_bf16_f32 v122, v100, v101
    s_waitcnt lgkmcnt(0)
    v_mfma_f32_16x16x32_bf16 v[60:63], v[208:211], v[56:59], v[60:63]
    v_cvt_pk_bf16_f32 v123, v102, v103
    v_mfma_f32_16x16x32_bf16 v[64:67], v[212:215], v[56:59], v[64:67]
    v_rcp_f32 v52, v52
    v_mfma_f32_16x16x32_bf16 v[68:71], v[216:219], v[56:59], v[68:71]
    v_rcp_f32 v53, v53
    v_rcp_f32 v54, v54
    v_mfma_f32_16x16x32_bf16 v[72:75], v[220:223], v[56:59], v[72:75]
    v_rcp_f32 v55, v55
    v_mfma_f32_16x16x32_bf16 v[76:79], v[224:227], v[56:59], v[76:79]
    v_exp_f32 v40, v40
    v_mfma_f32_16x16x32_bf16 v[80:83], v[228:231], v[56:59], v[80:83]
    v_exp_f32 v41, v41
    v_mfma_f32_16x16x32_bf16 v[132:135], v[208:211], v[120:123], v[132:135]
    v_exp_f32 v42, v42
    v_mfma_f32_16x16x32_bf16 v[136:139], v[212:215], v[120:123], v[136:139]
    v_exp_f32 v43, v43
    v_mfma_f32_16x16x32_bf16 v[140:143], v[216:219], v[120:123], v[140:143]
    v_exp_f32 v44, v44
    v_mfma_f32_16x16x32_bf16 v[144:147], v[220:223], v[120:123], v[144:147]
    v_exp_f32 v45, v45
    v_mfma_f32_16x16x32_bf16 v[148:151], v[224:227], v[120:123], v[148:151]
    v_exp_f32 v46, v46
    v_mfma_f32_16x16x32_bf16 v[152:155], v[228:231], v[120:123], v[152:155]
    v_exp_f32 v47, v47
    ds_read_b128 v[8:11], v240 offset:512
    ds_read_b128 v[12:15], v240 offset:576
    ds_read_b128 v[96:99], v240 offset:512
    ds_read_b128 v[100:103], v240 offset:576
    ds_read_b64_tr_b16 v[184:185], v232 offset:49408
    ds_read_b64_tr_b16 v[186:187], v232 offset:50432
    ds_read_b64_tr_b16 v[188:189], v232 offset:51456
    ds_read_b64_tr_b16 v[190:191], v232 offset:52480
    ds_read_b64_tr_b16 v[192:193], v232 offset:53504
    ds_read_b64_tr_b16 v[194:195], v232 offset:54528
    ds_read_b64_tr_b16 v[196:197], v237 offset:49408
    ds_read_b64_tr_b16 v[198:199], v237 offset:50432
    ds_read_b64_tr_b16 v[200:201], v237 offset:51456
    ds_read_b64_tr_b16 v[202:203], v237 offset:52480
    ds_read_b64_tr_b16 v[204:205], v237 offset:53504
    ds_read_b64_tr_b16 v[206:207], v237 offset:54528
    ds_read_b64_tr_b16 v[208:209], v233 offset:12352
    ds_read_b64_tr_b16 v[210:211], v233 offset:15456
    ds_read_b64_tr_b16 v[212:213], v233 offset:12360
    ds_read_b64_tr_b16 v[214:215], v233 offset:15464
    ds_read_b64_tr_b16 v[216:217], v233 offset:12416
    ds_read_b64_tr_b16 v[218:219], v233 offset:15520
    ds_read_b64_tr_b16 v[220:221], v233 offset:12424
    ds_read_b64_tr_b16 v[222:223], v233 offset:15528
    ds_read_b64_tr_b16 v[224:225], v233 offset:12480
    ds_read_b64_tr_b16 v[226:227], v233 offset:15584
    ds_read_b64_tr_b16 v[228:229], v233 offset:12488
    ds_read_b64_tr_b16 v[230:231], v233 offset:15592
    ds_read_b32 v5, v245
    s_mov_b32 exec_hi, 0xffff
    s_add_u32 m0, s57, 111168
    s_movk_i32 s59, 576
    buffer_load_dwordx4 v236, s[28:31], s59 offen lds
    s_add_u32 m0, s58, 74112
    s_mov_b32 s59, 36864
    buffer_load_dwordx4 v242, s[32:35], s59 offen lds
    s_mov_b32 exec_hi, -1
    s_setprio 1
    s_nop 0
    v_pk_mul_f32 v[16:17], v[16:17], v[48:49]
    v_pk_mul_f32 v[18:19], v[18:19], v[50:51]
    v_pk_mul_f32 v[20:21], v[20:21], v[52:53]
    v_pk_mul_f32 v[22:23], v[22:23], v[54:55]
    v_pk_add_f32 v[40:41], v[40:41], s[62:63]
    v_pk_add_f32 v[42:43], v[42:43], s[62:63]
    v_pk_add_f32 v[44:45], v[44:45], s[62:63]
    v_pk_add_f32 v[46:47], v[46:47], s[62:63]
    v_pk_fma_f32 v[48:49], v[32:33], v[32:33], s[60:61]
    v_pk_fma_f32 v[50:51], v[34:35], v[34:35], s[60:61]
    v_pk_fma_f32 v[52:53], v[36:37], v[36:37], s[60:61]
    v_pk_fma_f32 v[54:55], v[38:39], v[38:39], s[60:61]
    v_pk_mul_f32 v[48:49], v[32:33], v[48:49] neg_lo:[1,0] neg_hi:[1,0]
    v_pk_mul_f32 v[50:51], v[34:35], v[50:51] neg_lo:[1,0] neg_hi:[1,0]
    v_pk_mul_f32 v[52:53], v[36:37], v[52:53] neg_lo:[1,0] neg_hi:[1,0]
    v_pk_mul_f32 v[54:55], v[38:39], v[54:55] neg_lo:[1,0] neg_hi:[1,0]
    v_rcp_f32 v40, v40
    s_waitcnt lgkmcnt(13)
    v_mfma_f32_16x16x32_bf16 v[8:11], v[184:187], v[84:87], v[8:11]
    v_cvt_pk_bf16_f32 v56, v16, v17
    v_cvt_pk_bf16_f32 v57, v18, v19
    v_mfma_f32_16x16x32_bf16 v[8:11], v[188:191], v[88:91], v[8:11]
    v_rcp_f32 v41, v41
    v_mfma_f32_16x16x32_bf16 v[8:11], v[192:195], v[92:95], v[8:11]
    v_cvt_pk_bf16_f32 v58, v20, v21
    v_cvt_pk_bf16_f32 v59, v22, v23
    v_mfma_f32_16x16x32_bf16 v[12:15], v[196:199], v[84:87], v[12:15]
    v_rcp_f32 v42, v42
    v_mfma_f32_16x16x32_bf16 v[12:15], v[200:203], v[88:91], v[12:15]
    v_rcp_f32 v43, v43
    v_mfma_f32_16x16x32_bf16 v[12:15], v[204:207], v[92:95], v[12:15]
    v_rcp_f32 v44, v44
    v_mfma_f32_16x16x32_bf16 v[96:99], v[184:187], v[156:159], v[96:99]
    v_rcp_f32 v45, v45
    v_mfma_f32_16x16x32_bf16 v[96:99], v[188:191], v[160:163], v[96:99]
    v_rcp_f32 v46, v46
    v_mfma_f32_16x16x32_bf16 v[96:99], v[192:195], v[164:167], v[96:99]
    v_rcp_f32 v47, v47
    v_mfma_f32_16x16x32_bf16 v[100:103], v[196:199], v[156:159], v[100:103]
    v_mfma_f32_16x16x32_bf16 v[100:103], v[200:203], v[160:163], v[100:103]
    v_exp_f32 v48, v48
    v_mfma_f32_16x16x32_bf16 v[100:103], v[204:207], v[164:167], v[100:103]
    v_exp_f32 v49, v49
    s_waitcnt lgkmcnt(0)
    v_mfma_f32_16x16x32_bf16 v[60:63], v[208:211], v[56:59], v[60:63]
    v_exp_f32 v50, v50
    v_mfma_f32_16x16x32_bf16 v[64:67], v[212:215], v[56:59], v[64:67]
    v_exp_f32 v51, v51
    v_mfma_f32_16x16x32_bf16 v[68:71], v[216:219], v[56:59], v[68:71]
    v_exp_f32 v52, v52
    v_mfma_f32_16x16x32_bf16 v[72:75], v[220:223], v[56:59], v[72:75]
    v_exp_f32 v53, v53
    v_mfma_f32_16x16x32_bf16 v[76:79], v[224:227], v[56:59], v[76:79]
    v_exp_f32 v54, v54
    v_mfma_f32_16x16x32_bf16 v[80:83], v[228:231], v[56:59], v[80:83]
    v_exp_f32 v55, v55
    v_cmp_le_u32 vcc, 5, v5
    s_cmp_eq_u64 vcc, -1
    s_cbranch_scc1 L_gate_N0_3_ok
L_gate_N0_3:
    ds_read_b32 v5, v245
    s_waitcnt lgkmcnt(0)
    v_cmp_le_u32 vcc, 5, v5
    s_cmp_eq_u64 vcc, -1
    s_cbranch_scc0 L_gate_N0_3
L_gate_N0_3_ok:
    s_nop 0
    v_add_u32 v232, 61760, v232
    v_add_u32 v237, 61760, v237
    ds_read_b128 v[16:19], v240 offset:640
    ds_read_b128 v[20:23], v240 offset:704
    ds_read_b64_tr_b16 v[184:185], v232 offset:0
    ds_read_b64_tr_b16 v[186:187], v232 offset:1024
    ds_read_b64_tr_b16 v[188:189], v232 offset:2048
    ds_read_b64_tr_b16 v[190:191], v232 offset:3072
    ds_read_b64_tr_b16 v[192:193], v232 offset:4096
    ds_read_b64_tr_b16 v[194:195], v232 offset:5120
    ds_read_b64_tr_b16 v[196:197], v237 offset:0
    ds_read_b64_tr_b16 v[198:199], v237 offset:1024
    ds_read_b64_tr_b16 v[200:201], v237 offset:2048
    ds_read_b64_tr_b16 v[202:203], v237 offset:3072
    ds_read_b64_tr_b16 v[204:205], v237 offset:4096
    ds_read_b64_tr_b16 v[206:207], v237 offset:5120
    ds_read_b64_tr_b16 v[208:209], v233 offset:24704
    ds_read_b64_tr_b16 v[210:211], v233 offset:27808
    ds_read_b64_tr_b16 v[212:213], v233 offset:24712
    ds_read_b64_tr_b16 v[214:215], v233 offset:27816
    ds_read_b64_tr_b16 v[216:217], v233 offset:24768
    ds_read_b64_tr_b16 v[218:219], v233 offset:27872
    ds_read_b64_tr_b16 v[220:221], v233 offset:24776
    ds_read_b64_tr_b16 v[222:223], v233 offset:27880
    ds_read_b64_tr_b16 v[224:225], v233 offset:24832
    ds_read_b64_tr_b16 v[226:227], v233 offset:27936
    ds_read_b64_tr_b16 v[228:229], v233 offset:24840
    ds_read_b64_tr_b16 v[230:231], v233 offset:27944
    s_mov_b32 exec_hi, 0xffff
    s_add_u32 m0, s57, 123520
    s_movk_i32 s59, 640
    buffer_load_dwordx4 v236, s[28:31], s59 offen lds
    s_add_u32 m0, s58, 86464
    s_mov_b32 s59, 43008
    buffer_load_dwordx4 v242, s[32:35], s59 offen lds
    s_mov_b32 exec_hi, -1
    v_pk_mul_f32 v[24:25], v[24:25], v[40:41]
    v_pk_mul_f32 v[26:27], v[26:27], v[42:43]
    v_pk_mul_f32 v[28:29], v[28:29], v[44:45]
    v_pk_mul_f32 v[30:31], v[30:31], v[46:47]
    v_pk_add_f32 v[48:49], v[48:49], s[62:63]
    v_pk_add_f32 v[50:51], v[50:51], s[62:63]
    v_pk_add_f32 v[52:53], v[52:53], s[62:63]
    v_pk_add_f32 v[54:55], v[54:55], s[62:63]
    v_pk_fma_f32 v[40:41], v[8:9], v[8:9], s[60:61]
    v_pk_fma_f32 v[42:43], v[10:11], v[10:11], s[60:61]
    v_pk_fma_f32 v[44:45], v[12:13], v[12:13], s[60:61]
    v_pk_fma_f32 v[46:47], v[14:15], v[14:15], s[60:61]
    v_pk_mul_f32 v[40:41], v[8:9], v[40:41] neg_lo:[1,0] neg_hi:[1,0]
    v_pk_mul_f32 v[42:43], v[10:11], v[42:43] neg_lo:[1,0] neg_hi:[1,0]
    v_pk_mul_f32 v[44:45], v[12:13], v[44:45] neg_lo:[1,0] neg_hi:[1,0]
    v_pk_mul_f32 v[46:47], v[14:15], v[46:47] neg_lo:[1,0] neg_hi:[1,0]
    v_pk_fma_f32 v[112:113], v[96:97], v[96:97], s[60:61]
    v_pk_fma_f32 v[114:115], v[98:99], v[98:99], s[60:61]
    v_pk_fma_f32 v[116:117], v[100:101], v[100:101], s[60:61]
    v_pk_fma_f32 v[118:119], v[102:103], v[102:103], s[60:61]
    v_pk_mul_f32 v[112:113], v[96:97], v[112:113] neg_lo:[1,0] neg_hi:[1,0]
    v_pk_mul_f32 v[114:115], v[98:99], v[114:115] neg_lo:[1,0] neg_hi:[1,0]
    v_pk_mul_f32 v[116:117], v[100:101], v[116:117] neg_lo:[1,0] neg_hi:[1,0]
    v_pk_mul_f32 v[118:119], v[102:103], v[118:119] neg_lo:[1,0] neg_hi:[1,0]
    v_rcp_f32 v48, v48
    s_waitcnt lgkmcnt(12)
    v_mfma_f32_16x16x32_bf16 v[16:19], v[184:187], v[84:87], v[16:19]
    v_cvt_pk_bf16_f32 v56, v24, v25
    v_cvt_pk_bf16_f32 v57, v26, v27
    v_rcp_f32 v49, v49
    v_mfma_f32_16x16x32_bf16 v[16:19], v[188:191], v[88:91], v[16:19]
    v_cvt_pk_bf16_f32 v58, v28, v29
    v_cvt_pk_bf16_f32 v59, v30, v31
    v_rcp_f32 v50, v50
    v_mfma_f32_16x16x32_bf16 v[16:19], v[192:195], v[92:95], v[16:19]
    v_rcp_f32 v51, v51
    v_rcp_f32 v52, v52
    v_mfma_f32_16x16x32_bf16 v[20:23], v[196:199], v[84:87], v[20:23]
    v_rcp_f32 v53, v53
    v_rcp_f32 v54, v54
    v_mfma_f32_16x16x32_bf16 v[20:23], v[200:203], v[88:91], v[20:23]
    v_rcp_f32 v55, v55
    v_exp_f32 v40, v40
    v_mfma_f32_16x16x32_bf16 v[20:23], v[204:207], v[92:95], v[20:23]
    v_exp_f32 v41, v41
    v_exp_f32 v42, v42
    v_exp_f32 v43, v43
    s_waitcnt lgkmcnt(0)
    v_mfma_f32_16x16x32_bf16 v[60:63], v[208:211], v[56:59], v[60:63]
    v_exp_f32 v44, v44
    v_exp_f32 v45, v45
    v_mfma_f32_16x16x32_bf16 v[64:67], v[212:215], v[56:59], v[64:67]
    v_exp_f32 v46, v46
    v_exp_f32 v47, v47
    v_mfma_f32_16x16x32_bf16 v[68:71], v[216:219], v[56:59], v[68:71]
    v_exp_f32 v112, v112
    v_exp_f32 v113, v113
    v_mfma_f32_16x16x32_bf16 v[72:75], v[220:223], v[56:59], v[72:75]
    v_exp_f32 v114, v114
    v_exp_f32 v115, v115
    v_mfma_f32_16x16x32_bf16 v[76:79], v[224:227], v[56:59], v[76:79]
    v_exp_f32 v116, v116
    v_exp_f32 v117, v117
    v_mfma_f32_16x16x32_bf16 v[80:83], v[228:231], v[56:59], v[80:83]
    v_exp_f32 v118, v118
    v_exp_f32 v119, v119
    ds_read_b128 v[24:27], v240 offset:768
    ds_read_b128 v[28:31], v240 offset:832
    ds_read_b64_tr_b16 v[184:185], v232 offset:12352
    ds_read_b64_tr_b16 v[186:187], v232 offset:13376
    ds_read_b64_tr_b16 v[188:189], v232 offset:14400
    ds_read_b64_tr_b16 v[190:191], v232 offset:15424
    ds_read_b64_tr_b16 v[192:193], v232 offset:16448
    ds_read_b64_tr_b16 v[194:195], v232 offset:17472
    ds_read_b64_tr_b16 v[196:197], v237 offset:12352
    ds_read_b64_tr_b16 v[198:199], v237 offset:13376
    ds_read_b64_tr_b16 v[200:201], v237 offset:14400
    ds_read_b64_tr_b16 v[202:203], v237 offset:15424
    ds_read_b64_tr_b16 v[204:205], v237 offset:16448
    ds_read_b64_tr_b16 v[206:207], v237 offset:17472
    ds_read_b64_tr_b16 v[208:209], v233 offset:37056
    ds_read_b64_tr_b16 v[210:211], v233 offset:40160
    ds_read_b64_tr_b16 v[212:213], v233 offset:37064
    ds_read_b64_tr_b16 v[214:215], v233 offset:40168
    ds_read_b64_tr_b16 v[216:217], v233 offset:37120
    ds_read_b64_tr_b16 v[218:219], v233 offset:40224
    ds_read_b64_tr_b16 v[220:221], v233 offset:37128
    ds_read_b64_tr_b16 v[222:223], v233 offset:40232
    ds_read_b64_tr_b16 v[224:225], v233 offset:37184
    ds_read_b64_tr_b16 v[226:227], v233 offset:40288
    ds_read_b64_tr_b16 v[228:229], v233 offset:37192
    ds_read_b64_tr_b16 v[230:231], v233 offset:40296
    s_waitcnt vmcnt(0)
    v_mov_b32 v4, 6
    ds_write_b32 v244, v4
    s_mov_b32 exec_hi, 0xffff
    s_add_u32 m0, s57, 135872
    s_movk_i32 s59, 704
    buffer_load_dwordx4 v236, s[28:31], s59 offen lds
    s_add_u32 m0, s58, 98816
    s_mov_b32 s59, 49152
    buffer_load_dwordx4 v242, s[32:35], s59 offen lds
    s_mov_b32 exec_hi, -1
    buffer_load_dwordx4 v[248:251], v1, s[96:99], 0 offen offset:2048
    buffer_load_dwordx4 v[252:255], v1, s[96:99], 0 offen offset:3072
    v_pk_mul_f32 v[32:33], v[32:33], v[48:49]
    v_pk_mul_f32 v[34:35], v[34:35], v[50:51]
    v_pk_mul_f32 v[36:37], v[36:37], v[52:53]
    v_pk_mul_f32 v[38:39], v[38:39], v[54:55]
    v_pk_add_f32 v[40:41], v[40:41], s[62:63]
    v_pk_add_f32 v[42:43], v[42:43], s[62:63]
    v_pk_add_f32 v[44:45], v[44:45], s[62:63]
    v_pk_add_f32 v[46:47], v[46:47], s[62:63]
    v_pk_add_f32 v[112:113], v[112:113], s[62:63]
    v_pk_add_f32 v[114:115], v[114:115], s[62:63]
    v_pk_add_f32 v[116:117], v[116:117], s[62:63]
    v_pk_add_f32 v[118:119], v[118:119], s[62:63]
    v_pk_fma_f32 v[48:49], v[16:17], v[16:17], s[60:61]
    v_pk_fma_f32 v[50:51], v[18:19], v[18:19], s[60:61]
    v_pk_fma_f32 v[52:53], v[20:21], v[20:21], s[60:61]
    v_pk_fma_f32 v[54:55], v[22:23], v[22:23], s[60:61]
    v_pk_mul_f32 v[48:49], v[16:17], v[48:49] neg_lo:[1,0] neg_hi:[1,0]
    v_pk_mul_f32 v[50:51], v[18:19], v[50:51] neg_lo:[1,0] neg_hi:[1,0]
    v_pk_mul_f32 v[52:53], v[20:21], v[52:53] neg_lo:[1,0] neg_hi:[1,0]
    v_pk_mul_f32 v[54:55], v[22:23], v[54:55] neg_lo:[1,0] neg_hi:[1,0]
    v_rcp_f32 v40, v40
    s_waitcnt lgkmcnt(13)
    v_mfma_f32_16x16x32_bf16 v[24:27], v[184:187], v[84:87], v[24:27]
    v_cvt_pk_bf16_f32 v56, v32, v33
    v_cvt_pk_bf16_f32 v57, v34, v35
    v_rcp_f32 v41, v41
    v_mfma_f32_16x16x32_bf16 v[24:27], v[188:191], v[88:91], v[24:27]
    v_cvt_pk_bf16_f32 v58, v36, v37
    v_cvt_pk_bf16_f32 v59, v38, v39
    v_rcp_f32 v42, v42
    v_mfma_f32_16x16x32_bf16 v[24:27], v[192:195], v[92:95], v[24:27]
    v_rcp_f32 v43, v43
    v_rcp_f32 v44, v44
    v_mfma_f32_16x16x32_bf16 v[28:31], v[196:199], v[84:87], v[28:31]
    v_rcp_f32 v45, v45
    v_rcp_f32 v46, v46
    v_mfma_f32_16x16x32_bf16 v[28:31], v[200:203], v[88:91], v[28:31]
    v_rcp_f32 v47, v47
    v_exp_f32 v48, v48
    v_mfma_f32_16x16x32_bf16 v[28:31], v[204:207], v[92:95], v[28:31]
    v_exp_f32 v49, v49
    v_exp_f32 v50, v50
    v_exp_f32 v51, v51
    s_waitcnt lgkmcnt(0)
    v_mfma_f32_16x16x32_bf16 v[60:63], v[208:211], v[56:59], v[60:63]
    v_exp_f32 v52, v52
    v_exp_f32 v53, v53
    v_mfma_f32_16x16x32_bf16 v[64:67], v[212:215], v[56:59], v[64:67]
    v_exp_f32 v54, v54
    v_exp_f32 v55, v55
    v_mfma_f32_16x16x32_bf16 v[68:71], v[216:219], v[56:59], v[68:71]
    v_rcp_f32 v112, v112
    v_rcp_f32 v113, v113
    v_mfma_f32_16x16x32_bf16 v[72:75], v[220:223], v[56:59], v[72:75]
    v_rcp_f32 v114, v114
    v_rcp_f32 v115, v115
    v_mfma_f32_16x16x32_bf16 v[76:79], v[224:227], v[56:59], v[76:79]
    v_rcp_f32 v116, v116
    v_rcp_f32 v117, v117
    v_mfma_f32_16x16x32_bf16 v[80:83], v[228:231], v[56:59], v[80:83]
    v_rcp_f32 v118, v118
    v_rcp_f32 v119, v119
    ds_read_b128 v[32:35], v240 offset:896
    ds_read_b128 v[36:39], v240 offset:960
    ds_read_b64_tr_b16 v[184:185], v232 offset:24704
    ds_read_b64_tr_b16 v[186:187], v232 offset:25728
    ds_read_b64_tr_b16 v[188:189], v232 offset:26752
    ds_read_b64_tr_b16 v[190:191], v232 offset:27776
    ds_read_b64_tr_b16 v[192:193], v232 offset:28800
    ds_read_b64_tr_b16 v[194:195], v232 offset:29824
    ds_read_b64_tr_b16 v[196:197], v237 offset:24704
    ds_read_b64_tr_b16 v[198:199], v237 offset:25728
    ds_read_b64_tr_b16 v[200:201], v237 offset:26752
    ds_read_b64_tr_b16 v[202:203], v237 offset:27776
    ds_read_b64_tr_b16 v[204:205], v237 offset:28800
    ds_read_b64_tr_b16 v[206:207], v237 offset:29824
    ds_read_b64_tr_b16 v[208:209], v233 offset:49408
    ds_read_b64_tr_b16 v[210:211], v233 offset:52512
    ds_read_b64_tr_b16 v[212:213], v233 offset:49416
    ds_read_b64_tr_b16 v[214:215], v233 offset:52520
    ds_read_b64_tr_b16 v[216:217], v233 offset:49472
    ds_read_b64_tr_b16 v[218:219], v233 offset:52576
    ds_read_b64_tr_b16 v[220:221], v233 offset:49480
    ds_read_b64_tr_b16 v[222:223], v233 offset:52584
    ds_read_b64_tr_b16 v[224:225], v233 offset:49536
    ds_read_b64_tr_b16 v[226:227], v233 offset:52640
    ds_read_b64_tr_b16 v[228:229], v233 offset:49544
    ds_read_b64_tr_b16 v[230:231], v233 offset:52648
    ds_read_b32 v5, v245
    s_mov_b32 exec_hi, 0xffff
    s_add_u32 m0, s58, 111168
    s_mov_b32 s59, 55296
    buffer_load_dwordx4 v242, s[32:35], s59 offen lds
    s_add_u32 m0, s58, 123520
    s_mov_b32 s59, 61440
    buffer_load_dwordx4 v242, s[32:35], s59 offen lds
    s_mov_b32 exec_hi, -1
    s_nop 0
    v_pk_mul_f32 v[8:9], v[8:9], v[40:41]
    v_pk_mul_f32 v[10:11], v[10:11], v[42:43]
    v_pk_mul_f32 v[12:13], v[12:13], v[44:45]
    v_pk_mul_f32 v[14:15], v[14:15], v[46:47]
    v_pk_add_f32 v[48:49], v[48:49], s[62:63]
    v_pk_add_f32 v[50:51], v[50:51], s[62:63]
    v_pk_add_f32 v[52:53], v[52:53], s[62:63]
    v_pk_add_f32 v[54:55], v[54:55], s[62:63]
    v_pk_mul_f32 v[96:97], v[96:97], v[112:113]
    v_pk_mul_f32 v[98:99], v[98:99], v[114:115]
    v_pk_mul_f32 v[100:101], v[100:101], v[116:117]
    v_pk_mul_f32 v[102:103], v[102:103], v[118:119]
    v_pk_fma_f32 v[40:41], v[24:25], v[24:25], s[60:61]
    v_pk_fma_f32 v[42:43], v[26:27], v[26:27], s[60:61]
    v_pk_fma_f32 v[44:45], v[28:29], v[28:29], s[60:61]
    v_pk_fma_f32 v[46:47], v[30:31], v[30:31], s[60:61]
    v_pk_mul_f32 v[40:41], v[24:25], v[40:41] neg_lo:[1,0] neg_hi:[1,0]
    v_pk_mul_f32 v[42:43], v[26:27], v[42:43] neg_lo:[1,0] neg_hi:[1,0]
    v_pk_mul_f32 v[44:45], v[28:29], v[44:45] neg_lo:[1,0] neg_hi:[1,0]
    v_pk_mul_f32 v[46:47], v[30:31], v[46:47] neg_lo:[1,0] neg_hi:[1,0]
    v_rcp_f32 v48, v48
    s_waitcnt lgkmcnt(13)
    v_mfma_f32_16x16x32_bf16 v[32:35], v[184:187], v[84:87], v[32:35]
    v_cvt_pk_bf16_f32 v56, v8, v9
    v_cvt_pk_bf16_f32 v57, v10, v11
    v_mfma_f32_16x16x32_bf16 v[32:35], v[188:191], v[88:91], v[32:35]
    v_rcp_f32 v49, v49
    v_mfma_f32_16x16x32_bf16 v[32:35], v[192:195], v[92:95], v[32:35]
    v_cvt_pk_bf16_f32 v58, v12, v13
    v_cvt_pk_bf16_f32 v59, v14, v15
    v_mfma_f32_16x16x32_bf16 v[36:39], v[196:199], v[84:87], v[36:39]
    v_rcp_f32 v50, v50
    v_mfma_f32_16x16x32_bf16 v[36:39], v[200:203], v[88:91], v[36:39]
    v_cvt_pk_bf16_f32 v120, v96, v97
    v_cvt_pk_bf16_f32 v121, v98, v99
    v_mfma_f32_16x16x32_bf16 v[36:39], v[204:207], v[92:95], v[36:39]
    v_rcp_f32 v51, v51
    v_cvt_pk_bf16_f32 v122, v100, v101
    s_waitcnt lgkmcnt(0)
    v_mfma_f32_16x16x32_bf16 v[60:63], v[208:211], v[56:59], v[60:63]
    v_cvt_pk_bf16_f32 v123, v102, v103
    v_mfma_f32_16x16x32_bf16 v[64:67], v[212:215], v[56:59], v[64:67]
    v_rcp_f32 v52, v52
    v_mfma_f32_16x16x32_bf16 v[68:71], v[216:219], v[56:59], v[68:71]
    v_rcp_f32 v53, v53
    v_rcp_f32 v54, v54
    v_mfma_f32_16x16x32_bf16 v[72:75], v[220:223], v[56:59], v[72:75]
    v_rcp_f32 v55, v55
    v_mfma_f32_16x16x32_bf16 v[76:79], v[224:227], v[56:59], v[76:79]
    v_exp_f32 v40, v40
    v_mfma_f32_16x16x32_bf16 v[80:83], v[228:231], v[56:59], v[80:83]
    v_exp_f32 v41, v41
    v_mfma_f32_16x16x32_bf16 v[132:135], v[208:211], v[120:123], v[132:135]
    v_exp_f32 v42, v42
    v_mfma_f32_16x16x32_bf16 v[136:139], v[212:215], v[120:123], v[136:139]
    v_exp_f32 v43, v43
    v_mfma_f32_16x16x32_bf16 v[140:143], v[216:219], v[120:123], v[140:143]
    v_exp_f32 v44, v44
    v_mfma_f32_16x16x32_bf16 v[144:147], v[220:223], v[120:123], v[144:147]
    v_exp_f32 v45, v45
    v_mfma_f32_16x16x32_bf16 v[148:151], v[224:227], v[120:123], v[148:151]
    v_exp_f32 v46, v46
    v_mfma_f32_16x16x32_bf16 v[152:155], v[228:231], v[120:123], v[152:155]
    v_exp_f32 v47, v47
    v_cmp_le_u32 vcc, 6, v5
    s_cmp_eq_u64 vcc, -1
    s_cbranch_scc1 L_gate_N0_6_ok
L_gate_N0_6:
    ds_read_b32 v5, v245
    s_waitcnt lgkmcnt(0)
    v_cmp_le_u32 vcc, 6, v5
    s_cmp_eq_u64 vcc, -1
    s_cbranch_scc0 L_gate_N0_6
L_gate_N0_6_ok:
    s_nop 0
    ds_read_b128 v[8:11], v240 offset:1024
    ds_read_b128 v[12:15], v240 offset:1088
    ds_read_b128 v[96:99], v240 offset:1024
    ds_read_b128 v[100:103], v240 offset:1088
    ds_read_b64_tr_b16 v[184:185], v232 offset:37056
    ds_read_b64_tr_b16 v[186:187], v232 offset:38080
    ds_read_b64_tr_b16 v[188:189], v232 offset:39104
    ds_read_b64_tr_b16 v[190:191], v232 offset:40128
    ds_read_b64_tr_b16 v[192:193], v232 offset:41152
    ds_read_b64_tr_b16 v[194:195], v232 offset:42176
    ds_read_b64_tr_b16 v[196:197], v237 offset:37056
    ds_read_b64_tr_b16 v[198:199], v237 offset:38080
    ds_read_b64_tr_b16 v[200:201], v237 offset:39104
    ds_read_b64_tr_b16 v[202:203], v237 offset:40128
    ds_read_b64_tr_b16 v[204:205], v237 offset:41152
    ds_read_b64_tr_b16 v[206:207], v237 offset:42176
    v_add_u32 v233, 61760, v233
    ds_read_b64_tr_b16 v[208:209], v233 offset:0
    ds_read_b64_tr_b16 v[210:211], v233 offset:3104
    ds_read_b64_tr_b16 v[212:213], v233 offset:8
    ds_read_b64_tr_b16 v[214:215], v233 offset:3112
    ds_read_b64_tr_b16 v[216:217], v233 offset:64
    ds_read_b64_tr_b16 v[218:219], v233 offset:3168
    ds_read_b64_tr_b16 v[220:221], v233 offset:72
    ds_read_b64_tr_b16 v[222:223], v233 offset:3176
    ds_read_b64_tr_b16 v[224:225], v233 offset:128
    ds_read_b64_tr_b16 v[226:227], v233 offset:3232
    ds_read_b64_tr_b16 v[228:229], v233 offset:136
    ds_read_b64_tr_b16 v[230:231], v233 offset:3240
    s_mov_b32 exec_hi, 0xffff
    s_add_u32 m0, s58, 135872
    s_mov_b32 s59, 67584
    buffer_load_dwordx4 v242, s[32:35], s59 offen lds
    s_mov_b32 exec_hi, -1
    s_nop 0
    v_pk_mul_f32 v[16:17], v[16:17], v[48:49]
    v_pk_mul_f32 v[18:19], v[18:19], v[50:51]
    v_pk_mul_f32 v[20:21], v[20:21], v[52:53]
    v_pk_mul_f32 v[22:23], v[22:23], v[54:55]
    v_pk_add_f32 v[40:41], v[40:41], s[62:63]
    v_pk_add_f32 v[42:43], v[42:43], s[62:63]
    v_pk_add_f32 v[44:45], v[44:45], s[62:63]
    v_pk_add_f32 v[46:47], v[46:47], s[62:63]
    v_pk_fma_f32 v[48:49], v[32:33], v[32:33], s[60:61]
    v_pk_fma_f32 v[50:51], v[34:35], v[34:35], s[60:61]
    v_pk_fma_f32 v[52:53], v[36:37], v[36:37], s[60:61]
    v_pk_fma_f32 v[54:55], v[38:39], v[38:39], s[60:61]
    v_pk_mul_f32 v[48:49], v[32:33], v[48:49] neg_lo:[1,0] neg_hi:[1,0]
    v_pk_mul_f32 v[50:51], v[34:35], v[50:51] neg_lo:[1,0] neg_hi:[1,0]
    v_pk_mul_f32 v[52:53], v[36:37], v[52:53] neg_lo:[1,0] neg_hi:[1,0]
    v_pk_mul_f32 v[54:55], v[38:39], v[54:55] neg_lo:[1,0] neg_hi:[1,0]
    v_rcp_f32 v40, v40
    s_waitcnt lgkmcnt(12)
    v_mfma_f32_16x16x32_bf16 v[8:11], v[184:187], v[84:87], v[8:11]
    v_cvt_pk_bf16_f32 v56, v16, v17
    v_cvt_pk_bf16_f32 v57, v18, v19
    v_mfma_f32_16x16x32_bf16 v[8:11], v[188:191], v[88:91], v[8:11]
    v_rcp_f32 v41, v41
    v_mfma_f32_16x16x32_bf16 v[8:11], v[192:195], v[92:95], v[8:11]
    v_cvt_pk_bf16_f32 v58, v20, v21
    v_cvt_pk_bf16_f32 v59, v22, v23
    v_mfma_f32_16x16x32_bf16 v[12:15], v[196:199], v[84:87], v[12:15]
    v_rcp_f32 v42, v42
    v_mfma_f32_16x16x32_bf16 v[12:15], v[200:203], v[88:91], v[12:15]
    v_rcp_f32 v43, v43
    v_mfma_f32_16x16x32_bf16 v[12:15], v[204:207], v[92:95], v[12:15]
    v_rcp_f32 v44, v44
    v_mfma_f32_16x16x32_bf16 v[96:99], v[184:187], v[156:159], v[96:99]
    v_rcp_f32 v45, v45
    v_mfma_f32_16x16x32_bf16 v[96:99], v[188:191], v[160:163], v[96:99]
    v_rcp_f32 v46, v46
    v_mfma_f32_16x16x32_bf16 v[96:99], v[192:195], v[164:167], v[96:99]
    v_rcp_f32 v47, v47
    v_mfma_f32_16x16x32_bf16 v[100:103], v[196:199], v[156:159], v[100:103]
    v_mfma_f32_16x16x32_bf16 v[100:103], v[200:203], v[160:163], v[100:103]
    v_exp_f32 v48, v48
    v_mfma_f32_16x16x32_bf16 v[100:103], v[204:207], v[164:167], v[100:103]
    v_exp_f32 v49, v49
    s_waitcnt lgkmcnt(0)
    v_mfma_f32_16x16x32_bf16 v[60:63], v[208:211], v[56:59], v[60:63]
    v_exp_f32 v50, v50
    v_mfma_f32_16x16x32_bf16 v[64:67], v[212:215], v[56:59], v[64:67]
    v_exp_f32 v51, v51
    v_mfma_f32_16x16x32_bf16 v[68:71], v[216:219], v[56:59], v[68:71]
    v_exp_f32 v52, v52
    v_mfma_f32_16x16x32_bf16 v[72:75], v[220:223], v[56:59], v[72:75]
    v_exp_f32 v53, v53
    v_mfma_f32_16x16x32_bf16 v[76:79], v[224:227], v[56:59], v[76:79]
    v_exp_f32 v54, v54
    v_mfma_f32_16x16x32_bf16 v[80:83], v[228:231], v[56:59], v[80:83]
    v_exp_f32 v55, v55
    ds_read_b128 v[16:19], v240 offset:1152
    ds_read_b128 v[20:23], v240 offset:1216
    ds_read_b64_tr_b16 v[184:185], v232 offset:49408
    ds_read_b64_tr_b16 v[186:187], v232 offset:50432
    ds_read_b64_tr_b16 v[188:189], v232 offset:51456
    ds_read_b64_tr_b16 v[190:191], v232 offset:52480
    ds_read_b64_tr_b16 v[192:193], v232 offset:53504
    ds_read_b64_tr_b16 v[194:195], v232 offset:54528
    ds_read_b64_tr_b16 v[196:197], v237 offset:49408
    ds_read_b64_tr_b16 v[198:199], v237 offset:50432
    ds_read_b64_tr_b16 v[200:201], v237 offset:51456
    ds_read_b64_tr_b16 v[202:203], v237 offset:52480
    ds_read_b64_tr_b16 v[204:205], v237 offset:53504
    ds_read_b64_tr_b16 v[206:207], v237 offset:54528
    ds_read_b64_tr_b16 v[208:209], v233 offset:12352
    ds_read_b64_tr_b16 v[210:211], v233 offset:15456
    ds_read_b64_tr_b16 v[212:213], v233 offset:12360
    ds_read_b64_tr_b16 v[214:215], v233 offset:15464
    ds_read_b64_tr_b16 v[216:217], v233 offset:12416
    ds_read_b64_tr_b16 v[218:219], v233 offset:15520
    ds_read_b64_tr_b16 v[220:221], v233 offset:12424
    ds_read_b64_tr_b16 v[222:223], v233 offset:15528
    ds_read_b64_tr_b16 v[224:225], v233 offset:12480
    ds_read_b64_tr_b16 v[226:227], v233 offset:15584
    ds_read_b64_tr_b16 v[228:229], v233 offset:12488
    ds_read_b64_tr_b16 v[230:231], v233 offset:15592
    s_waitcnt vmcnt(0)
    v_mov_b32 v4, 7
    ds_write_b32 v244, v4
    v_pk_mul_f32 v[24:25], v[24:25], v[40:41]
    v_pk_mul_f32 v[26:27], v[26:27], v[42:43]
    v_pk_mul_f32 v[28:29], v[28:29], v[44:45]
    v_pk_mul_f32 v[30:31], v[30:31], v[46:47]
    v_pk_add_f32 v[48:49], v[48:49], s[62:63]
    v_pk_add_f32 v[50:51], v[50:51], s[62:63]
    v_pk_add_f32 v[52:53], v[52:53], s[62:63]
    v_pk_add_f32 v[54:55], v[54:55], s[62:63]
    v_pk_fma_f32 v[40:41], v[8:9], v[8:9], s[60:61]
    v_pk_fma_f32 v[42:43], v[10:11], v[10:11], s[60:61]
    v_pk_fma_f32 v[44:45], v[12:13], v[12:13], s[60:61]
    v_pk_fma_f32 v[46:47], v[14:15], v[14:15], s[60:61]
    v_pk_mul_f32 v[40:41], v[8:9], v[40:41] neg_lo:[1,0] neg_hi:[1,0]
    v_pk_mul_f32 v[42:43], v[10:11], v[42:43] neg_lo:[1,0] neg_hi:[1,0]
    v_pk_mul_f32 v[44:45], v[12:13], v[44:45] neg_lo:[1,0] neg_hi:[1,0]
    v_pk_mul_f32 v[46:47], v[14:15], v[46:47] neg_lo:[1,0] neg_hi:[1,0]
    v_pk_fma_f32 v[112:113], v[96:97], v[96:97], s[60:61]
    v_pk_fma_f32 v[114:115], v[98:99], v[98:99], s[60:61]
    v_pk_fma_f32 v[116:117], v[100:101], v[100:101], s[60:61]
    v_pk_fma_f32 v[118:119], v[102:103], v[102:103], s[60:61]
    v_pk_mul_f32 v[112:113], v[96:97], v[112:113] neg_lo:[1,0] neg_hi:[1,0]
    v_pk_mul_f32 v[114:115], v[98:99], v[114:115] neg_lo:[1,0] neg_hi:[1,0]
    v_pk_mul_f32 v[116:117], v[100:101], v[116:117] neg_lo:[1,0] neg_hi:[1,0]
    v_pk_mul_f32 v[118:119], v[102:103], v[118:119] neg_lo:[1,0] neg_hi:[1,0]
    v_rcp_f32 v48, v48
    s_waitcnt lgkmcnt(13)
    v_mfma_f32_16x16x32_bf16 v[16:19], v[184:187], v[84:87], v[16:19]
    v_cvt_pk_bf16_f32 v56, v24, v25
    v_cvt_pk_bf16_f32 v57, v26, v27
    v_rcp_f32 v49, v49
    v_mfma_f32_16x16x32_bf16 v[16:19], v[188:191], v[88:91], v[16:19]
    v_cvt_pk_bf16_f32 v58, v28, v29
    v_cvt_pk_bf16_f32 v59, v30, v31
    v_rcp_f32 v50, v50
    v_mfma_f32_16x16x32_bf16 v[16:19], v[192:195], v[92:95], v[16:19]
    v_rcp_f32 v51, v51
    v_rcp_f32 v52, v52
    v_mfma_f32_16x16x32_bf16 v[20:23], v[196:199], v[84:87], v[20:23]
    v_rcp_f32 v53, v53
    v_rcp_f32 v54, v54
    v_mfma_f32_16x16x32_bf16 v[20:23], v[200:203], v[88:91], v[20:23]
    v_rcp_f32 v55, v55
    v_exp_f32 v40, v40
    v_mfma_f32_16x16x32_bf16 v[20:23], v[204:207], v[92:95], v[20:23]
    v_exp_f32 v41, v41
    v_exp_f32 v42, v42
    v_exp_f32 v43, v43
    s_waitcnt lgkmcnt(0)
    v_mfma_f32_16x16x32_bf16 v[60:63], v[208:211], v[56:59], v[60:63]
    v_exp_f32 v44, v44
    v_exp_f32 v45, v45
    v_mfma_f32_16x16x32_bf16 v[64:67], v[212:215], v[56:59], v[64:67]
    v_exp_f32 v46, v46
    v_exp_f32 v47, v47
    v_mfma_f32_16x16x32_bf16 v[68:71], v[216:219], v[56:59], v[68:71]
    v_exp_f32 v112, v112
    v_exp_f32 v113, v113
    v_mfma_f32_16x16x32_bf16 v[72:75], v[220:223], v[56:59], v[72:75]
    v_exp_f32 v114, v114
    v_exp_f32 v115, v115
    v_mfma_f32_16x16x32_bf16 v[76:79], v[224:227], v[56:59], v[76:79]
    v_exp_f32 v116, v116
    v_exp_f32 v117, v117
    v_mfma_f32_16x16x32_bf16 v[80:83], v[228:231], v[56:59], v[80:83]
    v_exp_f32 v118, v118
    v_exp_f32 v119, v119
    v_add_u32 v232, 61760, v232
    v_add_u32 v237, 61760, v237
    ds_read_b128 v[24:27], v240 offset:1280
    ds_read_b128 v[28:31], v240 offset:1344
    ds_read_b64_tr_b16 v[184:185], v232 offset:0
    ds_read_b64_tr_b16 v[186:187], v232 offset:1024
    ds_read_b64_tr_b16 v[188:189], v232 offset:2048
    ds_read_b64_tr_b16 v[190:191], v232 offset:3072
    ds_read_b64_tr_b16 v[192:193], v232 offset:4096
    ds_read_b64_tr_b16 v[194:195], v232 offset:5120
    ds_read_b64_tr_b16 v[196:197], v237 offset:0
    ds_read_b64_tr_b16 v[198:199], v237 offset:1024
    ds_read_b64_tr_b16 v[200:201], v237 offset:2048
    ds_read_b64_tr_b16 v[202:203], v237 offset:3072
    ds_read_b64_tr_b16 v[204:205], v237 offset:4096
    ds_read_b64_tr_b16 v[206:207], v237 offset:5120
    ds_read_b64_tr_b16 v[208:209], v233 offset:24704
    ds_read_b64_tr_b16 v[210:211], v233 offset:27808
    ds_read_b64_tr_b16 v[212:213], v233 offset:24712
    ds_read_b64_tr_b16 v[214:215], v233 offset:27816
    ds_read_b64_tr_b16 v[216:217], v233 offset:24768
    ds_read_b64_tr_b16 v[218:219], v233 offset:27872
    ds_read_b64_tr_b16 v[220:221], v233 offset:24776
    ds_read_b64_tr_b16 v[222:223], v233 offset:27880
    ds_read_b64_tr_b16 v[224:225], v233 offset:24832
    ds_read_b64_tr_b16 v[226:227], v233 offset:27936
    ds_read_b64_tr_b16 v[228:229], v233 offset:24840
    ds_read_b64_tr_b16 v[230:231], v233 offset:27944
    ds_read_b32 v5, v245
    v_pk_mul_f32 v[32:33], v[32:33], v[48:49]
    v_pk_mul_f32 v[34:35], v[34:35], v[50:51]
    v_pk_mul_f32 v[36:37], v[36:37], v[52:53]
    v_pk_mul_f32 v[38:39], v[38:39], v[54:55]
    v_pk_add_f32 v[40:41], v[40:41], s[62:63]
    v_pk_add_f32 v[42:43], v[42:43], s[62:63]
    v_pk_add_f32 v[44:45], v[44:45], s[62:63]
    v_pk_add_f32 v[46:47], v[46:47], s[62:63]
    v_pk_add_f32 v[112:113], v[112:113], s[62:63]
    v_pk_add_f32 v[114:115], v[114:115], s[62:63]
    v_pk_add_f32 v[116:117], v[116:117], s[62:63]
    v_pk_add_f32 v[118:119], v[118:119], s[62:63]
    v_pk_fma_f32 v[48:49], v[16:17], v[16:17], s[60:61]
    v_pk_fma_f32 v[50:51], v[18:19], v[18:19], s[60:61]
    v_pk_fma_f32 v[52:53], v[20:21], v[20:21], s[60:61]
    v_pk_fma_f32 v[54:55], v[22:23], v[22:23], s[60:61]
    v_pk_mul_f32 v[48:49], v[16:17], v[48:49] neg_lo:[1,0] neg_hi:[1,0]
    v_pk_mul_f32 v[50:51], v[18:19], v[50:51] neg_lo:[1,0] neg_hi:[1,0]
    v_pk_mul_f32 v[52:53], v[20:21], v[52:53] neg_lo:[1,0] neg_hi:[1,0]
    v_pk_mul_f32 v[54:55], v[22:23], v[54:55] neg_lo:[1,0] neg_hi:[1,0]
    v_rcp_f32 v40, v40
    s_waitcnt lgkmcnt(13)
    v_mfma_f32_16x16x32_bf16 v[24:27], v[184:187], v[84:87], v[24:27]
    v_cvt_pk_bf16_f32 v56, v32, v33
    v_cvt_pk_bf16_f32 v57, v34, v35
    v_rcp_f32 v41, v41
    v_mfma_f32_16x16x32_bf16 v[24:27], v[188:191], v[88:91], v[24:27]
    v_cvt_pk_bf16_f32 v58, v36, v37
    v_cvt_pk_bf16_f32 v59, v38, v39
    v_rcp_f32 v42, v42
    v_mfma_f32_16x16x32_bf16 v[24:27], v[192:195], v[92:95], v[24:27]
    v_rcp_f32 v43, v43
    v_rcp_f32 v44, v44
    v_mfma_f32_16x16x32_bf16 v[28:31], v[196:199], v[84:87], v[28:31]
    v_rcp_f32 v45, v45
    v_rcp_f32 v46, v46
    v_mfma_f32_16x16x32_bf16 v[28:31], v[200:203], v[88:91], v[28:31]
    v_rcp_f32 v47, v47
    v_exp_f32 v48, v48
    v_mfma_f32_16x16x32_bf16 v[28:31], v[204:207], v[92:95], v[28:31]
    v_exp_f32 v49, v49
    v_exp_f32 v50, v50
    v_exp_f32 v51, v51
    s_waitcnt lgkmcnt(0)
    v_mfma_f32_16x16x32_bf16 v[60:63], v[208:211], v[56:59], v[60:63]
    v_exp_f32 v52, v52
    v_exp_f32 v53, v53
    v_mfma_f32_16x16x32_bf16 v[64:67], v[212:215], v[56:59], v[64:67]
    v_exp_f32 v54, v54
    v_exp_f32 v55, v55
    v_mfma_f32_16x16x32_bf16 v[68:71], v[216:219], v[56:59], v[68:71]
    v_rcp_f32 v112, v112
    v_rcp_f32 v113, v113
    v_mfma_f32_16x16x32_bf16 v[72:75], v[220:223], v[56:59], v[72:75]
    v_rcp_f32 v114, v114
    v_rcp_f32 v115, v115
    v_mfma_f32_16x16x32_bf16 v[76:79], v[224:227], v[56:59], v[76:79]
    v_rcp_f32 v116, v116
    v_rcp_f32 v117, v117
    v_mfma_f32_16x16x32_bf16 v[80:83], v[228:231], v[56:59], v[80:83]
    v_rcp_f32 v118, v118
    v_rcp_f32 v119, v119
    v_cmp_le_u32 vcc, 7, v5
    s_cmp_eq_u64 vcc, -1
    s_cbranch_scc1 L_gate_N0_9_ok
L_gate_N0_9:
    ds_read_b32 v5, v245
    s_waitcnt lgkmcnt(0)
    v_cmp_le_u32 vcc, 7, v5
    s_cmp_eq_u64 vcc, -1
    s_cbranch_scc0 L_gate_N0_9
L_gate_N0_9_ok:
    s_nop 0
    ds_read_b128 v[32:35], v240 offset:1408
    ds_read_b128 v[36:39], v240 offset:1472
    ds_read_b64_tr_b16 v[184:185], v232 offset:12352
    ds_read_b64_tr_b16 v[186:187], v232 offset:13376
    ds_read_b64_tr_b16 v[188:189], v232 offset:14400
    ds_read_b64_tr_b16 v[190:191], v232 offset:15424
    ds_read_b64_tr_b16 v[192:193], v232 offset:16448
    ds_read_b64_tr_b16 v[194:195], v232 offset:17472
    ds_read_b64_tr_b16 v[196:197], v237 offset:12352
    ds_read_b64_tr_b16 v[198:199], v237 offset:13376
    ds_read_b64_tr_b16 v[200:201], v237 offset:14400
    ds_read_b64_tr_b16 v[202:203], v237 offset:15424
    ds_read_b64_tr_b16 v[204:205], v237 offset:16448
    ds_read_b64_tr_b16 v[206:207], v237 offset:17472
    ds_read_b64_tr_b16 v[208:209], v233 offset:37056
    ds_read_b64_tr_b16 v[210:211], v233 offset:40160
    ds_read_b64_tr_b16 v[212:213], v233 offset:37064
    ds_read_b64_tr_b16 v[214:215], v233 offset:40168
    ds_read_b64_tr_b16 v[216:217], v233 offset:37120
    ds_read_b64_tr_b16 v[218:219], v233 offset:40224
    ds_read_b64_tr_b16 v[220:221], v233 offset:37128
    ds_read_b64_tr_b16 v[222:223], v233 offset:40232
    ds_read_b64_tr_b16 v[224:225], v233 offset:37184
    ds_read_b64_tr_b16 v[226:227], v233 offset:40288
    ds_read_b64_tr_b16 v[228:229], v233 offset:37192
    ds_read_b64_tr_b16 v[230:231], v233 offset:40296
    v_pk_mul_f32 v[8:9], v[8:9], v[40:41]
    v_pk_mul_f32 v[10:11], v[10:11], v[42:43]
    v_pk_mul_f32 v[12:13], v[12:13], v[44:45]
    v_pk_mul_f32 v[14:15], v[14:15], v[46:47]
    v_pk_add_f32 v[48:49], v[48:49], s[62:63]
    v_pk_add_f32 v[50:51], v[50:51], s[62:63]
    v_pk_add_f32 v[52:53], v[52:53], s[62:63]
    v_pk_add_f32 v[54:55], v[54:55], s[62:63]
    v_pk_mul_f32 v[96:97], v[96:97], v[112:113]
    v_pk_mul_f32 v[98:99], v[98:99], v[114:115]
    v_pk_mul_f32 v[100:101], v[100:101], v[116:117]
    v_pk_mul_f32 v[102:103], v[102:103], v[118:119]
    v_pk_fma_f32 v[40:41], v[24:25], v[24:25], s[60:61]
    v_pk_fma_f32 v[42:43], v[26:27], v[26:27], s[60:61]
    v_pk_fma_f32 v[44:45], v[28:29], v[28:29], s[60:61]
    v_pk_fma_f32 v[46:47], v[30:31], v[30:31], s[60:61]
    v_pk_mul_f32 v[40:41], v[24:25], v[40:41] neg_lo:[1,0] neg_hi:[1,0]
    v_pk_mul_f32 v[42:43], v[26:27], v[42:43] neg_lo:[1,0] neg_hi:[1,0]
    v_pk_mul_f32 v[44:45], v[28:29], v[44:45] neg_lo:[1,0] neg_hi:[1,0]
    v_pk_mul_f32 v[46:47], v[30:31], v[46:47] neg_lo:[1,0] neg_hi:[1,0]
    v_rcp_f32 v48, v48
    s_waitcnt lgkmcnt(12)
    v_mfma_f32_16x16x32_bf16 v[32:35], v[184:187], v[84:87], v[32:35]
    v_cvt_pk_bf16_f32 v56, v8, v9
    v_cvt_pk_bf16_f32 v57, v10, v11
    v_mfma_f32_16x16x32_bf16 v[32:35], v[188:191], v[88:91], v[32:35]
    v_rcp_f32 v49, v49
    v_mfma_f32_16x16x32_bf16 v[32:35], v[192:195], v[92:95], v[32:35]
    v_cvt_pk_bf16_f32 v58, v12, v13
    v_cvt_pk_bf16_f32 v59, v14, v15
    v_mfma_f32_16x16x32_bf16 v[36:39], v[196:199], v[84:87], v[36:39]
    v_rcp_f32 v50, v50
    v_mfma_f32_16x16x32_bf16 v[36:39], v[200:203], v[88:91], v[36:39]
    v_cvt_pk_bf16_f32 v120, v96, v97
    v_cvt_pk_bf16_f32 v121, v98, v99
    v_mfma_f32_16x16x32_bf16 v[36:39], v[204:207], v[92:95], v[36:39]
    v_rcp_f32 v51, v51
    v_cvt_pk_bf16_f32 v122, v100, v101
    s_waitcnt lgkmcnt(0)
    v_mfma_f32_16x16x32_bf16 v[60:63], v[208:211], v[56:59], v[60:63]
    v_cvt_pk_bf16_f32 v123, v102, v103
    v_mfma_f32_16x16x32_bf16 v[64:67], v[212:215], v[56:59], v[64:67]
    v_rcp_f32 v52, v52
    v_mfma_f32_16x16x32_bf16 v[68:71], v[216:219], v[56:59], v[68:71]
    v_rcp_f32 v53, v53
    v_rcp_f32 v54, v54
    v_mfma_f32_16x16x32_bf16 v[72:75], v[220:223], v[56:59], v[72:75]
    v_rcp_f32 v55, v55
    v_mfma_f32_16x16x32_bf16 v[76:79], v[224:227], v[56:59], v[76:79]
    v_exp_f32 v40, v40
    v_mfma_f32_16x16x32_bf16 v[80:83], v[228:231], v[56:59], v[80:83]
    v_exp_f32 v41, v41
    v_mfma_f32_16x16x32_bf16 v[132:135], v[208:211], v[120:123], v[132:135]
    v_exp_f32 v42, v42
    v_mfma_f32_16x16x32_bf16 v[136:139], v[212:215], v[120:123], v[136:139]
    v_exp_f32 v43, v43
    v_mfma_f32_16x16x32_bf16 v[140:143], v[216:219], v[120:123], v[140:143]
    v_exp_f32 v44, v44
    v_mfma_f32_16x16x32_bf16 v[144:147], v[220:223], v[120:123], v[144:147]
    v_exp_f32 v45, v45
    v_mfma_f32_16x16x32_bf16 v[148:151], v[224:227], v[120:123], v[148:151]
    v_exp_f32 v46, v46
    v_mfma_f32_16x16x32_bf16 v[152:155], v[228:231], v[120:123], v[152:155]
    v_exp_f32 v47, v47
    s_mov_b64 exec, s[52:53]
    s_nop 2
    ds_write_b128 v238, v[140:143] offset:512
    ds_write_b128 v238, v[144:147] offset:768
    ds_write_b128 v238, v[148:151] offset:1024
    ds_write_b128 v238, v[152:155] offset:1280
    s_mov_b64 exec, -1
    v_mov_b32 v4, 8
    ds_write_b32 v244, v4
    ds_read_b64_tr_b16 v[208:209], v233 offset:49408
    ds_read_b64_tr_b16 v[210:211], v233 offset:52512
    ds_read_b64_tr_b16 v[212:213], v233 offset:49416
    ds_read_b64_tr_b16 v[214:215], v233 offset:52520
    ds_read_b64_tr_b16 v[216:217], v233 offset:49472
    ds_read_b64_tr_b16 v[218:219], v233 offset:52576
    ds_read_b64_tr_b16 v[220:221], v233 offset:49480
    ds_read_b64_tr_b16 v[222:223], v233 offset:52584
    ds_read_b64_tr_b16 v[224:225], v233 offset:49536
    ds_read_b64_tr_b16 v[226:227], v233 offset:52640
    ds_read_b64_tr_b16 v[228:229], v233 offset:49544
    ds_read_b64_tr_b16 v[230:231], v233 offset:52648
    buffer_load_dwordx4 v[184:187], v255, s[20:23], s55 offen offset:0
    buffer_load_dwordx4 v[188:191], v255, s[20:23], s55 offen offset:64
    buffer_load_dwordx4 v[192:195], v255, s[20:23], s55 offen offset:128
    buffer_load_dwordx4 v[196:199], v251, s[20:23], s55 offen offset:0
    s_setprio 3
    s_nop 0
    v_pk_mul_f32 v[16:17], v[16:17], v[48:49]
    v_pk_mul_f32 v[18:19], v[18:19], v[50:51]
    v_pk_mul_f32 v[20:21], v[20:21], v[52:53]
    v_pk_mul_f32 v[22:23], v[22:23], v[54:55]
    v_pk_add_f32 v[40:41], v[40:41], s[62:63]
    v_pk_add_f32 v[42:43], v[42:43], s[62:63]
    v_pk_add_f32 v[44:45], v[44:45], s[62:63]
    v_pk_add_f32 v[46:47], v[46:47], s[62:63]
    v_pk_fma_f32 v[48:49], v[32:33], v[32:33], s[60:61]
    v_pk_fma_f32 v[50:51], v[34:35], v[34:35], s[60:61]
    v_pk_fma_f32 v[52:53], v[36:37], v[36:37], s[60:61]
    v_pk_fma_f32 v[54:55], v[38:39], v[38:39], s[60:61]
    v_pk_mul_f32 v[48:49], v[32:33], v[48:49] neg_lo:[1,0] neg_hi:[1,0]
    v_pk_mul_f32 v[50:51], v[34:35], v[50:51] neg_lo:[1,0] neg_hi:[1,0]
    v_pk_mul_f32 v[52:53], v[36:37], v[52:53] neg_lo:[1,0] neg_hi:[1,0]
    v_pk_mul_f32 v[54:55], v[38:39], v[54:55] neg_lo:[1,0] neg_hi:[1,0]
    v_cvt_pk_bf16_f32 v56, v16, v17
    v_cvt_pk_bf16_f32 v57, v18, v19
    v_cvt_pk_bf16_f32 v58, v20, v21
    v_cvt_pk_bf16_f32 v59, v22, v23
    v_rcp_f32 v40, v40
    v_rcp_f32 v41, v41
    s_waitcnt lgkmcnt(0)
    v_mfma_f32_16x16x32_bf16 v[60:63], v[208:211], v[56:59], v[60:63]
    v_rcp_f32 v42, v42
    v_rcp_f32 v43, v43
    v_mfma_f32_16x16x32_bf16 v[64:67], v[212:215], v[56:59], v[64:67]
    v_rcp_f32 v44, v44
    v_rcp_f32 v45, v45
    v_rcp_f32 v46, v46
    v_mfma_f32_16x16x32_bf16 v[68:71], v[216:219], v[56:59], v[68:71]
    v_rcp_f32 v47, v47
    v_exp_f32 v48, v48
    v_mfma_f32_16x16x32_bf16 v[72:75], v[220:223], v[56:59], v[72:75]
    v_exp_f32 v49, v49
    v_exp_f32 v50, v50
    v_mfma_f32_16x16x32_bf16 v[76:79], v[224:227], v[56:59], v[76:79]
    v_exp_f32 v51, v51
    v_exp_f32 v52, v52
    v_exp_f32 v53, v53
    v_mfma_f32_16x16x32_bf16 v[80:83], v[228:231], v[56:59], v[80:83]
    v_exp_f32 v54, v54
    v_exp_f32_e64 v55, v55
    v_add_u32 v233, 61760, v233
    ds_read_b64_tr_b16 v[208:209], v233 offset:0
    ds_read_b64_tr_b16 v[210:211], v233 offset:3104
    ds_read_b64_tr_b16 v[212:213], v233 offset:8
    ds_read_b64_tr_b16 v[214:215], v233 offset:3112
    ds_read_b64_tr_b16 v[216:217], v233 offset:64
    ds_read_b64_tr_b16 v[218:219], v233 offset:3168
    ds_read_b64_tr_b16 v[220:221], v233 offset:72
    ds_read_b64_tr_b16 v[222:223], v233 offset:3176
    ds_read_b64_tr_b16 v[224:225], v233 offset:128
    ds_read_b64_tr_b16 v[226:227], v233 offset:3232
    ds_read_b64_tr_b16 v[228:229], v233 offset:136
    ds_read_b64_tr_b16 v[230:231], v233 offset:3240
    v_pk_mul_f32 v[24:25], v[24:25], v[40:41]
    v_pk_mul_f32 v[26:27], v[26:27], v[42:43]
    v_pk_mul_f32 v[28:29], v[28:29], v[44:45]
    v_pk_mul_f32 v[30:31], v[30:31], v[46:47]
    v_pk_add_f32 v[48:49], v[48:49], s[62:63]
    v_pk_add_f32 v[50:51], v[50:51], s[62:63]
    v_pk_add_f32 v[52:53], v[52:53], s[62:63]
    v_pk_add_f32 v[54:55], v[54:55], s[62:63]
    v_cvt_pk_bf16_f32 v56, v24, v25
    v_cvt_pk_bf16_f32 v57, v26, v27
    v_cvt_pk_bf16_f32 v58, v28, v29
    v_cvt_pk_bf16_f32 v59, v30, v31
    v_rcp_f32 v48, v48
    v_rcp_f32 v49, v49
    s_waitcnt lgkmcnt(0)
    v_mfma_f32_16x16x32_bf16 v[60:63], v[208:211], v[56:59], v[60:63]
    v_rcp_f32 v50, v50
    v_mfma_f32_16x16x32_bf16 v[64:67], v[212:215], v[56:59], v[64:67]
    v_rcp_f32 v51, v51
    v_mfma_f32_16x16x32_bf16 v[68:71], v[216:219], v[56:59], v[68:71]
    v_rcp_f32 v52, v52
    v_mfma_f32_16x16x32_bf16 v[72:75], v[220:223], v[56:59], v[72:75]
    v_rcp_f32 v53, v53
    v_mfma_f32_16x16x32_bf16 v[76:79], v[224:227], v[56:59], v[76:79]
    v_rcp_f32 v54, v54
    v_mfma_f32_16x16x32_bf16 v[80:83], v[228:231], v[56:59], v[80:83]
    v_rcp_f32_e64 v55, v55
    ds_read_b64_tr_b16 v[208:209], v233 offset:12352
    ds_read_b64_tr_b16 v[210:211], v233 offset:15456
    ds_read_b64_tr_b16 v[212:213], v233 offset:12360
    ds_read_b64_tr_b16 v[214:215], v233 offset:15464
    ds_read_b64_tr_b16 v[216:217], v233 offset:12416
    ds_read_b64_tr_b16 v[218:219], v233 offset:15520
    ds_read_b64_tr_b16 v[220:221], v233 offset:12424
    ds_read_b64_tr_b16 v[222:223], v233 offset:15528
    ds_read_b64_tr_b16 v[224:225], v233 offset:12480
    ds_read_b64_tr_b16 v[226:227], v233 offset:15584
    ds_read_b64_tr_b16 v[228:229], v233 offset:12488
    ds_read_b64_tr_b16 v[230:231], v233 offset:15592
    v_pk_mul_f32 v[32:33], v[32:33], v[48:49]
    v_pk_mul_f32 v[34:35], v[34:35], v[50:51]
    v_pk_mul_f32 v[36:37], v[36:37], v[52:53]
    v_pk_mul_f32 v[38:39], v[38:39], v[54:55]
    ds_read_b128 v[168:171], v241 offset:512
    ds_read_b128 v[172:175], v241 offset:528
    ds_read_b128 v[176:179], v241 offset:640
    ds_read_b128 v[180:183], v241 offset:656
    ds_read_b128 v[84:87], v241 offset:768
    ds_read_b128 v[88:91], v241 offset:784
    s_waitcnt vmcnt(0)
    v_cvt_pk_bf16_f32 v56, v32, v33
    v_cvt_pk_bf16_f32 v57, v34, v35
    v_cvt_pk_bf16_f32 v58, v36, v37
    v_cvt_pk_bf16_f32 v59, v38, v39
    v_lshlrev_b32 v8, 16, v184
    v_and_b32 v9, v7, v184
    s_waitcnt lgkmcnt(6)
    v_mfma_f32_16x16x32_bf16 v[60:63], v[208:211], v[56:59], v[60:63]
    v_lshlrev_b32 v10, 16, v185
    v_and_b32 v11, v7, v185
    v_lshlrev_b32 v12, 16, v186
    v_and_b32 v13, v7, v186
    v_mfma_f32_16x16x32_bf16 v[64:67], v[212:215], v[56:59], v[64:67]
    v_lshlrev_b32 v14, 16, v187
    v_and_b32 v15, v7, v187
    v_lshlrev_b32 v16, 16, v188
    v_mfma_f32_16x16x32_bf16 v[68:71], v[216:219], v[56:59], v[68:71]
    v_and_b32 v17, v7, v188
    v_lshlrev_b32 v18, 16, v189
    v_and_b32 v19, v7, v189
    v_lshlrev_b32 v20, 16, v190
    v_mfma_f32_16x16x32_bf16 v[72:75], v[220:223], v[56:59], v[72:75]
    v_and_b32 v21, v7, v190
    v_lshlrev_b32 v22, 16, v191
    v_and_b32 v23, v7, v191
    v_lshlrev_b32 v24, 16, v192
    v_mfma_f32_16x16x32_bf16 v[76:79], v[224:227], v[56:59], v[76:79]
    v_and_b32 v25, v7, v192
    v_lshlrev_b32 v26, 16, v193
    v_and_b32 v27, v7, v193
    v_mfma_f32_16x16x32_bf16 v[80:83], v[228:231], v[56:59], v[80:83]
    v_lshlrev_b32 v28, 16, v194
    v_and_b32 v29, v7, v194
    v_lshlrev_b32 v30, 16, v195
    v_and_b32 v31, v7, v195
    s_waitcnt lgkmcnt(0)
    v_lshlrev_b32 v96, 16, v196
    v_and_b32 v97, v7, v196
    v_lshlrev_b32 v98, 16, v197
    v_and_b32 v99, v7, v197
    v_lshlrev_b32 v100, 16, v198
    v_and_b32 v101, v7, v198
    v_lshlrev_b32 v102, 16, v199
    v_and_b32_e64 v103, v7, v199
    v_pk_fma_f32 v[8:9], v[60:61], v[168:169], v[8:9]
    v_pk_fma_f32 v[10:11], v[62:63], v[170:171], v[10:11]
    v_pk_fma_f32 v[12:13], v[64:65], v[172:173], v[12:13]
    v_pk_fma_f32 v[14:15], v[66:67], v[174:175], v[14:15]
    v_cvt_pk_bf16_f32 v208, v8, v9
    v_cvt_pk_bf16_f32 v209, v10, v11
    v_cvt_pk_bf16_f32 v210, v12, v13
    v_cvt_pk_bf16_f32 v211, v14, v15
    ds_write_b128 v254, v[208:211] offset:0
    v_pk_fma_f32 v[16:17], v[68:69], v[176:177], v[16:17]
    v_pk_fma_f32 v[18:19], v[70:71], v[178:179], v[18:19]
    v_pk_fma_f32 v[20:21], v[72:73], v[180:181], v[20:21]
    v_pk_fma_f32 v[22:23], v[74:75], v[182:183], v[22:23]
    v_cvt_pk_bf16_f32 v212, v16, v17
    v_cvt_pk_bf16_f32 v213, v18, v19
    v_cvt_pk_bf16_f32 v214, v20, v21
    v_cvt_pk_bf16_f32 v215, v22, v23
    ds_write_b128 v254, v[212:215] offset:64
    ds_read_b32 v5, v245
    v_pk_fma_f32 v[24:25], v[76:77], v[84:85], v[24:25]
    v_pk_fma_f32 v[26:27], v[78:79], v[86:87], v[26:27]
    v_pk_fma_f32 v[28:29], v[80:81], v[88:89], v[28:29]
    v_pk_fma_f32 v[30:31], v[82:83], v[90:91], v[30:31]
    v_cvt_pk_bf16_f32 v216, v24, v25
    v_cvt_pk_bf16_f32 v217, v26, v27
    v_cvt_pk_bf16_f32 v218, v28, v29
    v_cvt_pk_bf16_f32 v219, v30, v31
    ds_write_b128 v254, v[216:219] offset:128
    s_waitcnt lgkmcnt(0)
    ds_read_b128 v[184:187], v243 offset:0
    ds_read_b128 v[188:191], v243 offset:1024
    ds_read_b128 v[192:195], v243 offset:2048
    v_cmp_le_u32 vcc, 8, v5
    s_and_b32 s47, vcc_lo, 15
    s_cmp_eq_u32 s47, 15
    s_cbranch_scc0 L_mb0_slow
    ds_read_b128 v[8:11], v238 offset:1536
    ds_read_b128 v[12:15], v238 offset:1792
    ds_read_b128 v[16:19], v238 offset:3072
    ds_read_b128 v[20:23], v238 offset:3328
    ds_read_b128 v[24:27], v238 offset:4608
    ds_read_b128 v[28:31], v238 offset:4864
    s_waitcnt lgkmcnt(8)
    buffer_store_dwordx4 v[184:187], v248, s[36:39], s55 offen sc1
    s_waitcnt lgkmcnt(7)
    buffer_store_dwordx4 v[188:191], v249, s[36:39], s55 offen sc1
    s_waitcnt lgkmcnt(6)
    buffer_store_dwordx4 v[192:195], v250, s[36:39], s55 offen sc1
L_mb0_join:
    s_waitcnt lgkmcnt(4)
    v_pk_add_f32 v[132:133], v[132:133], v[8:9]
    v_pk_add_f32 v[134:135], v[134:135], v[10:11]
    v_pk_add_f32 v[136:137], v[136:137], v[12:13]
    v_pk_add_f32 v[138:139], v[138:139], v[14:15]
    s_waitcnt lgkmcnt(2)
    v_pk_add_f32 v[132:133], v[132:133], v[16:17]
    v_pk_add_f32 v[134:135], v[134:135], v[18:19]
    v_pk_add_f32 v[136:137], v[136:137], v[20:21]
    v_pk_add_f32 v[138:139], v[138:139], v[22:23]
    s_waitcnt lgkmcnt(0)
    s_nop 0
    v_pk_add_f32 v[132:133], v[132:133], v[24:25]
    v_pk_add_f32 v[134:135], v[134:135], v[26:27]
    v_pk_add_f32 v[136:137], v[136:137], v[28:29]
    v_pk_add_f32 v[138:139], v[138:139], v[30:31]
    v_pk_fma_f32 v[96:97], v[132:133], v[168:169], v[96:97]
    v_pk_fma_f32 v[98:99], v[134:135], v[170:171], v[98:99]
    v_pk_fma_f32 v[100:101], v[136:137], v[172:173], v[100:101]
    v_pk_fma_f32 v[102:103], v[138:139], v[174:175], v[102:103]
    v_cvt_pk_bf16_f32 v120, v96, v97
    v_cvt_pk_bf16_f32 v121, v98, v99
    v_cvt_pk_bf16_f32 v122, v100, v101
    v_cvt_pk_bf16_f32 v123, v102, v103
    buffer_store_dwordx4 v[120:123], v251, s[36:39], s55 offen offset:0 sc1
    s_endpgm
L_mb0_slow:
    s_waitcnt lgkmcnt(0)
    buffer_store_dwordx4 v[184:187], v248, s[36:39], s55 offen sc1
    buffer_store_dwordx4 v[188:191], v249, s[36:39], s55 offen sc1
    buffer_store_dwordx4 v[192:195], v250, s[36:39], s55 offen sc1
L_mb0:
    ds_read_b32 v5, v245
    s_waitcnt lgkmcnt(0)
    v_cmp_le_u32 vcc, 8, v5
    s_and_b32 s47, vcc_lo, 15
    s_cmp_eq_u32 s47, 15
    s_cbranch_scc0 L_mb0
    ds_read_b128 v[8:11], v238 offset:1536
    ds_read_b128 v[12:15], v238 offset:1792
    ds_read_b128 v[16:19], v238 offset:3072
    ds_read_b128 v[20:23], v238 offset:3328
    ds_read_b128 v[24:27], v238 offset:4608
    ds_read_b128 v[28:31], v238 offset:4864
    s_branch L_mb0_join
L_n1:
    ds_read_b128 v[16:19], v240 offset:128
    ds_read_b128 v[20:23], v240 offset:192
    ds_read_b128 v[96:99], v240 offset:128
    ds_read_b128 v[100:103], v240 offset:192
    ds_read_b64_tr_b16 v[184:185], v232 offset:12352
    ds_read_b64_tr_b16 v[186:187], v232 offset:13376
    ds_read_b64_tr_b16 v[188:189], v232 offset:14400
    ds_read_b64_tr_b16 v[190:191], v232 offset:15424
    ds_read_b64_tr_b16 v[192:193], v232 offset:16448
    ds_read_b64_tr_b16 v[194:195], v232 offset:17472
    ds_read_b64_tr_b16 v[196:197], v237 offset:12352
    ds_read_b64_tr_b16 v[198:199], v237 offset:13376
    ds_read_b64_tr_b16 v[200:201], v237 offset:14400
    ds_read_b64_tr_b16 v[202:203], v237 offset:15424
    ds_read_b64_tr_b16 v[204:205], v237 offset:16448
    ds_read_b64_tr_b16 v[206:207], v237 offset:17472
    s_mov_b32 exec_hi, 0xffff
    s_add_u32 m0, s57, 61760
    s_movk_i32 s59, 320
    buffer_load_dwordx4 v236, s[28:31], s59 offen lds
    s_add_u32 m0, s58, 24704
    s_mov_b32 s59, 12288
    buffer_load_dwordx4 v242, s[32:35], s59 offen lds
    s_add_u32 m0, s57, 74112
    s_movk_i32 s59, 384
    buffer_load_dwordx4 v236, s[28:31], s59 offen lds
    s_mov_b32 exec_hi, -1
    s_setprio 2
    v_pk_fma_f32 v[40:41], v[8:9], v[8:9], s[60:61]
    v_pk_fma_f32 v[42:43], v[10:11], v[10:11], s[60:61]
    v_pk_fma_f32 v[44:45], v[12:13], v[12:13], s[60:61]
    v_pk_fma_f32 v[46:47], v[14:15], v[14:15], s[60:61]
    v_pk_mul_f32 v[40:41], v[8:9], v[40:41] neg_lo:[1,0] neg_hi:[1,0]
    v_pk_mul_f32 v[42:43], v[10:11], v[42:43] neg_lo:[1,0] neg_hi:[1,0]
    v_pk_mul_f32 v[44:45], v[12:13], v[44:45] neg_lo:[1,0] neg_hi:[1,0]
    v_pk_mul_f32 v[46:47], v[14:15], v[46:47] neg_lo:[1,0] neg_hi:[1,0]
    v_exp_f32 v40, v40
    s_waitcnt lgkmcnt(0)
    v_mfma_f32_16x16x32_bf16 v[16:19], v[184:187], v[84:87], v[16:19]
    v_exp_f32 v41, v41
    v_mfma_f32_16x16x32_bf16 v[16:19], v[188:191], v[88:91], v[16:19]
    v_mfma_f32_16x16x32_bf16 v[16:19], v[192:195], v[92:95], v[16:19]
    v_exp_f32 v42, v42
    v_mfma_f32_16x16x32_bf16 v[20:23], v[196:199], v[84:87], v[20:23]
    v_mfma_f32_16x16x32_bf16 v[20:23], v[200:203], v[88:91], v[20:23]
    v_exp_f32 v43, v43
    v_mfma_f32_16x16x32_bf16 v[20:23], v[204:207], v[92:95], v[20:23]
    v_exp_f32 v44, v44
    v_mfma_f32_16x16x32_bf16 v[96:99], v[184:187], v[156:159], v[96:99]
    v_mfma_f32_16x16x32_bf16 v[96:99], v[188:191], v[160:163], v[96:99]
    v_exp_f32 v45, v45
    v_mfma_f32_16x16x32_bf16 v[96:99], v[192:195], v[164:167], v[96:99]
    v_mfma_f32_16x16x32_bf16 v[100:103], v[196:199], v[156:159], v[100:103]
    v_exp_f32 v46, v46
    v_mfma_f32_16x16x32_bf16 v[100:103], v[200:203], v[160:163], v[100:103]
    v_mfma_f32_16x16x32_bf16 v[100:103], v[204:207], v[164:167], v[100:103]
    v_exp_f32_e64 v47, v47
    ds_read_b128 v[24:27], v240 offset:256
    ds_read_b128 v[28:31], v240 offset:320
    ds_read_b64_tr_b16 v[184:185], v232 offset:24704
    ds_read_b64_tr_b16 v[186:187], v232 offset:25728
    ds_read_b64_tr_b16 v[188:189], v232 offset:26752
    ds_read_b64_tr_b16 v[190:191], v232 offset:27776
    ds_read_b64_tr_b16 v[192:193], v232 offset:28800
    ds_read_b64_tr_b16 v[194:195], v232 offset:29824
    ds_read_b64_tr_b16 v[196:197], v237 offset:24704
    ds_read_b64_tr_b16 v[198:199], v237 offset:25728
    ds_read_b64_tr_b16 v[200:201], v237 offset:26752
    ds_read_b64_tr_b16 v[202:203], v237 offset:27776
    ds_read_b64_tr_b16 v[204:205], v237 offset:28800
    ds_read_b64_tr_b16 v[206:207], v237 offset:29824
    ds_read_b128 v[60:63], v241 offset:0
    ds_read_b128 v[64:67], v241 offset:16
    ds_read_b128 v[68:71], v241 offset:128
    ds_read_b128 v[72:75], v241 offset:144
    ds_read_b128 v[76:79], v241 offset:256
    ds_read_b128 v[80:83], v241 offset:272
    s_mov_b32 exec_hi, 0xffff
    s_add_u32 m0, s58, 37056
    s_mov_b32 s59, 18432
    buffer_load_dwordx4 v242, s[32:35], s59 offen lds
    s_add_u32 m0, s57, 86464
    s_movk_i32 s59, 448
    buffer_load_dwordx4 v236, s[28:31], s59 offen lds
    s_add_u32 m0, s58, 49408
    s_mov_b32 s59, 24576
    buffer_load_dwordx4 v242, s[32:35], s59 offen lds
    s_mov_b32 exec_hi, -1
    v_pk_add_f32 v[40:41], v[40:41], s[62:63]
    v_pk_add_f32 v[42:43], v[42:43], s[62:63]
    v_pk_add_f32 v[44:45], v[44:45], s[62:63]
    v_pk_add_f32 v[46:47], v[46:47], s[62:63]
    v_pk_fma_f32 v[48:49], v[16:17], v[16:17], s[60:61]
    v_pk_fma_f32 v[50:51], v[18:19], v[18:19], s[60:61]
    v_pk_fma_f32 v[52:53], v[20:21], v[20:21], s[60:61]
    v_pk_fma_f32 v[54:55], v[22:23], v[22:23], s[60:61]
    v_pk_mul_f32 v[48:49], v[16:17], v[48:49] neg_lo:[1,0] neg_hi:[1,0]
    v_pk_mul_f32 v[50:51], v[18:19], v[50:51] neg_lo:[1,0] neg_hi:[1,0]
    v_pk_mul_f32 v[52:53], v[20:21], v[52:53] neg_lo:[1,0] neg_hi:[1,0]
    v_pk_mul_f32 v[54:55], v[22:23], v[54:55] neg_lo:[1,0] neg_hi:[1,0]
    v_pk_fma_f32 v[112:113], v[96:97], v[96:97], s[60:61]
    v_pk_fma_f32 v[114:115], v[98:99], v[98:99], s[60:61]
    v_pk_fma_f32 v[116:117], v[100:101], v[100:101], s[60:61]
    v_pk_fma_f32 v[118:119], v[102:103], v[102:103], s[60:61]
    v_pk_mul_f32 v[112:113], v[96:97], v[112:113] neg_lo:[1,0] neg_hi:[1,0]
    v_pk_mul_f32 v[114:115], v[98:99], v[114:115] neg_lo:[1,0] neg_hi:[1,0]
    v_pk_mul_f32 v[116:117], v[100:101], v[116:117] neg_lo:[1,0] neg_hi:[1,0]
    v_pk_mul_f32 v[118:119], v[102:103], v[118:119] neg_lo:[1,0] neg_hi:[1,0]
    v_rcp_f32 v40, v40
    s_waitcnt lgkmcnt(6)
    v_mfma_f32_16x16x32_bf16 v[24:27], v[184:187], v[84:87], v[24:27]
    v_rcp_f32 v41, v41
    v_rcp_f32 v42, v42
    v_rcp_f32 v43, v43
    v_rcp_f32 v44, v44
    v_mfma_f32_16x16x32_bf16 v[24:27], v[188:191], v[88:91], v[24:27]
    v_rcp_f32 v45, v45
    v_rcp_f32 v46, v46
    v_rcp_f32 v47, v47
    v_exp_f32 v48, v48
    v_mfma_f32_16x16x32_bf16 v[24:27], v[192:195], v[92:95], v[24:27]
    v_exp_f32 v49, v49
    v_exp_f32 v50, v50
    v_exp_f32 v51, v51
    v_exp_f32 v52, v52
    v_mfma_f32_16x16x32_bf16 v[28:31], v[196:199], v[84:87], v[28:31]
    v_exp_f32 v53, v53
    v_exp_f32 v54, v54
    v_exp_f32 v55, v55
    v_mfma_f32_16x16x32_bf16 v[28:31], v[200:203], v[88:91], v[28:31]
    v_exp_f32 v112, v112
    v_exp_f32 v113, v113
    v_exp_f32 v114, v114
    v_exp_f32 v115, v115
    v_mfma_f32_16x16x32_bf16 v[28:31], v[204:207], v[92:95], v[28:31]
    v_exp_f32 v116, v116
    v_exp_f32 v117, v117
    v_exp_f32 v118, v118
    v_exp_f32_e64 v119, v119
    ds_read_b128 v[32:35], v240 offset:384
    ds_read_b128 v[36:39], v240 offset:448
    ds_read_b64_tr_b16 v[184:185], v232 offset:37056
    ds_read_b64_tr_b16 v[186:187], v232 offset:38080
    ds_read_b64_tr_b16 v[188:189], v232 offset:39104
    ds_read_b64_tr_b16 v[190:191], v232 offset:40128
    ds_read_b64_tr_b16 v[192:193], v232 offset:41152
    ds_read_b64_tr_b16 v[194:195], v232 offset:42176
    ds_read_b64_tr_b16 v[196:197], v237 offset:37056
    ds_read_b64_tr_b16 v[198:199], v237 offset:38080
    ds_read_b64_tr_b16 v[200:201], v237 offset:39104
    ds_read_b64_tr_b16 v[202:203], v237 offset:40128
    ds_read_b64_tr_b16 v[204:205], v237 offset:41152
    ds_read_b64_tr_b16 v[206:207], v237 offset:42176
    ds_read_b64_tr_b16 v[208:209], v233 offset:0
    ds_read_b64_tr_b16 v[210:211], v233 offset:3104
    ds_read_b64_tr_b16 v[212:213], v233 offset:8
    ds_read_b64_tr_b16 v[214:215], v233 offset:3112
    ds_read_b64_tr_b16 v[216:217], v233 offset:64
    ds_read_b64_tr_b16 v[218:219], v233 offset:3168
    ds_read_b64_tr_b16 v[220:221], v233 offset:72
    ds_read_b64_tr_b16 v[222:223], v233 offset:3176
    ds_read_b64_tr_b16 v[224:225], v233 offset:128
    ds_read_b64_tr_b16 v[226:227], v233 offset:3232
    ds_read_b64_tr_b16 v[228:229], v233 offset:136
    ds_read_b64_tr_b16 v[230:231], v233 offset:3240
    s_waitcnt vmcnt(0)
    v_mov_b32 v4, 5
    ds_write_b32 v244, v4
    s_mov_b32 exec_hi, 0xffff
    s_add_u32 m0, s57, 98816
    s_movk_i32 s59, 512
    buffer_load_dwordx4 v236, s[28:31], s59 offen lds
    s_add_u32 m0, s58, 61760
    s_mov_b32 s59, 30720
    buffer_load_dwordx4 v242, s[32:35], s59 offen lds
    s_mov_b32 exec_hi, -1
    v_pk_mul_f32 v[8:9], v[8:9], v[40:41]
    v_pk_mul_f32 v[10:11], v[10:11], v[42:43]
    v_pk_mul_f32 v[12:13], v[12:13], v[44:45]
    v_pk_mul_f32 v[14:15], v[14:15], v[46:47]
    v_pk_add_f32 v[48:49], v[48:49], s[62:63]
    v_pk_add_f32 v[50:51], v[50:51], s[62:63]
    v_pk_add_f32 v[52:53], v[52:53], s[62:63]
    v_pk_add_f32 v[54:55], v[54:55], s[62:63]
    v_pk_add_f32 v[112:113], v[112:113], s[62:63]
    v_pk_add_f32 v[114:115], v[114:115], s[62:63]
    v_pk_add_f32 v[116:117], v[116:117], s[62:63]
    v_pk_add_f32 v[118:119], v[118:119], s[62:63]
    v_pk_fma_f32 v[40:41], v[24:25], v[24:25], s[60:61]
    v_pk_fma_f32 v[42:43], v[26:27], v[26:27], s[60:61]
    v_pk_fma_f32 v[44:45], v[28:29], v[28:29], s[60:61]
    v_pk_fma_f32 v[46:47], v[30:31], v[30:31], s[60:61]
    v_pk_mul_f32 v[40:41], v[24:25], v[40:41] neg_lo:[1,0] neg_hi:[1,0]
    v_pk_mul_f32 v[42:43], v[26:27], v[42:43] neg_lo:[1,0] neg_hi:[1,0]
    v_pk_mul_f32 v[44:45], v[28:29], v[44:45] neg_lo:[1,0] neg_hi:[1,0]
    v_pk_mul_f32 v[46:47], v[30:31], v[46:47] neg_lo:[1,0] neg_hi:[1,0]
    v_rcp_f32 v48, v48
    s_waitcnt lgkmcnt(13)
    v_mfma_f32_16x16x32_bf16 v[32:35], v[184:187], v[84:87], v[32:35]
    v_cvt_pk_bf16_f32 v56, v8, v9
    v_cvt_pk_bf16_f32 v57, v10, v11
    v_rcp_f32 v49, v49
    v_mfma_f32_16x16x32_bf16 v[32:35], v[188:191], v[88:91], v[32:35]
    v_cvt_pk_bf16_f32 v58, v12, v13
    v_cvt_pk_bf16_f32 v59, v14, v15
    v_rcp_f32 v50, v50
    v_mfma_f32_16x16x32_bf16 v[32:35], v[192:195], v[92:95], v[32:35]
    v_rcp_f32 v51, v51
    v_rcp_f32 v52, v52
    v_mfma_f32_16x16x32_bf16 v[36:39], v[196:199], v[84:87], v[36:39]
    v_rcp_f32 v53, v53
    v_rcp_f32 v54, v54
    v_mfma_f32_16x16x32_bf16 v[36:39], v[200:203], v[88:91], v[36:39]
    v_rcp_f32 v55, v55
    v_exp_f32 v40, v40
    v_mfma_f32_16x16x32_bf16 v[36:39], v[204:207], v[92:95], v[36:39]
    v_exp_f32 v41, v41
    v_exp_f32 v42, v42
    v_exp_f32 v43, v43
    s_waitcnt lgkmcnt(0)
    v_mfma_f32_16x16x32_bf16 v[60:63], v[208:211], v[56:59], v[60:63]
    v_exp_f32 v44, v44
    v_exp_f32 v45, v45
    v_mfma_f32_16x16x32_bf16 v[64:67], v[212:215], v[56:59], v[64:67]
    v_exp_f32 v46, v46
    v_exp_f32 v47, v47
    v_mfma_f32_16x16x32_bf16 v[68:71], v[216:219], v[56:59], v[68:71]
    v_rcp_f32 v112, v112
    v_rcp_f32 v113, v113
    v_mfma_f32_16x16x32_bf16 v[72:75], v[220:223], v[56:59], v[72:75]
    v_rcp_f32 v114, v114
    v_rcp_f32 v115, v115
    v_mfma_f32_16x16x32_bf16 v[76:79], v[224:227], v[56:59], v[76:79]
    v_rcp_f32 v116, v116
    v_rcp_f32 v117, v117
    v_mfma_f32_16x16x32_bf16 v[80:83], v[228:231], v[56:59], v[80:83]
    v_rcp_f32 v118, v118
    v_rcp_f32 v119, v119
    ds_read_b128 v[8:11], v240 offset:512
    ds_read_b128 v[12:15], v240 offset:576
    ds_read_b64_tr_b16 v[184:185], v232 offset:49408
    ds_read_b64_tr_b16 v[186:187], v232 offset:50432
    ds_read_b64_tr_b16 v[188:189], v232 offset:51456
    ds_read_b64_tr_b16 v[190:191], v232 offset:52480
    ds_read_b64_tr_b16 v[192:193], v232 offset:53504
    ds_read_b64_tr_b16 v[194:195], v232 offset:54528
    ds_read_b64_tr_b16 v[196:197], v237 offset:49408
    ds_read_b64_tr_b16 v[198:199], v237 offset:50432
    ds_read_b64_tr_b16 v[200:201], v237 offset:51456
    ds_read_b64_tr_b16 v[202:203], v237 offset:52480
    ds_read_b64_tr_b16 v[204:205], v237 offset:53504
    ds_read_b64_tr_b16 v[206:207], v237 offset:54528
    ds_read_b64_tr_b16 v[208:209], v233 offset:12352
    ds_read_b64_tr_b16 v[210:211], v233 offset:15456
    ds_read_b64_tr_b16 v[212:213], v233 offset:12360
    ds_read_b64_tr_b16 v[214:215], v233 offset:15464
    ds_read_b64_tr_b16 v[216:217], v233 offset:12416
    ds_read_b64_tr_b16 v[218:219], v233 offset:15520
    ds_read_b64_tr_b16 v[220:221], v233 offset:12424
    ds_read_b64_tr_b16 v[222:223], v233 offset:15528
    ds_read_b64_tr_b16 v[224:225], v233 offset:12480
    ds_read_b64_tr_b16 v[226:227], v233 offset:15584
    ds_read_b64_tr_b16 v[228:229], v233 offset:12488
    ds_read_b64_tr_b16 v[230:231], v233 offset:15592
    ds_read_b32 v5, v245
    s_mov_b32 exec_hi, 0xffff
    s_add_u32 m0, s57, 111168
    s_movk_i32 s59, 576
    buffer_load_dwordx4 v236, s[28:31], s59 offen lds
    s_add_u32 m0, s58, 74112
    s_mov_b32 s59, 36864
    buffer_load_dwordx4 v242, s[32:35], s59 offen lds
    s_mov_b32 exec_hi, -1
    s_setprio 1
    s_nop 0
    v_pk_mul_f32 v[16:17], v[16:17], v[48:49]
    v_pk_mul_f32 v[18:19], v[18:19], v[50:51]
    v_pk_mul_f32 v[20:21], v[20:21], v[52:53]
    v_pk_mul_f32 v[22:23], v[22:23], v[54:55]
    v_pk_add_f32 v[40:41], v[40:41], s[62:63]
    v_pk_add_f32 v[42:43], v[42:43], s[62:63]
    v_pk_add_f32 v[44:45], v[44:45], s[62:63]
    v_pk_add_f32 v[46:47], v[46:47], s[62:63]
    v_pk_mul_f32 v[96:97], v[96:97], v[112:113]
    v_pk_mul_f32 v[98:99], v[98:99], v[114:115]
    v_pk_mul_f32 v[100:101], v[100:101], v[116:117]
    v_pk_mul_f32 v[102:103], v[102:103], v[118:119]
    v_pk_fma_f32 v[48:49], v[32:33], v[32:33], s[60:61]
    v_pk_fma_f32 v[50:51], v[34:35], v[34:35], s[60:61]
    v_pk_fma_f32 v[52:53], v[36:37], v[36:37], s[60:61]
    v_pk_fma_f32 v[54:55], v[38:39], v[38:39], s[60:61]
    v_pk_mul_f32 v[48:49], v[32:33], v[48:49] neg_lo:[1,0] neg_hi:[1,0]
    v_pk_mul_f32 v[50:51], v[34:35], v[50:51] neg_lo:[1,0] neg_hi:[1,0]
    v_pk_mul_f32 v[52:53], v[36:37], v[52:53] neg_lo:[1,0] neg_hi:[1,0]
    v_pk_mul_f32 v[54:55], v[38:39], v[54:55] neg_lo:[1,0] neg_hi:[1,0]
    v_rcp_f32 v40, v40
    s_waitcnt lgkmcnt(13)
    v_mfma_f32_16x16x32_bf16 v[8:11], v[184:187], v[84:87], v[8:11]
    v_cvt_pk_bf16_f32 v56, v16, v17
    v_cvt_pk_bf16_f32 v57, v18, v19
    v_mfma_f32_16x16x32_bf16 v[8:11], v[188:191], v[88:91], v[8:11]
    v_rcp_f32 v41, v41
    v_mfma_f32_16x16x32_bf16 v[8:11], v[192:195], v[92:95], v[8:11]
    v_cvt_pk_bf16_f32 v58, v20, v21
    v_cvt_pk_bf16_f32 v59, v22, v23
    v_mfma_f32_16x16x32_bf16 v[12:15], v[196:199], v[84:87], v[12:15]
    v_rcp_f32 v42, v42
    v_mfma_f32_16x16x32_bf16 v[12:15], v[200:203], v[88:91], v[12:15]
    v_cvt_pk_bf16_f32 v120, v96, v97
    v_cvt_pk_bf16_f32 v121, v98, v99
    v_mfma_f32_16x16x32_bf16 v[12:15], v[204:207], v[92:95], v[12:15]
    v_rcp_f32 v43, v43
    v_cvt_pk_bf16_f32 v122, v100, v101
    s_waitcnt lgkmcnt(0)
    v_mfma_f32_16x16x32_bf16 v[60:63], v[208:211], v[56:59], v[60:63]
    v_cvt_pk_bf16_f32 v123, v102, v103
    v_mfma_f32_16x16x32_bf16 v[64:67], v[212:215], v[56:59], v[64:67]
    v_rcp_f32 v44, v44
    v_mfma_f32_16x16x32_bf16 v[68:71], v[216:219], v[56:59], v[68:71]
    v_rcp_f32 v45, v45
    v_rcp_f32 v46, v46
    v_mfma_f32_16x16x32_bf16 v[72:75], v[220:223], v[56:59], v[72:75]
    v_rcp_f32 v47, v47
    v_mfma_f32_16x16x32_bf16 v[76:79], v[224:227], v[56:59], v[76:79]
    v_exp_f32 v48, v48
    v_mfma_f32_16x16x32_bf16 v[80:83], v[228:231], v[56:59], v[80:83]
    v_exp_f32 v49, v49
    v_mfma_f32_16x16x32_bf16 v[132:135], v[208:211], v[120:123], 0
    v_exp_f32 v50, v50
    v_mfma_f32_16x16x32_bf16 v[136:139], v[212:215], v[120:123], 0
    v_exp_f32 v51, v51
    v_mfma_f32_16x16x32_bf16 v[140:143], v[216:219], v[120:123], 0
    v_exp_f32 v52, v52
    v_mfma_f32_16x16x32_bf16 v[144:147], v[220:223], v[120:123], 0
    v_exp_f32 v53, v53
    v_mfma_f32_16x16x32_bf16 v[148:151], v[224:227], v[120:123], 0
    v_exp_f32 v54, v54
    v_mfma_f32_16x16x32_bf16 v[152:155], v[228:231], v[120:123], 0
    v_exp_f32 v55, v55
    v_cmp_le_u32 vcc, 5, v5
    s_cmp_eq_u64 vcc, -1
    s_cbranch_scc1 L_gate_N1_3_ok
L_gate_N1_3:
    ds_read_b32 v5, v245
    s_waitcnt lgkmcnt(0)
    v_cmp_le_u32 vcc, 5, v5
    s_cmp_eq_u64 vcc, -1
    s_cbranch_scc0 L_gate_N1_3
L_gate_N1_3_ok:
    s_nop 0
    v_add_u32 v232, 61760, v232
    v_add_u32 v237, 61760, v237
    ds_read_b128 v[16:19], v240 offset:640
    ds_read_b128 v[20:23], v240 offset:704
    ds_read_b128 v[96:99], v240 offset:640
    ds_read_b128 v[100:103], v240 offset:704
    ds_read_b64_tr_b16 v[184:185], v232 offset:0
    ds_read_b64_tr_b16 v[186:187], v232 offset:1024
    ds_read_b64_tr_b16 v[188:189], v232 offset:2048
    ds_read_b64_tr_b16 v[190:191], v232 offset:3072
    ds_read_b64_tr_b16 v[192:193], v232 offset:4096
    ds_read_b64_tr_b16 v[194:195], v232 offset:5120
    ds_read_b64_tr_b16 v[196:197], v237 offset:0
    ds_read_b64_tr_b16 v[198:199], v237 offset:1024
    ds_read_b64_tr_b16 v[200:201], v237 offset:2048
    ds_read_b64_tr_b16 v[202:203], v237 offset:3072
    ds_read_b64_tr_b16 v[204:205], v237 offset:4096
    ds_read_b64_tr_b16 v[206:207], v237 offset:5120
    ds_read_b64_tr_b16 v[208:209], v233 offset:24704
    ds_read_b64_tr_b16 v[210:211], v233 offset:27808
    ds_read_b64_tr_b16 v[212:213], v233 offset:24712
    ds_read_b64_tr_b16 v[214:215], v233 offset:27816
    ds_read_b64_tr_b16 v[216:217], v233 offset:24768
    ds_read_b64_tr_b16 v[218:219], v233 offset:27872
    ds_read_b64_tr_b16 v[220:221], v233 offset:24776
    ds_read_b64_tr_b16 v[222:223], v233 offset:27880
    ds_read_b64_tr_b16 v[224:225], v233 offset:24832
    ds_read_b64_tr_b16 v[226:227], v233 offset:27936
    ds_read_b64_tr_b16 v[228:229], v233 offset:24840
    ds_read_b64_tr_b16 v[230:231], v233 offset:27944
    s_mov_b32 exec_hi, 0xffff
    s_add_u32 m0, s57, 123520
    s_movk_i32 s59, 640
    buffer_load_dwordx4 v236, s[28:31], s59 offen lds
    s_add_u32 m0, s58, 86464
    s_mov_b32 s59, 43008
    buffer_load_dwordx4 v242, s[32:35], s59 offen lds
    s_mov_b32 exec_hi, -1
    v_pk_mul_f32 v[24:25], v[24:25], v[40:41]
    v_pk_mul_f32 v[26:27], v[26:27], v[42:43]
    v_pk_mul_f32 v[28:29], v[28:29], v[44:45]
    v_pk_mul_f32 v[30:31], v[30:31], v[46:47]
    v_pk_add_f32 v[48:49], v[48:49], s[62:63]
    v_pk_add_f32 v[50:51], v[50:51], s[62:63]
    v_pk_add_f32 v[52:53], v[52:53], s[62:63]
    v_pk_add_f32 v[54:55], v[54:55], s[62:63]
    v_pk_fma_f32 v[40:41], v[8:9], v[8:9], s[60:61]
    v_pk_fma_f32 v[42:43], v[10:11], v[10:11], s[60:61]
    v_pk_fma_f32 v[44:45], v[12:13], v[12:13], s[60:61]
    v_pk_fma_f32 v[46:47], v[14:15], v[14:15], s[60:61]
    v_pk_mul_f32 v[40:41], v[8:9], v[40:41] neg_lo:[1,0] neg_hi:[1,0]
    v_pk_mul_f32 v[42:43], v[10:11], v[42:43] neg_lo:[1,0] neg_hi:[1,0]
    v_pk_mul_f32 v[44:45], v[12:13], v[44:45] neg_lo:[1,0] neg_hi:[1,0]
    v_pk_mul_f32 v[46:47], v[14:15], v[46:47] neg_lo:[1,0] neg_hi:[1,0]
    v_rcp_f32 v48, v48
    s_waitcnt lgkmcnt(12)
    v_mfma_f32_16x16x32_bf16 v[16:19], v[184:187], v[84:87], v[16:19]
    v_cvt_pk_bf16_f32 v56, v24, v25
    v_cvt_pk_bf16_f32 v57, v26, v27
    v_mfma_f32_16x16x32_bf16 v[16:19], v[188:191], v[88:91], v[16:19]
    v_rcp_f32 v49, v49
    v_mfma_f32_16x16x32_bf16 v[16:19], v[192:195], v[92:95], v[16:19]
    v_cvt_pk_bf16_f32 v58, v28, v29
    v_cvt_pk_bf16_f32 v59, v30, v31
    v_mfma_f32_16x16x32_bf16 v[20:23], v[196:199], v[84:87], v[20:23]
    v_rcp_f32 v50, v50
    v_mfma_f32_16x16x32_bf16 v[20:23], v[200:203], v[88:91], v[20:23]
    v_rcp_f32 v51, v51
    v_mfma_f32_16x16x32_bf16 v[20:23], v[204:207], v[92:95], v[20:23]
    v_rcp_f32 v52, v52
    v_mfma_f32_16x16x32_bf16 v[96:99], v[184:187], v[156:159], v[96:99]
    v_rcp_f32 v53, v53
    v_mfma_f32_16x16x32_bf16 v[96:99], v[188:191], v[160:163], v[96:99]
    v_rcp_f32 v54, v54
    v_mfma_f32_16x16x32_bf16 v[96:99], v[192:195], v[164:167], v[96:99]
    v_rcp_f32 v55, v55
    v_mfma_f32_16x16x32_bf16 v[100:103], v[196:199], v[156:159], v[100:103]
    v_mfma_f32_16x16x32_bf16 v[100:103], v[200:203], v[160:163], v[100:103]
    v_exp_f32 v40, v40
    v_mfma_f32_16x16x32_bf16 v[100:103], v[204:207], v[164:167], v[100:103]
    v_exp_f32 v41, v41
    s_waitcnt lgkmcnt(0)
    v_mfma_f32_16x16x32_bf16 v[60:63], v[208:211], v[56:59], v[60:63]
    v_exp_f32 v42, v42
    v_mfma_f32_16x16x32_bf16 v[64:67], v[212:215], v[56:59], v[64:67]
    v_exp_f32 v43, v43
    v_mfma_f32_16x16x32_bf16 v[68:71], v[216:219], v[56:59], v[68:71]
    v_exp_f32 v44, v44
    v_mfma_f32_16x16x32_bf16 v[72:75], v[220:223], v[56:59], v[72:75]
    v_exp_f32 v45, v45
    v_mfma_f32_16x16x32_bf16 v[76:79], v[224:227], v[56:59], v[76:79]
    v_exp_f32 v46, v46
    v_mfma_f32_16x16x32_bf16 v[80:83], v[228:231], v[56:59], v[80:83]
    v_exp_f32 v47, v47
    ds_read_b128 v[24:27], v240 offset:768
    ds_read_b128 v[28:31], v240 offset:832
    ds_read_b64_tr_b16 v[184:185], v232 offset:12352
    ds_read_b64_tr_b16 v[186:187], v232 offset:13376
    ds_read_b64_tr_b16 v[188:189], v232 offset:14400
    ds_read_b64_tr_b16 v[190:191], v232 offset:15424
    ds_read_b64_tr_b16 v[192:193], v232 offset:16448
    ds_read_b64_tr_b16 v[194:195], v232 offset:17472
    ds_read_b64_tr_b16 v[196:197], v237 offset:12352
    ds_read_b64_tr_b16 v[198:199], v237 offset:13376
    ds_read_b64_tr_b16 v[200:201], v237 offset:14400
    ds_read_b64_tr_b16 v[202:203], v237 offset:15424
    ds_read_b64_tr_b16 v[204:205], v237 offset:16448
    ds_read_b64_tr_b16 v[206:207], v237 offset:17472
    ds_read_b64_tr_b16 v[208:209], v233 offset:37056
    ds_read_b64_tr_b16 v[210:211], v233 offset:40160
    ds_read_b64_tr_b16 v[212:213], v233 offset:37064
    ds_read_b64_tr_b16 v[214:215], v233 offset:40168
    ds_read_b64_tr_b16 v[216:217], v233 offset:37120
    ds_read_b64_tr_b16 v[218:219], v233 offset:40224
    ds_read_b64_tr_b16 v[220:221], v233 offset:37128
    ds_read_b64_tr_b16 v[222:223], v233 offset:40232
    ds_read_b64_tr_b16 v[224:225], v233 offset:37184
    ds_read_b64_tr_b16 v[226:227], v233 offset:40288
    ds_read_b64_tr_b16 v[228:229], v233 offset:37192
    ds_read_b64_tr_b16 v[230:231], v233 offset:40296
    s_waitcnt vmcnt(0)
    v_mov_b32 v4, 6
    ds_write_b32 v244, v4
    s_mov_b32 exec_hi, 0xffff
    s_add_u32 m0, s57, 135872
    s_movk_i32 s59, 704
    buffer_load_dwordx4 v236, s[28:31], s59 offen lds
    s_add_u32 m0, s58, 98816
    s_mov_b32 s59, 49152
    buffer_load_dwordx4 v242, s[32:35], s59 offen lds
    s_mov_b32 exec_hi, -1
    buffer_load_dwordx4 v[248:251], v1, s[96:99], 0 offen offset:2048
    buffer_load_dwordx4 v[252:255], v1, s[96:99], 0 offen offset:3072
    v_pk_mul_f32 v[32:33], v[32:33], v[48:49]
    v_pk_mul_f32 v[34:35], v[34:35], v[50:51]
    v_pk_mul_f32 v[36:37], v[36:37], v[52:53]
    v_pk_mul_f32 v[38:39], v[38:39], v[54:55]
    v_pk_add_f32 v[40:41], v[40:41], s[62:63]
    v_pk_add_f32 v[42:43], v[42:43], s[62:63]
    v_pk_add_f32 v[44:45], v[44:45], s[62:63]
    v_pk_add_f32 v[46:47], v[46:47], s[62:63]
    v_pk_fma_f32 v[48:49], v[16:17], v[16:17], s[60:61]
    v_pk_fma_f32 v[50:51], v[18:19], v[18:19], s[60:61]
    v_pk_fma_f32 v[52:53], v[20:21], v[20:21], s[60:61]
    v_pk_fma_f32 v[54:55], v[22:23], v[22:23], s[60:61]
    v_pk_mul_f32 v[48:49], v[16:17], v[48:49] neg_lo:[1,0] neg_hi:[1,0]
    v_pk_mul_f32 v[50:51], v[18:19], v[50:51] neg_lo:[1,0] neg_hi:[1,0]
    v_pk_mul_f32 v[52:53], v[20:21], v[52:53] neg_lo:[1,0] neg_hi:[1,0]
    v_pk_mul_f32 v[54:55], v[22:23], v[54:55] neg_lo:[1,0] neg_hi:[1,0]
    v_pk_fma_f32 v[112:113], v[96:97], v[96:97], s[60:61]
    v_pk_fma_f32 v[114:115], v[98:99], v[98:99], s[60:61]
    v_pk_fma_f32 v[116:117], v[100:101], v[100:101], s[60:61]
    v_pk_fma_f32 v[118:119], v[102:103], v[102:103], s[60:61]
    v_pk_mul_f32 v[112:113], v[96:97], v[112:113] neg_lo:[1,0] neg_hi:[1,0]
    v_pk_mul_f32 v[114:115], v[98:99], v[114:115] neg_lo:[1,0] neg_hi:[1,0]
    v_pk_mul_f32 v[116:117], v[100:101], v[116:117] neg_lo:[1,0] neg_hi:[1,0]
    v_pk_mul_f32 v[118:119], v[102:103], v[118:119] neg_lo:[1,0] neg_hi:[1,0]
    v_rcp_f32 v40, v40
    s_waitcnt lgkmcnt(13)
    v_mfma_f32_16x16x32_bf16 v[24:27], v[184:187], v[84:87], v[24:27]
    v_cvt_pk_bf16_f32 v56, v32, v33
    v_cvt_pk_bf16_f32 v57, v34, v35
    v_rcp_f32 v41, v41
    v_mfma_f32_16x16x32_bf16 v[24:27], v[188:191], v[88:91], v[24:27]
    v_cvt_pk_bf16_f32 v58, v36, v37
    v_cvt_pk_bf16_f32 v59, v38, v39
    v_rcp_f32 v42, v42
    v_mfma_f32_16x16x32_bf16 v[24:27], v[192:195], v[92:95], v[24:27]
    v_rcp_f32 v43, v43
    v_rcp_f32 v44, v44
    v_mfma_f32_16x16x32_bf16 v[28:31], v[196:199], v[84:87], v[28:31]
    v_rcp_f32 v45, v45
    v_rcp_f32 v46, v46
    v_mfma_f32_16x16x32_bf16 v[28:31], v[200:203], v[88:91], v[28:31]
    v_rcp_f32 v47, v47
    v_exp_f32 v48, v48
    v_mfma_f32_16x16x32_bf16 v[28:31], v[204:207], v[92:95], v[28:31]
    v_exp_f32 v49, v49
    v_exp_f32 v50, v50
    v_exp_f32 v51, v51
    s_waitcnt lgkmcnt(0)
    v_mfma_f32_16x16x32_bf16 v[60:63], v[208:211], v[56:59], v[60:63]
    v_exp_f32 v52, v52
    v_exp_f32 v53, v53
    v_mfma_f32_16x16x32_bf16 v[64:67], v[212:215], v[56:59], v[64:67]
    v_exp_f32 v54, v54
    v_exp_f32 v55, v55
    v_mfma_f32_16x16x32_bf16 v[68:71], v[216:219], v[56:59], v[68:71]
    v_exp_f32 v112, v112
    v_exp_f32 v113, v113
    v_mfma_f32_16x16x32_bf16 v[72:75], v[220:223], v[56:59], v[72:75]
    v_exp_f32 v114, v114
    v_exp_f32 v115, v115
    v_mfma_f32_16x16x32_bf16 v[76:79], v[224:227], v[56:59], v[76:79]
    v_exp_f32 v116, v116
    v_exp_f32 v117, v117
    v_mfma_f32_16x16x32_bf16 v[80:83], v[228:231], v[56:59], v[80:83]
    v_exp_f32 v118, v118
    v_exp_f32 v119, v119
    ds_read_b128 v[32:35], v240 offset:896
    ds_read_b128 v[36:39], v240 offset:960
    ds_read_b64_tr_b16 v[184:185], v232 offset:24704
    ds_read_b64_tr_b16 v[186:187], v232 offset:25728
    ds_read_b64_tr_b16 v[188:189], v232 offset:26752
    ds_read_b64_tr_b16 v[190:191], v232 offset:27776
    ds_read_b64_tr_b16 v[192:193], v232 offset:28800
    ds_read_b64_tr_b16 v[194:195], v232 offset:29824
    ds_read_b64_tr_b16 v[196:197], v237 offset:24704
    ds_read_b64_tr_b16 v[198:199], v237 offset:25728
    ds_read_b64_tr_b16 v[200:201], v237 offset:26752
    ds_read_b64_tr_b16 v[202:203], v237 offset:27776
    ds_read_b64_tr_b16 v[204:205], v237 offset:28800
    ds_read_b64_tr_b16 v[206:207], v237 offset:29824
    ds_read_b64_tr_b16 v[208:209], v233 offset:49408
    ds_read_b64_tr_b16 v[210:211], v233 offset:52512
    ds_read_b64_tr_b16 v[212:213], v233 offset:49416
    ds_read_b64_tr_b16 v[214:215], v233 offset:52520
    ds_read_b64_tr_b16 v[216:217], v233 offset:49472
    ds_read_b64_tr_b16 v[218:219], v233 offset:52576
    ds_read_b64_tr_b16 v[220:221], v233 offset:49480
    ds_read_b64_tr_b16 v[222:223], v233 offset:52584
    ds_read_b64_tr_b16 v[224:225], v233 offset:49536
    ds_read_b64_tr_b16 v[226:227], v233 offset:52640
    ds_read_b64_tr_b16 v[228:229], v233 offset:49544
    ds_read_b64_tr_b16 v[230:231], v233 offset:52648
    ds_read_b32 v5, v245
    s_mov_b32 exec_hi, 0xffff
    s_add_u32 m0, s58, 111168
    s_mov_b32 s59, 55296
    buffer_load_dwordx4 v242, s[32:35], s59 offen lds
    s_add_u32 m0, s58, 123520
    s_mov_b32 s59, 61440
    buffer_load_dwordx4 v242, s[32:35], s59 offen lds
    s_mov_b32 exec_hi, -1
    s_nop 0
    v_pk_mul_f32 v[8:9], v[8:9], v[40:41]
    v_pk_mul_f32 v[10:11], v[10:11], v[42:43]
    v_pk_mul_f32 v[12:13], v[12:13], v[44:45]
    v_pk_mul_f32 v[14:15], v[14:15], v[46:47]
    v_pk_add_f32 v[48:49], v[48:49], s[62:63]
    v_pk_add_f32 v[50:51], v[50:51], s[62:63]
    v_pk_add_f32 v[52:53], v[52:53], s[62:63]
    v_pk_add_f32 v[54:55], v[54:55], s[62:63]
    v_pk_add_f32 v[112:113], v[112:113], s[62:63]
    v_pk_add_f32 v[114:115], v[114:115], s[62:63]
    v_pk_add_f32 v[116:117], v[116:117], s[62:63]
    v_pk_add_f32 v[118:119], v[118:119], s[62:63]
    v_pk_fma_f32 v[40:41], v[24:25], v[24:25], s[60:61]
    v_pk_fma_f32 v[42:43], v[26:27], v[26:27], s[60:61]
    v_pk_fma_f32 v[44:45], v[28:29], v[28:29], s[60:61]
    v_pk_fma_f32 v[46:47], v[30:31], v[30:31], s[60:61]
    v_pk_mul_f32 v[40:41], v[24:25], v[40:41] neg_lo:[1,0] neg_hi:[1,0]
    v_pk_mul_f32 v[42:43], v[26:27], v[42:43] neg_lo:[1,0] neg_hi:[1,0]
    v_pk_mul_f32 v[44:45], v[28:29], v[44:45] neg_lo:[1,0] neg_hi:[1,0]
    v_pk_mul_f32 v[46:47], v[30:31], v[46:47] neg_lo:[1,0] neg_hi:[1,0]
    v_rcp_f32 v48, v48
    s_waitcnt lgkmcnt(13)
    v_mfma_f32_16x16x32_bf16 v[32:35], v[184:187], v[84:87], v[32:35]
    v_cvt_pk_bf16_f32 v56, v8, v9
    v_cvt_pk_bf16_f32 v57, v10, v11
    v_rcp_f32 v49, v49
    v_mfma_f32_16x16x32_bf16 v[32:35], v[188:191], v[88:91], v[32:35]
    v_cvt_pk_bf16_f32 v58, v12, v13
    v_cvt_pk_bf16_f32 v59, v14, v15
    v_rcp_f32 v50, v50
    v_mfma_f32_16x16x32_bf16 v[32:35], v[192:195], v[92:95], v[32:35]
    v_rcp_f32 v51, v51
    v_rcp_f32 v52, v52
    v_mfma_f32_16x16x32_bf16 v[36:39], v[196:199], v[84:87], v[36:39]
    v_rcp_f32 v53, v53
    v_rcp_f32 v54, v54
    v_mfma_f32_16x16x32_bf16 v[36:39], v[200:203], v[88:91], v[36:39]
    v_rcp_f32 v55, v55
    v_exp_f32 v40, v40
    v_mfma_f32_16x16x32_bf16 v[36:39], v[204:207], v[92:95], v[36:39]
    v_exp_f32 v41, v41
    v_exp_f32 v42, v42
    v_exp_f32 v43, v43
    s_waitcnt lgkmcnt(0)
    v_mfma_f32_16x16x32_bf16 v[60:63], v[208:211], v[56:59], v[60:63]
    v_exp_f32 v44, v44
    v_exp_f32 v45, v45
    v_mfma_f32_16x16x32_bf16 v[64:67], v[212:215], v[56:59], v[64:67]
    v_exp_f32 v46, v46
    v_exp_f32 v47, v47
    v_mfma_f32_16x16x32_bf16 v[68:71], v[216:219], v[56:59], v[68:71]
    v_rcp_f32 v112, v112
    v_rcp_f32 v113, v113
    v_mfma_f32_16x16x32_bf16 v[72:75], v[220:223], v[56:59], v[72:75]
    v_rcp_f32 v114, v114
    v_rcp_f32 v115, v115
    v_mfma_f32_16x16x32_bf16 v[76:79], v[224:227], v[56:59], v[76:79]
    v_rcp_f32 v116, v116
    v_rcp_f32 v117, v117
    v_mfma_f32_16x16x32_bf16 v[80:83], v[228:231], v[56:59], v[80:83]
    v_rcp_f32 v118, v118
    v_rcp_f32 v119, v119
    v_cmp_le_u32 vcc, 6, v5
    s_cmp_eq_u64 vcc, -1
    s_cbranch_scc1 L_gate_N1_6_ok
L_gate_N1_6:
    ds_read_b32 v5, v245
    s_waitcnt lgkmcnt(0)
    v_cmp_le_u32 vcc, 6, v5
    s_cmp_eq_u64 vcc, -1
    s_cbranch_scc0 L_gate_N1_6
L_gate_N1_6_ok:
    s_nop 0
    ds_read_b128 v[8:11], v240 offset:1024
    ds_read_b128 v[12:15], v240 offset:1088
    ds_read_b64_tr_b16 v[184:185], v232 offset:37056
    ds_read_b64_tr_b16 v[186:187], v232 offset:38080
    ds_read_b64_tr_b16 v[188:189], v232 offset:39104
    ds_read_b64_tr_b16 v[190:191], v232 offset:40128
    ds_read_b64_tr_b16 v[192:193], v232 offset:41152
    ds_read_b64_tr_b16 v[194:195], v232 offset:42176
    ds_read_b64_tr_b16 v[196:197], v237 offset:37056
    ds_read_b64_tr_b16 v[198:199], v237 offset:38080
    ds_read_b64_tr_b16 v[200:201], v237 offset:39104
    ds_read_b64_tr_b16 v[202:203], v237 offset:40128
    ds_read_b64_tr_b16 v[204:205], v237 offset:41152
    ds_read_b64_tr_b16 v[206:207], v237 offset:42176
    v_add_u32 v233, 61760, v233
    ds_read_b64_tr_b16 v[208:209], v233 offset:0
    ds_read_b64_tr_b16 v[210:211], v233 offset:3104
    ds_read_b64_tr_b16 v[212:213], v233 offset:8
    ds_read_b64_tr_b16 v[214:215], v233 offset:3112
    ds_read_b64_tr_b16 v[216:217], v233 offset:64
    ds_read_b64_tr_b16 v[218:219], v233 offset:3168
    ds_read_b64_tr_b16 v[220:221], v233 offset:72
    ds_read_b64_tr_b16 v[222:223], v233 offset:3176
    ds_read_b64_tr_b16 v[224:225], v233 offset:128
    ds_read_b64_tr_b16 v[226:227], v233 offset:3232
    ds_read_b64_tr_b16 v[228:229], v233 offset:136
    ds_read_b64_tr_b16 v[230:231], v233 offset:3240
    s_mov_b32 exec_hi, 0xffff
    s_add_u32 m0, s58, 135872
    s_mov_b32 s59, 67584
    buffer_load_dwordx4 v242, s[32:35], s59 offen lds
    s_mov_b32 exec_hi, -1
    s_nop 0
    v_pk_mul_f32 v[16:17], v[16:17], v[48:49]
    v_pk_mul_f32 v[18:19], v[18:19], v[50:51]
    v_pk_mul_f32 v[20:21], v[20:21], v[52:53]
    v_pk_mul_f32 v[22:23], v[22:23], v[54:55]
    v_pk_add_f32 v[40:41], v[40:41], s[62:63]
    v_pk_add_f32 v[42:43], v[42:43], s[62:63]
    v_pk_add_f32 v[44:45], v[44:45], s[62:63]
    v_pk_add_f32 v[46:47], v[46:47], s[62:63]
    v_pk_mul_f32 v[96:97], v[96:97], v[112:113]
    v_pk_mul_f32 v[98:99], v[98:99], v[114:115]
    v_pk_mul_f32 v[100:101], v[100:101], v[116:117]
    v_pk_mul_f32 v[102:103], v[102:103], v[118:119]
    v_pk_fma_f32 v[48:49], v[32:33], v[32:33], s[60:61]
    v_pk_fma_f32 v[50:51], v[34:35], v[34:35], s[60:61]
    v_pk_fma_f32 v[52:53], v[36:37], v[36:37], s[60:61]
    v_pk_fma_f32 v[54:55], v[38:39], v[38:39], s[60:61]
    v_pk_mul_f32 v[48:49], v[32:33], v[48:49] neg_lo:[1,0] neg_hi:[1,0]
    v_pk_mul_f32 v[50:51], v[34:35], v[50:51] neg_lo:[1,0] neg_hi:[1,0]
    v_pk_mul_f32 v[52:53], v[36:37], v[52:53] neg_lo:[1,0] neg_hi:[1,0]
    v_pk_mul_f32 v[54:55], v[38:39], v[54:55] neg_lo:[1,0] neg_hi:[1,0]
    v_rcp_f32 v40, v40
    s_waitcnt lgkmcnt(12)
    v_mfma_f32_16x16x32_bf16 v[8:11], v[184:187], v[84:87], v[8:11]
    v_cvt_pk_bf16_f32 v56, v16, v17
    v_cvt_pk_bf16_f32 v57, v18, v19
    v_mfma_f32_16x16x32_bf16 v[8:11], v[188:191], v[88:91], v[8:11]
    v_rcp_f32 v41, v41
    v_mfma_f32_16x16x32_bf16 v[8:11], v[192:195], v[92:95], v[8:11]
    v_cvt_pk_bf16_f32 v58, v20, v21
    v_cvt_pk_bf16_f32 v59, v22, v23
    v_mfma_f32_16x16x32_bf16 v[12:15], v[196:199], v[84:87], v[12:15]
    v_rcp_f32 v42, v42
    v_mfma_f32_16x16x32_bf16 v[12:15], v[200:203], v[88:91], v[12:15]
    v_cvt_pk_bf16_f32 v120, v96, v97
    v_cvt_pk_bf16_f32 v121, v98, v99
    v_mfma_f32_16x16x32_bf16 v[12:15], v[204:207], v[92:95], v[12:15]
    v_rcp_f32 v43, v43
    v_cvt_pk_bf16_f32 v122, v100, v101
    s_waitcnt lgkmcnt(0)
    v_mfma_f32_16x16x32_bf16 v[60:63], v[208:211], v[56:59], v[60:63]
    v_cvt_pk_bf16_f32 v123, v102, v103
    v_mfma_f32_16x16x32_bf16 v[64:67], v[212:215], v[56:59], v[64:67]
    v_rcp_f32 v44, v44
    v_mfma_f32_16x16x32_bf16 v[68:71], v[216:219], v[56:59], v[68:71]
    v_rcp_f32 v45, v45
    v_rcp_f32 v46, v46
    v_mfma_f32_16x16x32_bf16 v[72:75], v[220:223], v[56:59], v[72:75]
    v_rcp_f32 v47, v47
    v_mfma_f32_16x16x32_bf16 v[76:79], v[224:227], v[56:59], v[76:79]
    v_exp_f32 v48, v48
    v_mfma_f32_16x16x32_bf16 v[80:83], v[228:231], v[56:59], v[80:83]
    v_exp_f32 v49, v49
    v_mfma_f32_16x16x32_bf16 v[132:135], v[208:211], v[120:123], v[132:135]
    v_exp_f32 v50, v50
    v_mfma_f32_16x16x32_bf16 v[136:139], v[212:215], v[120:123], v[136:139]
    v_exp_f32 v51, v51
    v_mfma_f32_16x16x32_bf16 v[140:143], v[216:219], v[120:123], v[140:143]
    v_exp_f32 v52, v52
    v_mfma_f32_16x16x32_bf16 v[144:147], v[220:223], v[120:123], v[144:147]
    v_exp_f32 v53, v53
    v_mfma_f32_16x16x32_bf16 v[148:151], v[224:227], v[120:123], v[148:151]
    v_exp_f32 v54, v54
    v_mfma_f32_16x16x32_bf16 v[152:155], v[228:231], v[120:123], v[152:155]
    v_exp_f32 v55, v55
    ds_read_b128 v[16:19], v240 offset:1152
    ds_read_b128 v[20:23], v240 offset:1216
    ds_read_b128 v[96:99], v240 offset:1152
    ds_read_b128 v[100:103], v240 offset:1216
    ds_read_b64_tr_b16 v[184:185], v232 offset:49408
    ds_read_b64_tr_b16 v[186:187], v232 offset:50432
    ds_read_b64_tr_b16 v[188:189], v232 offset:51456
    ds_read_b64_tr_b16 v[190:191], v232 offset:52480
    ds_read_b64_tr_b16 v[192:193], v232 offset:53504
    ds_read_b64_tr_b16 v[194:195], v232 offset:54528
    ds_read_b64_tr_b16 v[196:197], v237 offset:49408
    ds_read_b64_tr_b16 v[198:199], v237 offset:50432
    ds_read_b64_tr_b16 v[200:201], v237 offset:51456
    ds_read_b64_tr_b16 v[202:203], v237 offset:52480
    ds_read_b64_tr_b16 v[204:205], v237 offset:53504
    ds_read_b64_tr_b16 v[206:207], v237 offset:54528
    ds_read_b64_tr_b16 v[208:209], v233 offset:12352
    ds_read_b64_tr_b16 v[210:211], v233 offset:15456
    ds_read_b64_tr_b16 v[212:213], v233 offset:12360
    ds_read_b64_tr_b16 v[214:215], v233 offset:15464
    ds_read_b64_tr_b16 v[216:217], v233 offset:12416
    ds_read_b64_tr_b16 v[218:219], v233 offset:15520
    ds_read_b64_tr_b16 v[220:221], v233 offset:12424
    ds_read_b64_tr_b16 v[222:223], v233 offset:15528
    ds_read_b64_tr_b16 v[224:225], v233 offset:12480
    ds_read_b64_tr_b16 v[226:227], v233 offset:15584
    ds_read_b64_tr_b16 v[228:229], v233 offset:12488
    ds_read_b64_tr_b16 v[230:231], v233 offset:15592
    s_waitcnt vmcnt(0)
    v_mov_b32 v4, 7
    ds_write_b32 v244, v4
    v_pk_mul_f32 v[24:25], v[24:25], v[40:41]
    v_pk_mul_f32 v[26:27], v[26:27], v[42:43]
    v_pk_mul_f32 v[28:29], v[28:29], v[44:45]
    v_pk_mul_f32 v[30:31], v[30:31], v[46:47]
    v_pk_add_f32 v[48:49], v[48:49], s[62:63]
    v_pk_add_f32 v[50:51], v[50:51], s[62:63]
    v_pk_add_f32 v[52:53], v[52:53], s[62:63]
    v_pk_add_f32 v[54:55], v[54:55], s[62:63]
    v_pk_fma_f32 v[40:41], v[8:9], v[8:9], s[60:61]
    v_pk_fma_f32 v[42:43], v[10:11], v[10:11], s[60:61]
    v_pk_fma_f32 v[44:45], v[12:13], v[12:13], s[60:61]
    v_pk_fma_f32 v[46:47], v[14:15], v[14:15], s[60:61]
    v_pk_mul_f32 v[40:41], v[8:9], v[40:41] neg_lo:[1,0] neg_hi:[1,0]
    v_pk_mul_f32 v[42:43], v[10:11], v[42:43] neg_lo:[1,0] neg_hi:[1,0]
    v_pk_mul_f32 v[44:45], v[12:13], v[44:45] neg_lo:[1,0] neg_hi:[1,0]
    v_pk_mul_f32 v[46:47], v[14:15], v[46:47] neg_lo:[1,0] neg_hi:[1,0]
    v_rcp_f32 v48, v48
    s_waitcnt lgkmcnt(13)
    v_mfma_f32_16x16x32_bf16 v[16:19], v[184:187], v[84:87], v[16:19]
    v_cvt_pk_bf16_f32 v56, v24, v25
    v_cvt_pk_bf16_f32 v57, v26, v27
    v_mfma_f32_16x16x32_bf16 v[16:19], v[188:191], v[88:91], v[16:19]
    v_rcp_f32 v49, v49
    v_mfma_f32_16x16x32_bf16 v[16:19], v[192:195], v[92:95], v[16:19]
    v_cvt_pk_bf16_f32 v58, v28, v29
    v_cvt_pk_bf16_f32 v59, v30, v31
    v_mfma_f32_16x16x32_bf16 v[20:23], v[196:199], v[84:87], v[20:23]
    v_rcp_f32 v50, v50
    v_mfma_f32_16x16x32_bf16 v[20:23], v[200:203], v[88:91], v[20:23]
    v_rcp_f32 v51, v51
    v_mfma_f32_16x16x32_bf16 v[20:23], v[204:207], v[92:95], v[20:23]
    v_rcp_f32 v52, v52
    v_mfma_f32_16x16x32_bf16 v[96:99], v[184:187], v[156:159], v[96:99]
    v_rcp_f32 v53, v53
    v_mfma_f32_16x16x32_bf16 v[96:99], v[188:191], v[160:163], v[96:99]
    v_rcp_f32 v54, v54
    v_mfma_f32_16x16x32_bf16 v[96:99], v[192:195], v[164:167], v[96:99]
    v_rcp_f32 v55, v55
    v_mfma_f32_16x16x32_bf16 v[100:103], v[196:199], v[156:159], v[100:103]
    v_mfma_f32_16x16x32_bf16 v[100:103], v[200:203], v[160:163], v[100:103]
    v_exp_f32 v40, v40
    v_mfma_f32_16x16x32_bf16 v[100:103], v[204:207], v[164:167], v[100:103]
    v_exp_f32 v41, v41
    s_waitcnt lgkmcnt(0)
    v_mfma_f32_16x16x32_bf16 v[60:63], v[208:211], v[56:59], v[60:63]
    v_exp_f32 v42, v42
    v_mfma_f32_16x16x32_bf16 v[64:67], v[212:215], v[56:59], v[64:67]
    v_exp_f32 v43, v43
    v_mfma_f32_16x16x32_bf16 v[68:71], v[216:219], v[56:59], v[68:71]
    v_exp_f32 v44, v44
    v_mfma_f32_16x16x32_bf16 v[72:75], v[220:223], v[56:59], v[72:75]
    v_exp_f32 v45, v45
    v_mfma_f32_16x16x32_bf16 v[76:79], v[224:227], v[56:59], v[76:79]
    v_exp_f32 v46, v46
    v_mfma_f32_16x16x32_bf16 v[80:83], v[228:231], v[56:59], v[80:83]
    v_exp_f32 v47, v47
    v_add_u32 v232, 61760, v232
    v_add_u32 v237, 61760, v237
    ds_read_b128 v[24:27], v240 offset:1280
    ds_read_b128 v[28:31], v240 offset:1344
    ds_read_b64_tr_b16 v[184:185], v232 offset:0
    ds_read_b64_tr_b16 v[186:187], v232 offset:1024
    ds_read_b64_tr_b16 v[188:189], v232 offset:2048
    ds_read_b64_tr_b16 v[190:191], v232 offset:3072
    ds_read_b64_tr_b16 v[192:193], v232 offset:4096
    ds_read_b64_tr_b16 v[194:195], v232 offset:5120
    ds_read_b64_tr_b16 v[196:197], v237 offset:0
    ds_read_b64_tr_b16 v[198:199], v237 offset:1024
    ds_read_b64_tr_b16 v[200:201], v237 offset:2048
    ds_read_b64_tr_b16 v[202:203], v237 offset:3072
    ds_read_b64_tr_b16 v[204:205], v237 offset:4096
    ds_read_b64_tr_b16 v[206:207], v237 offset:5120
    ds_read_b64_tr_b16 v[208:209], v233 offset:24704
    ds_read_b64_tr_b16 v[210:211], v233 offset:27808
    ds_read_b64_tr_b16 v[212:213], v233 offset:24712
    ds_read_b64_tr_b16 v[214:215], v233 offset:27816
    ds_read_b64_tr_b16 v[216:217], v233 offset:24768
    ds_read_b64_tr_b16 v[218:219], v233 offset:27872
    ds_read_b64_tr_b16 v[220:221], v233 offset:24776
    ds_read_b64_tr_b16 v[222:223], v233 offset:27880
    ds_read_b64_tr_b16 v[224:225], v233 offset:24832
    ds_read_b64_tr_b16 v[226:227], v233 offset:27936
    ds_read_b64_tr_b16 v[228:229], v233 offset:24840
    ds_read_b64_tr_b16 v[230:231], v233 offset:27944
    ds_read_b32 v5, v245
    v_pk_mul_f32 v[32:33], v[32:33], v[48:49]
    v_pk_mul_f32 v[34:35], v[34:35], v[50:51]
    v_pk_mul_f32 v[36:37], v[36:37], v[52:53]
    v_pk_mul_f32 v[38:39], v[38:39], v[54:55]
    v_pk_add_f32 v[40:41], v[40:41], s[62:63]
    v_pk_add_f32 v[42:43], v[42:43], s[62:63]
    v_pk_add_f32 v[44:45], v[44:45], s[62:63]
    v_pk_add_f32 v[46:47], v[46:47], s[62:63]
    v_pk_fma_f32 v[48:49], v[16:17], v[16:17], s[60:61]
    v_pk_fma_f32 v[50:51], v[18:19], v[18:19], s[60:61]
    v_pk_fma_f32 v[52:53], v[20:21], v[20:21], s[60:61]
    v_pk_fma_f32 v[54:55], v[22:23], v[22:23], s[60:61]
    v_pk_mul_f32 v[48:49], v[16:17], v[48:49] neg_lo:[1,0] neg_hi:[1,0]
    v_pk_mul_f32 v[50:51], v[18:19], v[50:51] neg_lo:[1,0] neg_hi:[1,0]
    v_pk_mul_f32 v[52:53], v[20:21], v[52:53] neg_lo:[1,0] neg_hi:[1,0]
    v_pk_mul_f32 v[54:55], v[22:23], v[54:55] neg_lo:[1,0] neg_hi:[1,0]
    v_pk_fma_f32 v[112:113], v[96:97], v[96:97], s[60:61]
    v_pk_fma_f32 v[114:115], v[98:99], v[98:99], s[60:61]
    v_pk_fma_f32 v[116:117], v[100:101], v[100:101], s[60:61]
    v_pk_fma_f32 v[118:119], v[102:103], v[102:103], s[60:61]
    v_pk_mul_f32 v[112:113], v[96:97], v[112:113] neg_lo:[1,0] neg_hi:[1,0]
    v_pk_mul_f32 v[114:115], v[98:99], v[114:115] neg_lo:[1,0] neg_hi:[1,0]
    v_pk_mul_f32 v[116:117], v[100:101], v[116:117] neg_lo:[1,0] neg_hi:[1,0]
    v_pk_mul_f32 v[118:119], v[102:103], v[118:119] neg_lo:[1,0] neg_hi:[1,0]
    v_rcp_f32 v40, v40
    s_waitcnt lgkmcnt(13)
    v_mfma_f32_16x16x32_bf16 v[24:27], v[184:187], v[84:87], v[24:27]
    v_cvt_pk_bf16_f32 v56, v32, v33
    v_cvt_pk_bf16_f32 v57, v34, v35
    v_rcp_f32 v41, v41
    v_mfma_f32_16x16x32_bf16 v[24:27], v[188:191], v[88:91], v[24:27]
    v_cvt_pk_bf16_f32 v58, v36, v37
    v_cvt_pk_bf16_f32 v59, v38, v39
    v_rcp_f32 v42, v42
    v_mfma_f32_16x16x32_bf16 v[24:27], v[192:195], v[92:95], v[24:27]
    v_rcp_f32 v43, v43
    v_rcp_f32 v44, v44
    v_mfma_f32_16x16x32_bf16 v[28:31], v[196:199], v[84:87], v[28:31]
    v_rcp_f32 v45, v45
    v_rcp_f32 v46, v46
    v_mfma_f32_16x16x32_bf16 v[28:31], v[200:203], v[88:91], v[28:31]
    v_rcp_f32 v47, v47
    v_exp_f32 v48, v48
    v_mfma_f32_16x16x32_bf16 v[28:31], v[204:207], v[92:95], v[28:31]
    v_exp_f32 v49, v49
    v_exp_f32 v50, v50
    v_exp_f32 v51, v51
    s_waitcnt lgkmcnt(0)
    v_mfma_f32_16x16x32_bf16 v[60:63], v[208:211], v[56:59], v[60:63]
    v_exp_f32 v52, v52
    v_exp_f32 v53, v53
    v_mfma_f32_16x16x32_bf16 v[64:67], v[212:215], v[56:59], v[64:67]
    v_exp_f32 v54, v54
    v_exp_f32 v55, v55
    v_mfma_f32_16x16x32_bf16 v[68:71], v[216:219], v[56:59], v[68:71]
    v_exp_f32 v112, v112
    v_exp_f32 v113, v113
    v_mfma_f32_16x16x32_bf16 v[72:75], v[220:223], v[56:59], v[72:75]
    v_exp_f32 v114, v114
    v_exp_f32 v115, v115
    v_mfma_f32_16x16x32_bf16 v[76:79], v[224:227], v[56:59], v[76:79]
    v_exp_f32 v116, v116
    v_exp_f32 v117, v117
    v_mfma_f32_16x16x32_bf16 v[80:83], v[228:231], v[56:59], v[80:83]
    v_exp_f32 v118, v118
    v_exp_f32 v119, v119
    v_cmp_le_u32 vcc, 7, v5
    s_cmp_eq_u64 vcc, -1
    s_cbranch_scc1 L_gate_N1_9_ok
L_gate_N1_9:
    ds_read_b32 v5, v245
    s_waitcnt lgkmcnt(0)
    v_cmp_le_u32 vcc, 7, v5
    s_cmp_eq_u64 vcc, -1
    s_cbranch_scc0 L_gate_N1_9
L_gate_N1_9_ok:
    s_nop 0
    ds_read_b128 v[32:35], v240 offset:1408
    ds_read_b128 v[36:39], v240 offset:1472
    ds_read_b64_tr_b16 v[184:185], v232 offset:12352
    ds_read_b64_tr_b16 v[186:187], v232 offset:13376
    ds_read_b64_tr_b16 v[188:189], v232 offset:14400
    ds_read_b64_tr_b16 v[190:191], v232 offset:15424
    ds_read_b64_tr_b16 v[192:193], v232 offset:16448
    ds_read_b64_tr_b16 v[194:195], v232 offset:17472
    ds_read_b64_tr_b16 v[196:197], v237 offset:12352
    ds_read_b64_tr_b16 v[198:199], v237 offset:13376
    ds_read_b64_tr_b16 v[200:201], v237 offset:14400
    ds_read_b64_tr_b16 v[202:203], v237 offset:15424
    ds_read_b64_tr_b16 v[204:205], v237 offset:16448
    ds_read_b64_tr_b16 v[206:207], v237 offset:17472
    ds_read_b64_tr_b16 v[208:209], v233 offset:37056
    ds_read_b64_tr_b16 v[210:211], v233 offset:40160
    ds_read_b64_tr_b16 v[212:213], v233 offset:37064
    ds_read_b64_tr_b16 v[214:215], v233 offset:40168
    ds_read_b64_tr_b16 v[216:217], v233 offset:37120
    ds_read_b64_tr_b16 v[218:219], v233 offset:40224
    ds_read_b64_tr_b16 v[220:221], v233 offset:37128
    ds_read_b64_tr_b16 v[222:223], v233 offset:40232
    ds_read_b64_tr_b16 v[224:225], v233 offset:37184
    ds_read_b64_tr_b16 v[226:227], v233 offset:40288
    ds_read_b64_tr_b16 v[228:229], v233 offset:37192
    ds_read_b64_tr_b16 v[230:231], v233 offset:40296
    v_pk_mul_f32 v[8:9], v[8:9], v[40:41]
    v_pk_mul_f32 v[10:11], v[10:11], v[42:43]
    v_pk_mul_f32 v[12:13], v[12:13], v[44:45]
    v_pk_mul_f32 v[14:15], v[14:15], v[46:47]
    v_pk_add_f32 v[48:49], v[48:49], s[62:63]
    v_pk_add_f32 v[50:51], v[50:51], s[62:63]
    v_pk_add_f32 v[52:53], v[52:53], s[62:63]
    v_pk_add_f32 v[54:55], v[54:55], s[62:63]
    v_pk_add_f32 v[112:113], v[112:113], s[62:63]
    v_pk_add_f32 v[114:115], v[114:115], s[62:63]
    v_pk_add_f32 v[116:117], v[116:117], s[62:63]
    v_pk_add_f32 v[118:119], v[118:119], s[62:63]
    v_pk_fma_f32 v[40:41], v[24:25], v[24:25], s[60:61]
    v_pk_fma_f32 v[42:43], v[26:27], v[26:27], s[60:61]
    v_pk_fma_f32 v[44:45], v[28:29], v[28:29], s[60:61]
    v_pk_fma_f32 v[46:47], v[30:31], v[30:31], s[60:61]
    v_pk_mul_f32 v[40:41], v[24:25], v[40:41] neg_lo:[1,0] neg_hi:[1,0]
    v_pk_mul_f32 v[42:43], v[26:27], v[42:43] neg_lo:[1,0] neg_hi:[1,0]
    v_pk_mul_f32 v[44:45], v[28:29], v[44:45] neg_lo:[1,0] neg_hi:[1,0]
    v_pk_mul_f32 v[46:47], v[30:31], v[46:47] neg_lo:[1,0] neg_hi:[1,0]
    v_rcp_f32 v48, v48
    s_waitcnt lgkmcnt(12)
    v_mfma_f32_16x16x32_bf16 v[32:35], v[184:187], v[84:87], v[32:35]
    v_cvt_pk_bf16_f32 v56, v8, v9
    v_cvt_pk_bf16_f32 v57, v10, v11
    v_rcp_f32 v49, v49
    v_mfma_f32_16x16x32_bf16 v[32:35], v[188:191], v[88:91], v[32:35]
    v_cvt_pk_bf16_f32 v58, v12, v13
    v_cvt_pk_bf16_f32 v59, v14, v15
    v_rcp_f32 v50, v50
    v_mfma_f32_16x16x32_bf16 v[32:35], v[192:195], v[92:95], v[32:35]
    v_rcp_f32 v51, v51
    v_rcp_f32 v52, v52
    v_mfma_f32_16x16x32_bf16 v[36:39], v[196:199], v[84:87], v[36:39]
    v_rcp_f32 v53, v53
    v_rcp_f32 v54, v54
    v_mfma_f32_16x16x32_bf16 v[36:39], v[200:203], v[88:91], v[36:39]
    v_rcp_f32 v55, v55
    v_exp_f32 v40, v40
    v_mfma_f32_16x16x32_bf16 v[36:39], v[204:207], v[92:95], v[36:39]
    v_exp_f32 v41, v41
    v_exp_f32 v42, v42
    v_exp_f32 v43, v43
    s_waitcnt lgkmcnt(0)
    v_mfma_f32_16x16x32_bf16 v[60:63], v[208:211], v[56:59], v[60:63]
    v_exp_f32 v44, v44
    v_exp_f32 v45, v45
    v_mfma_f32_16x16x32_bf16 v[64:67], v[212:215], v[56:59], v[64:67]
    v_exp_f32 v46, v46
    v_exp_f32 v47, v47
    v_mfma_f32_16x16x32_bf16 v[68:71], v[216:219], v[56:59], v[68:71]
    v_rcp_f32 v112, v112
    v_rcp_f32 v113, v113
    v_mfma_f32_16x16x32_bf16 v[72:75], v[220:223], v[56:59], v[72:75]
    v_rcp_f32 v114, v114
    v_rcp_f32 v115, v115
    v_mfma_f32_16x16x32_bf16 v[76:79], v[224:227], v[56:59], v[76:79]
    v_rcp_f32 v116, v116
    v_rcp_f32 v117, v117
    v_mfma_f32_16x16x32_bf16 v[80:83], v[228:231], v[56:59], v[80:83]
    v_rcp_f32 v118, v118
    v_rcp_f32 v119, v119
    ds_read_b64_tr_b16 v[208:209], v233 offset:49408
    ds_read_b64_tr_b16 v[210:211], v233 offset:52512
    ds_read_b64_tr_b16 v[212:213], v233 offset:49416
    ds_read_b64_tr_b16 v[214:215], v233 offset:52520
    ds_read_b64_tr_b16 v[216:217], v233 offset:49472
    ds_read_b64_tr_b16 v[218:219], v233 offset:52576
    ds_read_b64_tr_b16 v[220:221], v233 offset:49480
    ds_read_b64_tr_b16 v[222:223], v233 offset:52584
    ds_read_b64_tr_b16 v[224:225], v233 offset:49536
    ds_read_b64_tr_b16 v[226:227], v233 offset:52640
    ds_read_b64_tr_b16 v[228:229], v233 offset:49544
    ds_read_b64_tr_b16 v[230:231], v233 offset:52648
    buffer_load_dwordx4 v[184:187], v255, s[20:23], s55 offen offset:0
    buffer_load_dwordx4 v[188:191], v255, s[20:23], s55 offen offset:64
    buffer_load_dwordx4 v[192:195], v255, s[20:23], s55 offen offset:128
    buffer_load_dwordx4 v[196:199], v251, s[20:23], s55 offen offset:64
    s_setprio 3
    s_nop 0
    v_pk_mul_f32 v[16:17], v[16:17], v[48:49]
    v_pk_mul_f32 v[18:19], v[18:19], v[50:51]
    v_pk_mul_f32 v[20:21], v[20:21], v[52:53]
    v_pk_mul_f32 v[22:23], v[22:23], v[54:55]
    v_pk_add_f32 v[40:41], v[40:41], s[62:63]
    v_pk_add_f32 v[42:43], v[42:43], s[62:63]
    v_pk_add_f32 v[44:45], v[44:45], s[62:63]
    v_pk_add_f32 v[46:47], v[46:47], s[62:63]
    v_pk_mul_f32 v[96:97], v[96:97], v[112:113]
    v_pk_mul_f32 v[98:99], v[98:99], v[114:115]
    v_pk_mul_f32 v[100:101], v[100:101], v[116:117]
    v_pk_mul_f32 v[102:103], v[102:103], v[118:119]
    v_pk_fma_f32 v[48:49], v[32:33], v[32:33], s[60:61]
    v_pk_fma_f32 v[50:51], v[34:35], v[34:35], s[60:61]
    v_pk_fma_f32 v[52:53], v[36:37], v[36:37], s[60:61]
    v_pk_fma_f32 v[54:55], v[38:39], v[38:39], s[60:61]
    v_pk_mul_f32 v[48:49], v[32:33], v[48:49] neg_lo:[1,0] neg_hi:[1,0]
    v_pk_mul_f32 v[50:51], v[34:35], v[50:51] neg_lo:[1,0] neg_hi:[1,0]
    v_pk_mul_f32 v[52:53], v[36:37], v[52:53] neg_lo:[1,0] neg_hi:[1,0]
    v_pk_mul_f32 v[54:55], v[38:39], v[54:55] neg_lo:[1,0] neg_hi:[1,0]
    v_cvt_pk_bf16_f32 v56, v16, v17
    v_cvt_pk_bf16_f32 v57, v18, v19
    v_cvt_pk_bf16_f32 v58, v20, v21
    v_cvt_pk_bf16_f32 v59, v22, v23
    v_cvt_pk_bf16_f32 v120, v96, v97
    v_cvt_pk_bf16_f32 v121, v98, v99
    v_cvt_pk_bf16_f32 v122, v100, v101
    v_cvt_pk_bf16_f32 v123, v102, v103
    v_rcp_f32 v40, v40
    v_rcp_f32 v41, v41
    s_waitcnt lgkmcnt(0)
    v_mfma_f32_16x16x32_bf16 v[60:63], v[208:211], v[56:59], v[60:63]
    v_rcp_f32 v42, v42
    v_mfma_f32_16x16x32_bf16 v[64:67], v[212:215], v[56:59], v[64:67]
    v_rcp_f32 v43, v43
    v_mfma_f32_16x16x32_bf16 v[68:71], v[216:219], v[56:59], v[68:71]
    v_rcp_f32 v44, v44
    v_rcp_f32 v45, v45
    v_mfma_f32_16x16x32_bf16 v[72:75], v[220:223], v[56:59], v[72:75]
    v_rcp_f32 v46, v46
    v_mfma_f32_16x16x32_bf16 v[76:79], v[224:227], v[56:59], v[76:79]
    v_rcp_f32 v47, v47
    v_mfma_f32_16x16x32_bf16 v[80:83], v[228:231], v[56:59], v[80:83]
    v_exp_f32 v48, v48
    v_mfma_f32_16x16x32_bf16 v[132:135], v[208:211], v[120:123], v[132:135]
    v_exp_f32 v49, v49
    v_mfma_f32_16x16x32_bf16 v[136:139], v[212:215], v[120:123], v[136:139]
    v_exp_f32 v50, v50
    v_mfma_f32_16x16x32_bf16 v[140:143], v[216:219], v[120:123], v[140:143]
    v_exp_f32 v51, v51
    v_exp_f32 v52, v52
    v_mfma_f32_16x16x32_bf16 v[144:147], v[220:223], v[120:123], v[144:147]
    v_exp_f32 v53, v53
    v_mfma_f32_16x16x32_bf16 v[148:151], v[224:227], v[120:123], v[148:151]
    v_exp_f32 v54, v54
    v_mfma_f32_16x16x32_bf16 v[152:155], v[228:231], v[120:123], v[152:155]
    v_exp_f32 v55, v55
    s_mov_b64 exec, s[52:53]
    s_nop 2
    ds_write_b128 v238, v[132:135] offset:1536
    ds_write_b128 v238, v[136:139] offset:1792
    ds_write_b128 v238, v[148:151] offset:2560
    ds_write_b128 v238, v[152:155] offset:2816
    s_mov_b64 exec, -1
    v_mov_b32_e64 v4, 8
    ds_write_b32 v244, v4
    v_add_u32 v233, 61760, v233
    ds_read_b64_tr_b16 v[208:209], v233 offset:0
    ds_read_b64_tr_b16 v[210:211], v233 offset:3104
    ds_read_b64_tr_b16 v[212:213], v233 offset:8
    ds_read_b64_tr_b16 v[214:215], v233 offset:3112
    ds_read_b64_tr_b16 v[216:217], v233 offset:64
    ds_read_b64_tr_b16 v[218:219], v233 offset:3168
    ds_read_b64_tr_b16 v[220:221], v233 offset:72
    ds_read_b64_tr_b16 v[222:223], v233 offset:3176
    ds_read_b64_tr_b16 v[224:225], v233 offset:128
    ds_read_b64_tr_b16 v[226:227], v233 offset:3232
    ds_read_b64_tr_b16 v[228:229], v233 offset:136
    ds_read_b64_tr_b16 v[230:231], v233 offset:3240
    v_pk_mul_f32 v[24:25], v[24:25], v[40:41]
    v_pk_mul_f32 v[26:27], v[26:27], v[42:43]
    v_pk_mul_f32 v[28:29], v[28:29], v[44:45]
    v_pk_mul_f32 v[30:31], v[30:31], v[46:47]
    v_pk_add_f32 v[48:49], v[48:49], s[62:63]
    v_pk_add_f32 v[50:51], v[50:51], s[62:63]
    v_pk_add_f32 v[52:53], v[52:53], s[62:63]
    v_pk_add_f32 v[54:55], v[54:55], s[62:63]
    v_cvt_pk_bf16_f32 v56, v24, v25
    v_cvt_pk_bf16_f32 v57, v26, v27
    v_cvt_pk_bf16_f32 v58, v28, v29
    v_cvt_pk_bf16_f32 v59, v30, v31
    v_rcp_f32 v48, v48
    v_rcp_f32 v49, v49
    s_waitcnt lgkmcnt(0)
    v_mfma_f32_16x16x32_bf16 v[60:63], v[208:211], v[56:59], v[60:63]
    v_rcp_f32 v50, v50
    v_mfma_f32_16x16x32_bf16 v[64:67], v[212:215], v[56:59], v[64:67]
    v_rcp_f32 v51, v51
    v_mfma_f32_16x16x32_bf16 v[68:71], v[216:219], v[56:59], v[68:71]
    v_rcp_f32 v52, v52
    v_mfma_f32_16x16x32_bf16 v[72:75], v[220:223], v[56:59], v[72:75]
    v_rcp_f32 v53, v53
    v_mfma_f32_16x16x32_bf16 v[76:79], v[224:227], v[56:59], v[76:79]
    v_rcp_f32 v54, v54
    v_mfma_f32_16x16x32_bf16 v[80:83], v[228:231], v[56:59], v[80:83]
    v_rcp_f32_e64 v55, v55
    ds_read_b64_tr_b16 v[208:209], v233 offset:12352
    ds_read_b64_tr_b16 v[210:211], v233 offset:15456
    ds_read_b64_tr_b16 v[212:213], v233 offset:12360
    ds_read_b64_tr_b16 v[214:215], v233 offset:15464
    ds_read_b64_tr_b16 v[216:217], v233 offset:12416
    ds_read_b64_tr_b16 v[218:219], v233 offset:15520
    ds_read_b64_tr_b16 v[220:221], v233 offset:12424
    ds_read_b64_tr_b16 v[222:223], v233 offset:15528
    ds_read_b64_tr_b16 v[224:225], v233 offset:12480
    ds_read_b64_tr_b16 v[226:227], v233 offset:15584
    ds_read_b64_tr_b16 v[228:229], v233 offset:12488
    ds_read_b64_tr_b16 v[230:231], v233 offset:15592
    v_pk_mul_f32 v[32:33], v[32:33], v[48:49]
    v_pk_mul_f32 v[34:35], v[34:35], v[50:51]
    v_pk_mul_f32 v[36:37], v[36:37], v[52:53]
    v_pk_mul_f32 v[38:39], v[38:39], v[54:55]
    ds_read_b128 v[168:171], v241 offset:512
    ds_read_b128 v[172:175], v241 offset:528
    ds_read_b128 v[176:179], v241 offset:640
    ds_read_b128 v[180:183], v241 offset:656
    ds_read_b128 v[84:87], v241 offset:768
    ds_read_b128 v[88:91], v241 offset:784
    s_waitcnt vmcnt(0)
    v_cvt_pk_bf16_f32 v56, v32, v33
    v_cvt_pk_bf16_f32 v57, v34, v35
    v_cvt_pk_bf16_f32 v58, v36, v37
    v_cvt_pk_bf16_f32 v59, v38, v39
    v_lshlrev_b32 v8, 16, v184
    v_and_b32 v9, v7, v184
    s_waitcnt lgkmcnt(6)
    v_mfma_f32_16x16x32_bf16 v[60:63], v[208:211], v[56:59], v[60:63]
    v_lshlrev_b32 v10, 16, v185
    v_and_b32 v11, v7, v185
    v_lshlrev_b32 v12, 16, v186
    v_and_b32 v13, v7, v186
    v_mfma_f32_16x16x32_bf16 v[64:67], v[212:215], v[56:59], v[64:67]
    v_lshlrev_b32 v14, 16, v187
    v_and_b32 v15, v7, v187
    v_lshlrev_b32 v16, 16, v188
    v_mfma_f32_16x16x32_bf16 v[68:71], v[216:219], v[56:59], v[68:71]
    v_and_b32 v17, v7, v188
    v_lshlrev_b32 v18, 16, v189
    v_and_b32 v19, v7, v189
    v_lshlrev_b32 v20, 16, v190
    v_mfma_f32_16x16x32_bf16 v[72:75], v[220:223], v[56:59], v[72:75]
    v_and_b32 v21, v7, v190
    v_lshlrev_b32 v22, 16, v191
    v_and_b32 v23, v7, v191
    v_lshlrev_b32 v24, 16, v192
    v_mfma_f32_16x16x32_bf16 v[76:79], v[224:227], v[56:59], v[76:79]
    v_and_b32 v25, v7, v192
    v_lshlrev_b32 v26, 16, v193
    v_and_b32 v27, v7, v193
    v_mfma_f32_16x16x32_bf16 v[80:83], v[228:231], v[56:59], v[80:83]
    v_lshlrev_b32 v28, 16, v194
    v_and_b32 v29, v7, v194
    v_lshlrev_b32 v30, 16, v195
    v_and_b32 v31, v7, v195
    s_waitcnt lgkmcnt(0)
    v_lshlrev_b32 v96, 16, v196
    v_and_b32 v97, v7, v196
    v_lshlrev_b32 v98, 16, v197
    v_and_b32 v99, v7, v197
    v_lshlrev_b32 v100, 16, v198
    v_and_b32 v101, v7, v198
    v_lshlrev_b32 v102, 16, v199
    v_and_b32_e64 v103, v7, v199
    v_pk_fma_f32 v[8:9], v[60:61], v[168:169], v[8:9]
    v_pk_fma_f32 v[10:11], v[62:63], v[170:171], v[10:11]
    v_pk_fma_f32 v[12:13], v[64:65], v[172:173], v[12:13]
    v_pk_fma_f32 v[14:15], v[66:67], v[174:175], v[14:15]
    v_cvt_pk_bf16_f32 v208, v8, v9
    v_cvt_pk_bf16_f32 v209, v10, v11
    v_cvt_pk_bf16_f32 v210, v12, v13
    v_cvt_pk_bf16_f32 v211, v14, v15
    ds_write_b128 v254, v[208:211] offset:0
    v_pk_fma_f32 v[16:17], v[68:69], v[176:177], v[16:17]
    v_pk_fma_f32 v[18:19], v[70:71], v[178:179], v[18:19]
    v_pk_fma_f32 v[20:21], v[72:73], v[180:181], v[20:21]
    v_pk_fma_f32 v[22:23], v[74:75], v[182:183], v[22:23]
    v_cvt_pk_bf16_f32 v212, v16, v17
    v_cvt_pk_bf16_f32 v213, v18, v19
    v_cvt_pk_bf16_f32 v214, v20, v21
    v_cvt_pk_bf16_f32 v215, v22, v23
    ds_write_b128 v254, v[212:215] offset:64
    ds_read_b32 v5, v245
    v_pk_fma_f32 v[24:25], v[76:77], v[84:85], v[24:25]
    v_pk_fma_f32 v[26:27], v[78:79], v[86:87], v[26:27]
    v_pk_fma_f32 v[28:29], v[80:81], v[88:89], v[28:29]
    v_pk_fma_f32 v[30:31], v[82:83], v[90:91], v[30:31]
    v_cvt_pk_bf16_f32 v216, v24, v25
    v_cvt_pk_bf16_f32 v217, v26, v27
    v_cvt_pk_bf16_f32 v218, v28, v29
    v_cvt_pk_bf16_f32 v219, v30, v31
    ds_write_b128 v254, v[216:219] offset:128
    s_waitcnt lgkmcnt(0)
    ds_read_b128 v[184:187], v243 offset:0
    ds_read_b128 v[188:191], v243 offset:1024
    ds_read_b128 v[192:195], v243 offset:2048
    v_cmp_le_u32 vcc, 8, v5
    s_and_b32 s47, vcc_lo, 15
    s_cmp_eq_u32 s47, 15
    s_cbranch_scc0 L_mb1_slow
    ds_read_b128 v[8:11], v238 offset:512
    ds_read_b128 v[12:15], v238 offset:768
    ds_read_b128 v[16:19], v238 offset:3584
    ds_read_b128 v[20:23], v238 offset:3840
    ds_read_b128 v[24:27], v238 offset:5120
    ds_read_b128 v[28:31], v238 offset:5376
    s_waitcnt lgkmcnt(8)
    buffer_store_dwordx4 v[184:187], v248, s[36:39], s55 offen sc1
    s_waitcnt lgkmcnt(7)
    buffer_store_dwordx4 v[188:191], v249, s[36:39], s55 offen sc1
    s_waitcnt lgkmcnt(6)
    buffer_store_dwordx4 v[192:195], v250, s[36:39], s55 offen sc1
L_mb1_join:
    s_waitcnt lgkmcnt(4)
    v_pk_add_f32 v[140:141], v[140:141], v[8:9]
    v_pk_add_f32 v[142:143], v[142:143], v[10:11]
    v_pk_add_f32 v[144:145], v[144:145], v[12:13]
    v_pk_add_f32 v[146:147], v[146:147], v[14:15]
    s_waitcnt lgkmcnt(2)
    v_pk_add_f32 v[140:141], v[140:141], v[16:17]
    v_pk_add_f32 v[142:143], v[142:143], v[18:19]
    v_pk_add_f32 v[144:145], v[144:145], v[20:21]
    v_pk_add_f32 v[146:147], v[146:147], v[22:23]
    s_waitcnt lgkmcnt(0)
    s_nop 0
    v_pk_add_f32 v[140:141], v[140:141], v[24:25]
    v_pk_add_f32 v[142:143], v[142:143], v[26:27]
    v_pk_add_f32 v[144:145], v[144:145], v[28:29]
    v_pk_add_f32 v[146:147], v[146:147], v[30:31]
    v_pk_fma_f32 v[96:97], v[140:141], v[176:177], v[96:97]
    v_pk_fma_f32 v[98:99], v[142:143], v[178:179], v[98:99]
    v_pk_fma_f32 v[100:101], v[144:145], v[180:181], v[100:101]
    v_pk_fma_f32 v[102:103], v[146:147], v[182:183], v[102:103]
    v_cvt_pk_bf16_f32 v120, v96, v97
    v_cvt_pk_bf16_f32 v121, v98, v99
    v_cvt_pk_bf16_f32 v122, v100, v101
    v_cvt_pk_bf16_f32 v123, v102, v103
    buffer_store_dwordx4 v[120:123], v251, s[36:39], s55 offen offset:64 sc1
    s_endpgm
L_mb1_slow:
    s_waitcnt lgkmcnt(0)
    buffer_store_dwordx4 v[184:187], v248, s[36:39], s55 offen sc1
    buffer_store_dwordx4 v[188:191], v249, s[36:39], s55 offen sc1
    buffer_store_dwordx4 v[192:195], v250, s[36:39], s55 offen sc1
L_mb1:
    ds_read_b32 v5, v245
    s_waitcnt lgkmcnt(0)
    v_cmp_le_u32 vcc, 8, v5
    s_and_b32 s47, vcc_lo, 15
    s_cmp_eq_u32 s47, 15
    s_cbranch_scc0 L_mb1
    ds_read_b128 v[8:11], v238 offset:512
    ds_read_b128 v[12:15], v238 offset:768
    ds_read_b128 v[16:19], v238 offset:3584
    ds_read_b128 v[20:23], v238 offset:3840
    ds_read_b128 v[24:27], v238 offset:5120
    ds_read_b128 v[28:31], v238 offset:5376
    s_branch L_mb1_join
L_n2:
    ds_read_b128 v[16:19], v240 offset:128
    ds_read_b128 v[20:23], v240 offset:192
    ds_read_b64_tr_b16 v[184:185], v232 offset:12352
    ds_read_b64_tr_b16 v[186:187], v232 offset:13376
    ds_read_b64_tr_b16 v[188:189], v232 offset:14400
    ds_read_b64_tr_b16 v[190:191], v232 offset:15424
    ds_read_b64_tr_b16 v[192:193], v232 offset:16448
    ds_read_b64_tr_b16 v[194:195], v232 offset:17472
    ds_read_b64_tr_b16 v[196:197], v237 offset:12352
    ds_read_b64_tr_b16 v[198:199], v237 offset:13376
    ds_read_b64_tr_b16 v[200:201], v237 offset:14400
    ds_read_b64_tr_b16 v[202:203], v237 offset:15424
    ds_read_b64_tr_b16 v[204:205], v237 offset:16448
    ds_read_b64_tr_b16 v[206:207], v237 offset:17472
    s_mov_b32 exec_hi, 0xffff
    s_add_u32 m0, s57, 61760
    s_movk_i32 s59, 320
    buffer_load_dwordx4 v236, s[28:31], s59 offen lds
    s_add_u32 m0, s58, 24704
    s_mov_b32 s59, 12288
    buffer_load_dwordx4 v242, s[32:35], s59 offen lds
    s_add_u32 m0, s57, 74112
    s_movk_i32 s59, 384
    buffer_load_dwordx4 v236, s[28:31], s59 offen lds
    s_mov_b32 exec_hi, -1
    s_setprio 2
    v_pk_fma_f32 v[40:41], v[8:9], v[8:9], s[60:61]
    v_pk_fma_f32 v[42:43], v[10:11], v[10:11], s[60:61]
    v_pk_fma_f32 v[44:45], v[12:13], v[12:13], s[60:61]
    v_pk_fma_f32 v[46:47], v[14:15], v[14:15], s[60:61]
    v_pk_mul_f32 v[40:41], v[8:9], v[40:41] neg_lo:[1,0] neg_hi:[1,0]
    v_pk_mul_f32 v[42:43], v[10:11], v[42:43] neg_lo:[1,0] neg_hi:[1,0]
    v_pk_mul_f32 v[44:45], v[12:13], v[44:45] neg_lo:[1,0] neg_hi:[1,0]
    v_pk_mul_f32 v[46:47], v[14:15], v[46:47] neg_lo:[1,0] neg_hi:[1,0]
    v_exp_f32 v40, v40
    s_waitcnt lgkmcnt(0)
    v_mfma_f32_16x16x32_bf16 v[16:19], v[184:187], v[84:87], v[16:19]
    v_exp_f32 v41, v41
    v_mfma_f32_16x16x32_bf16 v[16:19], v[188:191], v[88:91], v[16:19]
    v_exp_f32 v42, v42
    v_mfma_f32_16x16x32_bf16 v[16:19], v[192:195], v[92:95], v[16:19]
    v_exp_f32 v43, v43
    v_exp_f32 v44, v44
    v_mfma_f32_16x16x32_bf16 v[20:23], v[196:199], v[84:87], v[20:23]
    v_exp_f32 v45, v45
    v_mfma_f32_16x16x32_bf16 v[20:23], v[200:203], v[88:91], v[20:23]
    v_exp_f32 v46, v46
    v_mfma_f32_16x16x32_bf16 v[20:23], v[204:207], v[92:95], v[20:23]
    v_exp_f32_e64 v47, v47
    ds_read_b128 v[24:27], v240 offset:256
    ds_read_b128 v[28:31], v240 offset:320
    ds_read_b128 v[96:99], v240 offset:256
    ds_read_b128 v[100:103], v240 offset:320
    ds_read_b64_tr_b16 v[184:185], v232 offset:24704
    ds_read_b64_tr_b16 v[186:187], v232 offset:25728
    ds_read_b64_tr_b16 v[188:189], v232 offset:26752
    ds_read_b64_tr_b16 v[190:191], v232 offset:27776
    ds_read_b64_tr_b16 v[192:193], v232 offset:28800
    ds_read_b64_tr_b16 v[194:195], v232 offset:29824
    ds_read_b64_tr_b16 v[196:197], v237 offset:24704
    ds_read_b64_tr_b16 v[198:199], v237 offset:25728
    ds_read_b64_tr_b16 v[200:201], v237 offset:26752
    ds_read_b64_tr_b16 v[202:203], v237 offset:27776
    ds_read_b64_tr_b16 v[204:205], v237 offset:28800
    ds_read_b64_tr_b16 v[206:207], v237 offset:29824
    ds_read_b128 v[60:63], v241 offset:0
    ds_read_b128 v[64:67], v241 offset:16
    ds_read_b128 v[68:71], v241 offset:128
    ds_read_b128 v[72:75], v241 offset:144
    ds_read_b128 v[76:79], v241 offset:256
    ds_read_b128 v[80:83], v241 offset:272
    s_mov_b32 exec_hi, 0xffff
    s_add_u32 m0, s58, 37056
    s_mov_b32 s59, 18432
    buffer_load_dwordx4 v242, s[32:35], s59 offen lds
    s_add_u32 m0, s57, 86464
    s_movk_i32 s59, 448
    buffer_load_dwordx4 v236, s[28:31], s59 offen lds
    s_add_u32 m0, s58, 49408
    s_mov_b32 s59, 24576
    buffer_load_dwordx4 v242, s[32:35], s59 offen lds
    s_mov_b32 exec_hi, -1
    v_pk_add_f32 v[40:41], v[40:41], s[62:63]
    v_pk_add_f32 v[42:43], v[42:43], s[62:63]
    v_pk_add_f32 v[44:45], v[44:45], s[62:63]
    v_pk_add_f32 v[46:47], v[46:47], s[62:63]
    v_pk_fma_f32 v[48:49], v[16:17], v[16:17], s[60:61]
    v_pk_fma_f32 v[50:51], v[18:19], v[18:19], s[60:61]
    v_pk_fma_f32 v[52:53], v[20:21], v[20:21], s[60:61]
    v_pk_fma_f32 v[54:55], v[22:23], v[22:23], s[60:61]
    v_pk_mul_f32 v[48:49], v[16:17], v[48:49] neg_lo:[1,0] neg_hi:[1,0]
    v_pk_mul_f32 v[50:51], v[18:19], v[50:51] neg_lo:[1,0] neg_hi:[1,0]
    v_pk_mul_f32 v[52:53], v[20:21], v[52:53] neg_lo:[1,0] neg_hi:[1,0]
    v_pk_mul_f32 v[54:55], v[22:23], v[54:55] neg_lo:[1,0] neg_hi:[1,0]
    v_rcp_f32 v40, v40
    s_waitcnt lgkmcnt(6)
    v_mfma_f32_16x16x32_bf16 v[24:27], v[184:187], v[84:87], v[24:27]
    v_rcp_f32 v41, v41
    v_mfma_f32_16x16x32_bf16 v[24:27], v[188:191], v[88:91], v[24:27]
    v_rcp_f32 v42, v42
    v_rcp_f32 v43, v43
    v_mfma_f32_16x16x32_bf16 v[24:27], v[192:195], v[92:95], v[24:27]
    v_rcp_f32 v44, v44
    v_mfma_f32_16x16x32_bf16 v[28:31], v[196:199], v[84:87], v[28:31]
    v_rcp_f32 v45, v45
    v_mfma_f32_16x16x32_bf16 v[28:31], v[200:203], v[88:91], v[28:31]
    v_rcp_f32 v46, v46
    v_mfma_f32_16x16x32_bf16 v[28:31], v[204:207], v[92:95], v[28:31]
    v_rcp_f32 v47, v47
    v_exp_f32 v48, v48
    v_mfma_f32_16x16x32_bf16 v[96:99], v[184:187], v[156:159], v[96:99]
    v_exp_f32 v49, v49
    v_mfma_f32_16x16x32_bf16 v[96:99], v[188:191], v[160:163], v[96:99]
    v_exp_f32 v50, v50
    v_mfma_f32_16x16x32_bf16 v[96:99], v[192:195], v[164:167], v[96:99]
    v_exp_f32 v51, v51
    v_mfma_f32_16x16x32_bf16 v[100:103], v[196:199], v[156:159], v[100:103]
    v_exp_f32 v52, v52
    v_exp_f32 v53, v53
    v_mfma_f32_16x16x32_bf16 v[100:103], v[200:203], v[160:163], v[100:103]
    v_exp_f32 v54, v54
    v_mfma_f32_16x16x32_bf16 v[100:103], v[204:207], v[164:167], v[100:103]
    v_exp_f32_e64 v55, v55
    ds_read_b128 v[32:35], v240 offset:384
    ds_read_b128 v[36:39], v240 offset:448
    ds_read_b64_tr_b16 v[184:185], v232 offset:37056
    ds_read_b64_tr_b16 v[186:187], v232 offset:38080
    ds_read_b64_tr_b16 v[188:189], v232 offset:39104
    ds_read_b64_tr_b16 v[190:191], v232 offset:40128
    ds_read_b64_tr_b16 v[192:193], v232 offset:41152
    ds_read_b64_tr_b16 v[194:195], v232 offset:42176
    ds_read_b64_tr_b16 v[196:197], v237 offset:37056
    ds_read_b64_tr_b16 v[198:199], v237 offset:38080
    ds_read_b64_tr_b16 v[200:201], v237 offset:39104
    ds_read_b64_tr_b16 v[202:203], v237 offset:40128
    ds_read_b64_tr_b16 v[204:205], v237 offset:41152
    ds_read_b64_tr_b16 v[206:207], v237 offset:42176
    ds_read_b64_tr_b16 v[208:209], v233 offset:0
    ds_read_b64_tr_b16 v[210:211], v233 offset:3104
    ds_read_b64_tr_b16 v[212:213], v233 offset:8
    ds_read_b64_tr_b16 v[214:215], v233 offset:3112
    ds_read_b64_tr_b16 v[216:217], v233 offset:64
    ds_read_b64_tr_b16 v[218:219], v233 offset:3168
    ds_read_b64_tr_b16 v[220:221], v233 offset:72
    ds_read_b64_tr_b16 v[222:223], v233 offset:3176
    ds_read_b64_tr_b16 v[224:225], v233 offset:128
    ds_read_b64_tr_b16 v[226:227], v233 offset:3232
    ds_read_b64_tr_b16 v[228:229], v233 offset:136
    ds_read_b64_tr_b16 v[230:231], v233 offset:3240
    s_waitcnt vmcnt(0)
    v_mov_b32 v4, 5
    ds_write_b32 v244, v4
    s_mov_b32 exec_hi, 0xffff
    s_add_u32 m0, s57, 98816
    s_movk_i32 s59, 512
    buffer_load_dwordx4 v236, s[28:31], s59 offen lds
    s_add_u32 m0, s58, 61760
    s_mov_b32 s59, 30720
    buffer_load_dwordx4 v242, s[32:35], s59 offen lds
    s_mov_b32 exec_hi, -1
    v_pk_mul_f32 v[8:9], v[8:9], v[40:41]
    v_pk_mul_f32 v[10:11], v[10:11], v[42:43]
    v_pk_mul_f32 v[12:13], v[12:13], v[44:45]
    v_pk_mul_f32 v[14:15], v[14:15], v[46:47]
    v_pk_add_f32 v[48:49], v[48:49], s[62:63]
    v_pk_add_f32 v[50:51], v[50:51], s[62:63]
    v_pk_add_f32 v[52:53], v[52:53], s[62:63]
    v_pk_add_f32 v[54:55], v[54:55], s[62:63]
    v_pk_fma_f32 v[40:41], v[24:25], v[24:25], s[60:61]
    v_pk_fma_f32 v[42:43], v[26:27], v[26:27], s[60:61]
    v_pk_fma_f32 v[44:45], v[28:29], v[28:29], s[60:61]
    v_pk_fma_f32 v[46:47], v[30:31], v[30:31], s[60:61]
    v_pk_mul_f32 v[40:41], v[24:25], v[40:41] neg_lo:[1,0] neg_hi:[1,0]
    v_pk_mul_f32 v[42:43], v[26:27], v[42:43] neg_lo:[1,0] neg_hi:[1,0]
    v_pk_mul_f32 v[44:45], v[28:29], v[44:45] neg_lo:[1,0] neg_hi:[1,0]
    v_pk_mul_f32 v[46:47], v[30:31], v[46:47] neg_lo:[1,0] neg_hi:[1,0]
    v_pk_fma_f32 v[112:113], v[96:97], v[96:97], s[60:61]
    v_pk_fma_f32 v[114:115], v[98:99], v[98:99], s[60:61]
    v_pk_fma_f32 v[116:117], v[100:101], v[100:101], s[60:61]
    v_pk_fma_f32 v[118:119], v[102:103], v[102:103], s[60:61]
    v_pk_mul_f32 v[112:113], v[96:97], v[112:113] neg_lo:[1,0] neg_hi:[1,0]
    v_pk_mul_f32 v[114:115], v[98:99], v[114:115] neg_lo:[1,0] neg_hi:[1,0]
    v_pk_mul_f32 v[116:117], v[100:101], v[116:117] neg_lo:[1,0] neg_hi:[1,0]
    v_pk_mul_f32 v[118:119], v[102:103], v[118:119] neg_lo:[1,0] neg_hi:[1,0]
    v_rcp_f32 v48, v48
    s_waitcnt lgkmcnt(13)
    v_mfma_f32_16x16x32_bf16 v[32:35], v[184:187], v[84:87], v[32:35]
    v_cvt_pk_bf16_f32 v56, v8, v9
    v_cvt_pk_bf16_f32 v57, v10, v11
    v_rcp_f32 v49, v49
    v_mfma_f32_16x16x32_bf16 v[32:35], v[188:191], v[88:91], v[32:35]
    v_cvt_pk_bf16_f32 v58, v12, v13
    v_cvt_pk_bf16_f32 v59, v14, v15
    v_rcp_f32 v50, v50
    v_mfma_f32_16x16x32_bf16 v[32:35], v[192:195], v[92:95], v[32:35]
    v_rcp_f32 v51, v51
    v_rcp_f32 v52, v52
    v_mfma_f32_16x16x32_bf16 v[36:39], v[196:199], v[84:87], v[36:39]
    v_rcp_f32 v53, v53
    v_rcp_f32 v54, v54
    v_mfma_f32_16x16x32_bf16 v[36:39], v[200:203], v[88:91], v[36:39]
    v_rcp_f32 v55, v55
    v_exp_f32 v40, v40
    v_mfma_f32_16x16x32_bf16 v[36:39], v[204:207], v[92:95], v[36:39]
    v_exp_f32 v41, v41
    v_exp_f32 v42, v42
    v_exp_f32 v43, v43
    s_waitcnt lgkmcnt(0)
    v_mfma_f32_16x16x32_bf16 v[60:63], v[208:211], v[56:59], v[60:63]
    v_exp_f32 v44, v44
    v_exp_f32 v45, v45
    v_mfma_f32_16x16x32_bf16 v[64:67], v[212:215], v[56:59], v[64:67]
    v_exp_f32 v46, v46
    v_exp_f32 v47, v47
    v_mfma_f32_16x16x32_bf16 v[68:71], v[216:219], v[56:59], v[68:71]
    v_exp_f32 v112, v112
    v_exp_f32 v113, v113
    v_mfma_f32_16x16x32_bf16 v[72:75], v[220:223], v[56:59], v[72:75]
    v_exp_f32 v114, v114
    v_exp_f32 v115, v115
    v_mfma_f32_16x16x32_bf16 v[76:79], v[224:227], v[56:59], v[76:79]
    v_exp_f32 v116, v116
    v_exp_f32 v117, v117
    v_mfma_f32_16x16x32_bf16 v[80:83], v[228:231], v[56:59], v[80:83]
    v_exp_f32 v118, v118
    v_exp_f32 v119, v119
    ds_read_b128 v[8:11], v240 offset:512
    ds_read_b128 v[12:15], v240 offset:576
    ds_read_b64_tr_b16 v[184:185], v232 offset:49408
    ds_read_b64_tr_b16 v[186:187], v232 offset:50432
    ds_read_b64_tr_b16 v[188:189], v232 offset:51456
    ds_read_b64_tr_b16 v[190:191], v232 offset:52480
    ds_read_b64_tr_b16 v[192:193], v232 offset:53504
    ds_read_b64_tr_b16 v[194:195], v232 offset:54528
    ds_read_b64_tr_b16 v[196:197], v237 offset:49408
    ds_read_b64_tr_b16 v[198:199], v237 offset:50432
    ds_read_b64_tr_b16 v[200:201], v237 offset:51456
    ds_read_b64_tr_b16 v[202:203], v237 offset:52480
    ds_read_b64_tr_b16 v[204:205], v237 offset:53504
    ds_read_b64_tr_b16 v[206:207], v237 offset:54528
    ds_read_b64_tr_b16 v[208:209], v233 offset:12352
    ds_read_b64_tr_b16 v[210:211], v233 offset:15456
    ds_read_b64_tr_b16 v[212:213], v233 offset:12360
    ds_read_b64_tr_b16 v[214:215], v233 offset:15464
    ds_read_b64_tr_b16 v[216:217], v233 offset:12416
    ds_read_b64_tr_b16 v[218:219], v233 offset:15520
    ds_read_b64_tr_b16 v[220:221], v233 offset:12424
    ds_read_b64_tr_b16 v[222:223], v233 offset:15528
    ds_read_b64_tr_b16 v[224:225], v233 offset:12480
    ds_read_b64_tr_b16 v[226:227], v233 offset:15584
    ds_read_b64_tr_b16 v[228:229], v233 offset:12488
    ds_read_b64_tr_b16 v[230:231], v233 offset:15592
    ds_read_b32 v5, v245
    s_mov_b32 exec_hi, 0xffff
    s_add_u32 m0, s57, 111168
    s_movk_i32 s59, 576
    buffer_load_dwordx4 v236, s[28:31], s59 offen lds
    s_add_u32 m0, s58, 74112
    s_mov_b32 s59, 36864
    buffer_load_dwordx4 v242, s[32:35], s59 offen lds
    s_mov_b32 exec_hi, -1
    s_setprio 1
    s_nop 0
    v_pk_mul_f32 v[16:17], v[16:17], v[48:49]
    v_pk_mul_f32 v[18:19], v[18:19], v[50:51]
    v_pk_mul_f32 v[20:21], v[20:21], v[52:53]
    v_pk_mul_f32 v[22:23], v[22:23], v[54:55]
    v_pk_add_f32 v[40:41], v[40:41], s[62:63]
    v_pk_add_f32 v[42:43], v[42:43], s[62:63]
    v_pk_add_f32 v[44:45], v[44:45], s[62:63]
    v_pk_add_f32 v[46:47], v[46:47], s[62:63]
    v_pk_add_f32 v[112:113], v[112:113], s[62:63]
    v_pk_add_f32 v[114:115], v[114:115], s[62:63]
    v_pk_add_f32 v[116:117], v[116:117], s[62:63]
    v_pk_add_f32 v[118:119], v[118:119], s[62:63]
    v_pk_fma_f32 v[48:49], v[32:33], v[32:33], s[60:61]
    v_pk_fma_f32 v[50:51], v[34:35], v[34:35], s[60:61]
    v_pk_fma_f32 v[52:53], v[36:37], v[36:37], s[60:61]
    v_pk_fma_f32 v[54:55], v[38:39], v[38:39], s[60:61]
    v_pk_mul_f32 v[48:49], v[32:33], v[48:49] neg_lo:[1,0] neg_hi:[1,0]
    v_pk_mul_f32 v[50:51], v[34:35], v[50:51] neg_lo:[1,0] neg_hi:[1,0]
    v_pk_mul_f32 v[52:53], v[36:37], v[52:53] neg_lo:[1,0] neg_hi:[1,0]
    v_pk_mul_f32 v[54:55], v[38:39], v[54:55] neg_lo:[1,0] neg_hi:[1,0]
    v_rcp_f32 v40, v40
    s_waitcnt lgkmcnt(13)
    v_mfma_f32_16x16x32_bf16 v[8:11], v[184:187], v[84:87], v[8:11]
    v_cvt_pk_bf16_f32 v56, v16, v17
    v_cvt_pk_bf16_f32 v57, v18, v19
    v_rcp_f32 v41, v41
    v_mfma_f32_16x16x32_bf16 v[8:11], v[188:191], v[88:91], v[8:11]
    v_cvt_pk_bf16_f32 v58, v20, v21
    v_cvt_pk_bf16_f32 v59, v22, v23
    v_rcp_f32 v42, v42
    v_mfma_f32_16x16x32_bf16 v[8:11], v[192:195], v[92:95], v[8:11]
    v_rcp_f32 v43, v43
    v_rcp_f32 v44, v44
    v_mfma_f32_16x16x32_bf16 v[12:15], v[196:199], v[84:87], v[12:15]
    v_rcp_f32 v45, v45
    v_rcp_f32 v46, v46
    v_mfma_f32_16x16x32_bf16 v[12:15], v[200:203], v[88:91], v[12:15]
    v_rcp_f32 v47, v47
    v_exp_f32 v48, v48
    v_mfma_f32_16x16x32_bf16 v[12:15], v[204:207], v[92:95], v[12:15]
    v_exp_f32 v49, v49
    v_exp_f32 v50, v50
    v_exp_f32 v51, v51
    s_waitcnt lgkmcnt(0)
    v_mfma_f32_16x16x32_bf16 v[60:63], v[208:211], v[56:59], v[60:63]
    v_exp_f32 v52, v52
    v_exp_f32 v53, v53
    v_mfma_f32_16x16x32_bf16 v[64:67], v[212:215], v[56:59], v[64:67]
    v_exp_f32 v54, v54
    v_exp_f32 v55, v55
    v_mfma_f32_16x16x32_bf16 v[68:71], v[216:219], v[56:59], v[68:71]
    v_rcp_f32 v112, v112
    v_rcp_f32 v113, v113
    v_mfma_f32_16x16x32_bf16 v[72:75], v[220:223], v[56:59], v[72:75]
    v_rcp_f32 v114, v114
    v_rcp_f32 v115, v115
    v_mfma_f32_16x16x32_bf16 v[76:79], v[224:227], v[56:59], v[76:79]
    v_rcp_f32 v116, v116
    v_rcp_f32 v117, v117
    v_mfma_f32_16x16x32_bf16 v[80:83], v[228:231], v[56:59], v[80:83]
    v_rcp_f32 v118, v118
    v_rcp_f32 v119, v119
    v_cmp_le_u32 vcc, 5, v5
    s_cmp_eq_u64 vcc, -1
    s_cbranch_scc1 L_gate_N2_3_ok
L_gate_N2_3:
    ds_read_b32 v5, v245
    s_waitcnt lgkmcnt(0)
    v_cmp_le_u32 vcc, 5, v5
    s_cmp_eq_u64 vcc, -1
    s_cbranch_scc0 L_gate_N2_3
L_gate_N2_3_ok:
    s_nop 0
    v_add_u32 v232, 61760, v232
    v_add_u32 v237, 61760, v237
    ds_read_b128 v[16:19], v240 offset:640
    ds_read_b128 v[20:23], v240 offset:704
    ds_read_b64_tr_b16 v[184:185], v232 offset:0
    ds_read_b64_tr_b16 v[186:187], v232 offset:1024
    ds_read_b64_tr_b16 v[188:189], v232 offset:2048
    ds_read_b64_tr_b16 v[190:191], v232 offset:3072
    ds_read_b64_tr_b16 v[192:193], v232 offset:4096
    ds_read_b64_tr_b16 v[194:195], v232 offset:5120
    ds_read_b64_tr_b16 v[196:197], v237 offset:0
    ds_read_b64_tr_b16 v[198:199], v237 offset:1024
    ds_read_b64_tr_b16 v[200:201], v237 offset:2048
    ds_read_b64_tr_b16 v[202:203], v237 offset:3072
    ds_read_b64_tr_b16 v[204:205], v237 offset:4096
    ds_read_b64_tr_b16 v[206:207], v237 offset:5120
    ds_read_b64_tr_b16 v[208:209], v233 offset:24704
    ds_read_b64_tr_b16 v[210:211], v233 offset:27808
    ds_read_b64_tr_b16 v[212:213], v233 offset:24712
    ds_read_b64_tr_b16 v[214:215], v233 offset:27816
    ds_read_b64_tr_b16 v[216:217], v233 offset:24768
    ds_read_b64_tr_b16 v[218:219], v233 offset:27872
    ds_read_b64_tr_b16 v[220:221], v233 offset:24776
    ds_read_b64_tr_b16 v[222:223], v233 offset:27880
    ds_read_b64_tr_b16 v[224:225], v233 offset:24832
    ds_read_b64_tr_b16 v[226:227], v233 offset:27936
    ds_read_b64_tr_b16 v[228:229], v233 offset:24840
    ds_read_b64_tr_b16 v[230:231], v233 offset:27944
    s_mov_b32 exec_hi, 0xffff
    s_add_u32 m0, s57, 123520
    s_movk_i32 s59, 640
    buffer_load_dwordx4 v236, s[28:31], s59 offen lds
    s_add_u32 m0, s58, 86464
    s_mov_b32 s59, 43008
    buffer_load_dwordx4 v242, s[32:35], s59 offen lds
    s_mov_b32 exec_hi, -1
    v_pk_mul_f32 v[24:25], v[24:25], v[40:41]
    v_pk_mul_f32 v[26:27], v[26:27], v[42:43]
    v_pk_mul_f32 v[28:29], v[28:29], v[44:45]
    v_pk_mul_f32 v[30:31], v[30:31], v[46:47]
    v_pk_add_f32 v[48:49], v[48:49], s[62:63]
    v_pk_add_f32 v[50:51], v[50:51], s[62:63]
    v_pk_add_f32 v[52:53], v[52:53], s[62:63]
    v_pk_add_f32 v[54:55], v[54:55], s[62:63]
    v_pk_mul_f32 v[96:97], v[96:97], v[112:113]
    v_pk_mul_f32 v[98:99], v[98:99], v[114:115]
    v_pk_mul_f32 v[100:101], v[100:101], v[116:117]
    v_pk_mul_f32 v[102:103], v[102:103], v[118:119]
    v_pk_fma_f32 v[40:41], v[8:9], v[8:9], s[60:61]
    v_pk_fma_f32 v[42:43], v[10:11], v[10:11], s[60:61]
    v_pk_fma_f32 v[44:45], v[12:13], v[12:13], s[60:61]
    v_pk_fma_f32 v[46:47], v[14:15], v[14:15], s[60:61]
    v_pk_mul_f32 v[40:41], v[8:9], v[40:41] neg_lo:[1,0] neg_hi:[1,0]
    v_pk_mul_f32 v[42:43], v[10:11], v[42:43] neg_lo:[1,0] neg_hi:[1,0]
    v_pk_mul_f32 v[44:45], v[12:13], v[44:45] neg_lo:[1,0] neg_hi:[1,0]
    v_pk_mul_f32 v[46:47], v[14:15], v[46:47] neg_lo:[1,0] neg_hi:[1,0]
    v_rcp_f32 v48, v48
    s_waitcnt lgkmcnt(12)
    v_mfma_f32_16x16x32_bf16 v[16:19], v[184:187], v[84:87], v[16:19]
    v_cvt_pk_bf16_f32 v56, v24, v25
    v_cvt_pk_bf16_f32 v57, v26, v27
    v_mfma_f32_16x16x32_bf16 v[16:19], v[188:191], v[88:91], v[16:19]
    v_rcp_f32 v49, v49
    v_mfma_f32_16x16x32_bf16 v[16:19], v[192:195], v[92:95], v[16:19]
    v_cvt_pk_bf16_f32 v58, v28, v29
    v_cvt_pk_bf16_f32 v59, v30, v31
    v_mfma_f32_16x16x32_bf16 v[20:23], v[196:199], v[84:87], v[20:23]
    v_rcp_f32 v50, v50
    v_mfma_f32_16x16x32_bf16 v[20:23], v[200:203], v[88:91], v[20:23]
    v_cvt_pk_bf16_f32 v120, v96, v97
    v_cvt_pk_bf16_f32 v121, v98, v99
    v_mfma_f32_16x16x32_bf16 v[20:23], v[204:207], v[92:95], v[20:23]
    v_rcp_f32 v51, v51
    v_cvt_pk_bf16_f32 v122, v100, v101
    s_waitcnt lgkmcnt(0)
    v_mfma_f32_16x16x32_bf16 v[60:63], v[208:211], v[56:59], v[60:63]
    v_cvt_pk_bf16_f32 v123, v102, v103
    v_mfma_f32_16x16x32_bf16 v[64:67], v[212:215], v[56:59], v[64:67]
    v_rcp_f32 v52, v52
    v_mfma_f32_16x16x32_bf16 v[68:71], v[216:219], v[56:59], v[68:71]
    v_rcp_f32 v53, v53
    v_rcp_f32 v54, v54
    v_mfma_f32_16x16x32_bf16 v[72:75], v[220:223], v[56:59], v[72:75]
    v_rcp_f32 v55, v55
    v_mfma_f32_16x16x32_bf16 v[76:79], v[224:227], v[56:59], v[76:79]
    v_exp_f32 v40, v40
    v_mfma_f32_16x16x32_bf16 v[80:83], v[228:231], v[56:59], v[80:83]
    v_exp_f32 v41, v41
    v_mfma_f32_16x16x32_bf16 v[132:135], v[208:211], v[120:123], 0
    v_exp_f32 v42, v42
    v_mfma_f32_16x16x32_bf16 v[136:139], v[212:215], v[120:123], 0
    v_exp_f32 v43, v43
    v_mfma_f32_16x16x32_bf16 v[140:143], v[216:219], v[120:123], 0
    v_exp_f32 v44, v44
    v_mfma_f32_16x16x32_bf16 v[144:147], v[220:223], v[120:123], 0
    v_exp_f32 v45, v45
    v_mfma_f32_16x16x32_bf16 v[148:151], v[224:227], v[120:123], 0
    v_exp_f32 v46, v46
    v_mfma_f32_16x16x32_bf16 v[152:155], v[228:231], v[120:123], 0
    v_exp_f32 v47, v47
    ds_read_b128 v[24:27], v240 offset:768
    ds_read_b128 v[28:31], v240 offset:832
    ds_read_b128 v[96:99], v240 offset:768
    ds_read_b128 v[100:103], v240 offset:832
    ds_read_b64_tr_b16 v[184:185], v232 offset:12352
    ds_read_b64_tr_b16 v[186:187], v232 offset:13376
    ds_read_b64_tr_b16 v[188:189], v232 offset:14400
    ds_read_b64_tr_b16 v[190:191], v232 offset:15424
    ds_read_b64_tr_b16 v[192:193], v232 offset:16448
    ds_read_b64_tr_b16 v[194:195], v232 offset:17472
    ds_read_b64_tr_b16 v[196:197], v237 offset:12352
    ds_read_b64_tr_b16 v[198:199], v237 offset:13376
    ds_read_b64_tr_b16 v[200:201], v237 offset:14400
    ds_read_b64_tr_b16 v[202:203], v237 offset:15424
    ds_read_b64_tr_b16 v[204:205], v237 offset:16448
    ds_read_b64_tr_b16 v[206:207], v237 offset:17472
    ds_read_b64_tr_b16 v[208:209], v233 offset:37056
    ds_read_b64_tr_b16 v[210:211], v233 offset:40160
    ds_read_b64_tr_b16 v[212:213], v233 offset:37064
    ds_read_b64_tr_b16 v[214:215], v233 offset:40168
    ds_read_b64_tr_b16 v[216:217], v233 offset:37120
    ds_read_b64_tr_b16 v[218:219], v233 offset:40224
    ds_read_b64_tr_b16 v[220:221], v233 offset:37128
    ds_read_b64_tr_b16 v[222:223], v233 offset:40232
    ds_read_b64_tr_b16 v[224:225], v233 offset:37184
    ds_read_b64_tr_b16 v[226:227], v233 offset:40288
    ds_read_b64_tr_b16 v[228:229], v233 offset:37192
    ds_read_b64_tr_b16 v[230:231], v233 offset:40296
    s_waitcnt vmcnt(0)
    v_mov_b32 v4, 6
    ds_write_b32 v244, v4
    s_mov_b32 exec_hi, 0xffff
    s_add_u32 m0, s57, 135872
    s_movk_i32 s59, 704
    buffer_load_dwordx4 v236, s[28:31], s59 offen lds
    s_add_u32 m0, s58, 98816
    s_mov_b32 s59, 49152
    buffer_load_dwordx4 v242, s[32:35], s59 offen lds
    s_mov_b32 exec_hi, -1
    buffer_load_dwordx4 v[248:251], v1, s[96:99], 0 offen offset:2048
    buffer_load_dwordx4 v[252:255], v1, s[96:99], 0 offen offset:3072
    v_pk_mul_f32 v[32:33], v[32:33], v[48:49]
    v_pk_mul_f32 v[34:35], v[34:35], v[50:51]
    v_pk_mul_f32 v[36:37], v[36:37], v[52:53]
    v_pk_mul_f32 v[38:39], v[38:39], v[54:55]
    v_pk_add_f32 v[40:41], v[40:41], s[62:63]
    v_pk_add_f32 v[42:43], v[42:43], s[62:63]
    v_pk_add_f32 v[44:45], v[44:45], s[62:63]
    v_pk_add_f32 v[46:47], v[46:47], s[62:63]
    v_pk_fma_f32 v[48:49], v[16:17], v[16:17], s[60:61]
    v_pk_fma_f32 v[50:51], v[18:19], v[18:19], s[60:61]
    v_pk_fma_f32 v[52:53], v[20:21], v[20:21], s[60:61]
    v_pk_fma_f32 v[54:55], v[22:23], v[22:23], s[60:61]
    v_pk_mul_f32 v[48:49], v[16:17], v[48:49] neg_lo:[1,0] neg_hi:[1,0]
    v_pk_mul_f32 v[50:51], v[18:19], v[50:51] neg_lo:[1,0] neg_hi:[1,0]
    v_pk_mul_f32 v[52:53], v[20:21], v[52:53] neg_lo:[1,0] neg_hi:[1,0]
    v_pk_mul_f32 v[54:55], v[22:23], v[54:55] neg_lo:[1,0] neg_hi:[1,0]
    v_rcp_f32 v40, v40
    s_waitcnt lgkmcnt(13)
    v_mfma_f32_16x16x32_bf16 v[24:27], v[184:187], v[84:87], v[24:27]
    v_cvt_pk_bf16_f32 v56, v32, v33
    v_cvt_pk_bf16_f32 v57, v34, v35
    v_mfma_f32_16x16x32_bf16 v[24:27], v[188:191], v[88:91], v[24:27]
    v_rcp_f32 v41, v41
    v_mfma_f32_16x16x32_bf16 v[24:27], v[192:195], v[92:95], v[24:27]
    v_cvt_pk_bf16_f32 v58, v36, v37
    v_cvt_pk_bf16_f32 v59, v38, v39
    v_mfma_f32_16x16x32_bf16 v[28:31], v[196:199], v[84:87], v[28:31]
    v_rcp_f32 v42, v42
    v_mfma_f32_16x16x32_bf16 v[28:31], v[200:203], v[88:91], v[28:31]
    v_rcp_f32 v43, v43
    v_mfma_f32_16x16x32_bf16 v[28:31], v[204:207], v[92:95], v[28:31]
    v_rcp_f32 v44, v44
    v_mfma_f32_16x16x32_bf16 v[96:99], v[184:187], v[156:159], v[96:99]
    v_rcp_f32 v45, v45
    v_mfma_f32_16x16x32_bf16 v[96:99], v[188:191], v[160:163], v[96:99]
    v_rcp_f32 v46, v46
    v_mfma_f32_16x16x32_bf16 v[96:99], v[192:195], v[164:167], v[96:99]
    v_rcp_f32 v47, v47
    v_mfma_f32_16x16x32_bf16 v[100:103], v[196:199], v[156:159], v[100:103]
    v_mfma_f32_16x16x32_bf16 v[100:103], v[200:203], v[160:163], v[100:103]
    v_exp_f32 v48, v48
    v_mfma_f32_16x16x32_bf16 v[100:103], v[204:207], v[164:167], v[100:103]
    v_exp_f32 v49, v49
    s_waitcnt lgkmcnt(0)
    v_mfma_f32_16x16x32_bf16 v[60:63], v[208:211], v[56:59], v[60:63]
    v_exp_f32 v50, v50
    v_mfma_f32_16x16x32_bf16 v[64:67], v[212:215], v[56:59], v[64:67]
    v_exp_f32 v51, v51
    v_mfma_f32_16x16x32_bf16 v[68:71], v[216:219], v[56:59], v[68:71]
    v_exp_f32 v52, v52
    v_mfma_f32_16x16x32_bf16 v[72:75], v[220:223], v[56:59], v[72:75]
    v_exp_f32 v53, v53
    v_mfma_f32_16x16x32_bf16 v[76:79], v[224:227], v[56:59], v[76:79]
    v_exp_f32 v54, v54
    v_mfma_f32_16x16x32_bf16 v[80:83], v[228:231], v[56:59], v[80:83]
    v_exp_f32 v55, v55
    ds_read_b128 v[32:35], v240 offset:896
    ds_read_b128 v[36:39], v240 offset:960
    ds_read_b64_tr_b16 v[184:185], v232 offset:24704
    ds_read_b64_tr_b16 v[186:187], v232 offset:25728
    ds_read_b64_tr_b16 v[188:189], v232 offset:26752
    ds_read_b64_tr_b16 v[190:191], v232 offset:27776
    ds_read_b64_tr_b16 v[192:193], v232 offset:28800
    ds_read_b64_tr_b16 v[194:195], v232 offset:29824
    ds_read_b64_tr_b16 v[196:197], v237 offset:24704
    ds_read_b64_tr_b16 v[198:199], v237 offset:25728
    ds_read_b64_tr_b16 v[200:201], v237 offset:26752
    ds_read_b64_tr_b16 v[202:203], v237 offset:27776
    ds_read_b64_tr_b16 v[204:205], v237 offset:28800
    ds_read_b64_tr_b16 v[206:207], v237 offset:29824
    ds_read_b64_tr_b16 v[208:209], v233 offset:49408
    ds_read_b64_tr_b16 v[210:211], v233 offset:52512
    ds_read_b64_tr_b16 v[212:213], v233 offset:49416
    ds_read_b64_tr_b16 v[214:215], v233 offset:52520
    ds_read_b64_tr_b16 v[216:217], v233 offset:49472
    ds_read_b64_tr_b16 v[218:219], v233 offset:52576
    ds_read_b64_tr_b16 v[220:221], v233 offset:49480
    ds_read_b64_tr_b16 v[222:223], v233 offset:52584
    ds_read_b64_tr_b16 v[224:225], v233 offset:49536
    ds_read_b64_tr_b16 v[226:227], v233 offset:52640
    ds_read_b64_tr_b16 v[228:229], v233 offset:49544
    ds_read_b64_tr_b16 v[230:231], v233 offset:52648
    ds_read_b32 v5, v245
    s_mov_b32 exec_hi, 0xffff
    s_add_u32 m0, s58, 111168
    s_mov_b32 s59, 55296
    buffer_load_dwordx4 v242, s[32:35], s59 offen lds
    s_add_u32 m0, s58, 123520
    s_mov_b32 s59, 61440
    buffer_load_dwordx4 v242, s[32:35], s59 offen lds
    s_mov_b32 exec_hi, -1
    s_nop 0
    v_pk_mul_f32 v[8:9], v[8:9], v[40:41]
    v_pk_mul_f32 v[10:11], v[10:11], v[42:43]
    v_pk_mul_f32 v[12:13], v[12:13], v[44:45]
    v_pk_mul_f32 v[14:15], v[14:15], v[46:47]
    v_pk_add_f32 v[48:49], v[48:49], s[62:63]
    v_pk_add_f32 v[50:51], v[50:51], s[62:63]
    v_pk_add_f32 v[52:53], v[52:53], s[62:63]
    v_pk_add_f32 v[54:55], v[54:55], s[62:63]
    v_pk_fma_f32 v[40:41], v[24:25], v[24:25], s[60:61]
    v_pk_fma_f32 v[42:43], v[26:27], v[26:27], s[60:61]
    v_pk_fma_f32 v[44:45], v[28:29], v[28:29], s[60:61]
    v_pk_fma_f32 v[46:47], v[30:31], v[30:31], s[60:61]
    v_pk_mul_f32 v[40:41], v[24:25], v[40:41] neg_lo:[1,0] neg_hi:[1,0]
    v_pk_mul_f32 v[42:43], v[26:27], v[42:43] neg_lo:[1,0] neg_hi:[1,0]
    v_pk_mul_f32 v[44:45], v[28:29], v[44:45] neg_lo:[1,0] neg_hi:[1,0]
    v_pk_mul_f32 v[46:47], v[30:31], v[46:47] neg_lo:[1,0] neg_hi:[1,0]
    v_pk_fma_f32 v[112:113], v[96:97], v[96:97], s[60:61]
    v_pk_fma_f32 v[114:115], v[98:99], v[98:99], s[60:61]
    v_pk_fma_f32 v[116:117], v[100:101], v[100:101], s[60:61]
    v_pk_fma_f32 v[118:119], v[102:103], v[102:103], s[60:61]
    v_pk_mul_f32 v[112:113], v[96:97], v[112:113] neg_lo:[1,0] neg_hi:[1,0]
    v_pk_mul_f32 v[114:115], v[98:99], v[114:115] neg_lo:[1,0] neg_hi:[1,0]
    v_pk_mul_f32 v[116:117], v[100:101], v[116:117] neg_lo:[1,0] neg_hi:[1,0]
    v_pk_mul_f32 v[118:119], v[102:103], v[118:119] neg_lo:[1,0] neg_hi:[1,0]
    v_rcp_f32 v48, v48
    s_waitcnt lgkmcnt(13)
    v_mfma_f32_16x16x32_bf16 v[32:35], v[184:187], v[84:87], v[32:35]
    v_cvt_pk_bf16_f32 v56, v8, v9
    v_cvt_pk_bf16_f32 v57, v10, v11
    v_rcp_f32 v49, v49
    v_mfma_f32_16x16x32_bf16 v[32:35], v[188:191], v[88:91], v[32:35]
    v_cvt_pk_bf16_f32 v58, v12, v13
    v_cvt_pk_bf16_f32 v59, v14, v15
    v_rcp_f32 v50, v50
    v_mfma_f32_16x16x32_bf16 v[32:35], v[192:195], v[92:95], v[32:35]
    v_rcp_f32 v51, v51
    v_rcp_f32 v52, v52
    v_mfma_f32_16x16x32_bf16 v[36:39], v[196:199], v[84:87], v[36:39]
    v_rcp_f32 v53, v53
    v_rcp_f32 v54, v54
    v_mfma_f32_16x16x32_bf16 v[36:39], v[200:203], v[88:91], v[36:39]
    v_rcp_f32 v55, v55
    v_exp_f32 v40, v40
    v_mfma_f32_16x16x32_bf16 v[36:39], v[204:207], v[92:95], v[36:39]
    v_exp_f32 v41, v41
    v_exp_f32 v42, v42
    v_exp_f32 v43, v43
    s_waitcnt lgkmcnt(0)
    v_mfma_f32_16x16x32_bf16 v[60:63], v[208:211], v[56:59], v[60:63]
    v_exp_f32 v44, v44
    v_exp_f32 v45, v45
    v_mfma_f32_16x16x32_bf16 v[64:67], v[212:215], v[56:59], v[64:67]
    v_exp_f32 v46, v46
    v_exp_f32 v47, v47
    v_mfma_f32_16x16x32_bf16 v[68:71], v[216:219], v[56:59], v[68:71]
    v_exp_f32 v112, v112
    v_exp_f32 v113, v113
    v_mfma_f32_16x16x32_bf16 v[72:75], v[220:223], v[56:59], v[72:75]
    v_exp_f32 v114, v114
    v_exp_f32 v115, v115
    v_mfma_f32_16x16x32_bf16 v[76:79], v[224:227], v[56:59], v[76:79]
    v_exp_f32 v116, v116
    v_exp_f32 v117, v117
    v_mfma_f32_16x16x32_bf16 v[80:83], v[228:231], v[56:59], v[80:83]
    v_exp_f32 v118, v118
    v_exp_f32 v119, v119
    v_cmp_le_u32 vcc, 6, v5
    s_cmp_eq_u64 vcc, -1
    s_cbranch_scc1 L_gate_N2_6_ok
L_gate_N2_6:
    ds_read_b32 v5, v245
    s_waitcnt lgkmcnt(0)
    v_cmp_le_u32 vcc, 6, v5
    s_cmp_eq_u64 vcc, -1
    s_cbranch_scc0 L_gate_N2_6
L_gate_N2_6_ok:
    s_nop 0
    ds_read_b128 v[8:11], v240 offset:1024
    ds_read_b128 v[12:15], v240 offset:1088
    ds_read_b64_tr_b16 v[184:185], v232 offset:37056
    ds_read_b64_tr_b16 v[186:187], v232 offset:38080
    ds_read_b64_tr_b16 v[188:189], v232 offset:39104
    ds_read_b64_tr_b16 v[190:191], v232 offset:40128
    ds_read_b64_tr_b16 v[192:193], v232 offset:41152
    ds_read_b64_tr_b16 v[194:195], v232 offset:42176
    ds_read_b64_tr_b16 v[196:197], v237 offset:37056
    ds_read_b64_tr_b16 v[198:199], v237 offset:38080
    ds_read_b64_tr_b16 v[200:201], v237 offset:39104
    ds_read_b64_tr_b16 v[202:203], v237 offset:40128
    ds_read_b64_tr_b16 v[204:205], v237 offset:41152
    ds_read_b64_tr_b16 v[206:207], v237 offset:42176
    v_add_u32 v233, 61760, v233
    ds_read_b64_tr_b16 v[208:209], v233 offset:0
    ds_read_b64_tr_b16 v[210:211], v233 offset:3104
    ds_read_b64_tr_b16 v[212:213], v233 offset:8
    ds_read_b64_tr_b16 v[214:215], v233 offset:3112
    ds_read_b64_tr_b16 v[216:217], v233 offset:64
    ds_read_b64_tr_b16 v[218:219], v233 offset:3168
    ds_read_b64_tr_b16 v[220:221], v233 offset:72
    ds_read_b64_tr_b16 v[222:223], v233 offset:3176
    ds_read_b64_tr_b16 v[224:225], v233 offset:128
    ds_read_b64_tr_b16 v[226:227], v233 offset:3232
    ds_read_b64_tr_b16 v[228:229], v233 offset:136
    ds_read_b64_tr_b16 v[230:231], v233 offset:3240
    s_mov_b32 exec_hi, 0xffff
    s_add_u32 m0, s58, 135872
    s_mov_b32 s59, 67584
    buffer_load_dwordx4 v242, s[32:35], s59 offen lds
    s_mov_b32 exec_hi, -1
    s_nop 0
    v_pk_mul_f32 v[16:17], v[16:17], v[48:49]
    v_pk_mul_f32 v[18:19], v[18:19], v[50:51]
    v_pk_mul_f32 v[20:21], v[20:21], v[52:53]
    v_pk_mul_f32 v[22:23], v[22:23], v[54:55]
    v_pk_add_f32 v[40:41], v[40:41], s[62:63]
    v_pk_add_f32 v[42:43], v[42:43], s[62:63]
    v_pk_add_f32 v[44:45], v[44:45], s[62:63]
    v_pk_add_f32 v[46:47], v[46:47], s[62:63]
    v_pk_add_f32 v[112:113], v[112:113], s[62:63]
    v_pk_add_f32 v[114:115], v[114:115], s[62:63]
    v_pk_add_f32 v[116:117], v[116:117], s[62:63]
    v_pk_add_f32 v[118:119], v[118:119], s[62:63]
    v_pk_fma_f32 v[48:49], v[32:33], v[32:33], s[60:61]
    v_pk_fma_f32 v[50:51], v[34:35], v[34:35], s[60:61]
    v_pk_fma_f32 v[52:53], v[36:37], v[36:37], s[60:61]
    v_pk_fma_f32 v[54:55], v[38:39], v[38:39], s[60:61]
    v_pk_mul_f32 v[48:49], v[32:33], v[48:49] neg_lo:[1,0] neg_hi:[1,0]
    v_pk_mul_f32 v[50:51], v[34:35], v[50:51] neg_lo:[1,0] neg_hi:[1,0]
    v_pk_mul_f32 v[52:53], v[36:37], v[52:53] neg_lo:[1,0] neg_hi:[1,0]
    v_pk_mul_f32 v[54:55], v[38:39], v[54:55] neg_lo:[1,0] neg_hi:[1,0]
    v_rcp_f32 v40, v40
    s_waitcnt lgkmcnt(12)
    v_mfma_f32_16x16x32_bf16 v[8:11], v[184:187], v[84:87], v[8:11]
    v_cvt_pk_bf16_f32 v56, v16, v17
    v_cvt_pk_bf16_f32 v57, v18, v19
    v_rcp_f32 v41, v41
    v_mfma_f32_16x16x32_bf16 v[8:11], v[188:191], v[88:91], v[8:11]
    v_cvt_pk_bf16_f32 v58, v20, v21
    v_cvt_pk_bf16_f32 v59, v22, v23
    v_rcp_f32 v42, v42
    v_mfma_f32_16x16x32_bf16 v[8:11], v[192:195], v[92:95], v[8:11]
    v_rcp_f32 v43, v43
    v_rcp_f32 v44, v44
    v_mfma_f32_16x16x32_bf16 v[12:15], v[196:199], v[84:87], v[12:15]
    v_rcp_f32 v45, v45
    v_rcp_f32 v46, v46
    v_mfma_f32_16x16x32_bf16 v[12:15], v[200:203], v[88:91], v[12:15]
    v_rcp_f32 v47, v47
    v_exp_f32 v48, v48
    v_mfma_f32_16x16x32_bf16 v[12:15], v[204:207], v[92:95], v[12:15]
    v_exp_f32 v49, v49
    v_exp_f32 v50, v50
    v_exp_f32 v51, v51
    s_waitcnt lgkmcnt(0)
    v_mfma_f32_16x16x32_bf16 v[60:63], v[208:211], v[56:59], v[60:63]
    v_exp_f32 v52, v52
    v_exp_f32 v53, v53
    v_mfma_f32_16x16x32_bf16 v[64:67], v[212:215], v[56:59], v[64:67]
    v_exp_f32 v54, v54
    v_exp_f32 v55, v55
    v_mfma_f32_16x16x32_bf16 v[68:71], v[216:219], v[56:59], v[68:71]
    v_rcp_f32 v112, v112
    v_rcp_f32 v113, v113
    v_mfma_f32_16x16x32_bf16 v[72:75], v[220:223], v[56:59], v[72:75]
    v_rcp_f32 v114, v114
    v_rcp_f32 v115, v115
    v_mfma_f32_16x16x32_bf16 v[76:79], v[224:227], v[56:59], v[76:79]
    v_rcp_f32 v116, v116
    v_rcp_f32 v117, v117
    v_mfma_f32_16x16x32_bf16 v[80:83], v[228:231], v[56:59], v[80:83]
    v_rcp_f32 v118, v118
    v_rcp_f32 v119, v119
    ds_read_b128 v[16:19], v240 offset:1152
    ds_read_b128 v[20:23], v240 offset:1216
    ds_read_b64_tr_b16 v[184:185], v232 offset:49408
    ds_read_b64_tr_b16 v[186:187], v232 offset:50432
    ds_read_b64_tr_b16 v[188:189], v232 offset:51456
    ds_read_b64_tr_b16 v[190:191], v232 offset:52480
    ds_read_b64_tr_b16 v[192:193], v232 offset:53504
    ds_read_b64_tr_b16 v[194:195], v232 offset:54528
    ds_read_b64_tr_b16 v[196:197], v237 offset:49408
    ds_read_b64_tr_b16 v[198:199], v237 offset:50432
    ds_read_b64_tr_b16 v[200:201], v237 offset:51456
    ds_read_b64_tr_b16 v[202:203], v237 offset:52480
    ds_read_b64_tr_b16 v[204:205], v237 offset:53504
    ds_read_b64_tr_b16 v[206:207], v237 offset:54528
    ds_read_b64_tr_b16 v[208:209], v233 offset:12352
    ds_read_b64_tr_b16 v[210:211], v233 offset:15456
    ds_read_b64_tr_b16 v[212:213], v233 offset:12360
    ds_read_b64_tr_b16 v[214:215], v233 offset:15464
    ds_read_b64_tr_b16 v[216:217], v233 offset:12416
    ds_read_b64_tr_b16 v[218:219], v233 offset:15520
    ds_read_b64_tr_b16 v[220:221], v233 offset:12424
    ds_read_b64_tr_b16 v[222:223], v233 offset:15528
    ds_read_b64_tr_b16 v[224:225], v233 offset:12480
    ds_read_b64_tr_b16 v[226:227], v233 offset:15584
    ds_read_b64_tr_b16 v[228:229], v233 offset:12488
    ds_read_b64_tr_b16 v[230:231], v233 offset:15592
    s_waitcnt vmcnt(0)
    v_mov_b32 v4, 7
    ds_write_b32 v244, v4
    v_pk_mul_f32 v[24:25], v[24:25], v[40:41]
    v_pk_mul_f32 v[26:27], v[26:27], v[42:43]
    v_pk_mul_f32 v[28:29], v[28:29], v[44:45]
    v_pk_mul_f32 v[30:31], v[30:31], v[46:47]
    v_pk_add_f32 v[48:49], v[48:49], s[62:63]
    v_pk_add_f32 v[50:51], v[50:51], s[62:63]
    v_pk_add_f32 v[52:53], v[52:53], s[62:63]
    v_pk_add_f32 v[54:55], v[54:55], s[62:63]
    v_pk_mul_f32 v[96:97], v[96:97], v[112:113]
    v_pk_mul_f32 v[98:99], v[98:99], v[114:115]
    v_pk_mul_f32 v[100:101], v[100:101], v[116:117]
    v_pk_mul_f32 v[102:103], v[102:103], v[118:119]
    v_pk_fma_f32 v[40:41], v[8:9], v[8:9], s[60:61]
    v_pk_fma_f32 v[42:43], v[10:11], v[10:11], s[60:61]
    v_pk_fma_f32 v[44:45], v[12:13], v[12:13], s[60:61]
    v_pk_fma_f32 v[46:47], v[14:15], v[14:15], s[60:61]
    v_pk_mul_f32 v[40:41], v[8:9], v[40:41] neg_lo:[1,0] neg_hi:[1,0]
    v_pk_mul_f32 v[42:43], v[10:11], v[42:43] neg_lo:[1,0] neg_hi:[1,0]
    v_pk_mul_f32 v[44:45], v[12:13], v[44:45] neg_lo:[1,0] neg_hi:[1,0]
    v_pk_mul_f32 v[46:47], v[14:15], v[46:47] neg_lo:[1,0] neg_hi:[1,0]
    v_rcp_f32 v48, v48
    s_waitcnt lgkmcnt(13)
    v_mfma_f32_16x16x32_bf16 v[16:19], v[184:187], v[84:87], v[16:19]
    v_cvt_pk_bf16_f32 v56, v24, v25
    v_cvt_pk_bf16_f32 v57, v26, v27
    v_mfma_f32_16x16x32_bf16 v[16:19], v[188:191], v[88:91], v[16:19]
    v_rcp_f32 v49, v49
    v_mfma_f32_16x16x32_bf16 v[16:19], v[192:195], v[92:95], v[16:19]
    v_cvt_pk_bf16_f32 v58, v28, v29
    v_cvt_pk_bf16_f32 v59, v30, v31
    v_mfma_f32_16x16x32_bf16 v[20:23], v[196:199], v[84:87], v[20:23]
    v_rcp_f32 v50, v50
    v_mfma_f32_16x16x32_bf16 v[20:23], v[200:203], v[88:91], v[20:23]
    v_cvt_pk_bf16_f32 v120, v96, v97
    v_cvt_pk_bf16_f32 v121, v98, v99
    v_mfma_f32_16x16x32_bf16 v[20:23], v[204:207], v[92:95], v[20:23]
    v_rcp_f32 v51, v51
    v_cvt_pk_bf16_f32 v122, v100, v101
    s_waitcnt lgkmcnt(0)
    v_mfma_f32_16x16x32_bf16 v[60:63], v[208:211], v[56:59], v[60:63]
    v_cvt_pk_bf16_f32 v123, v102, v103
    v_mfma_f32_16x16x32_bf16 v[64:67], v[212:215], v[56:59], v[64:67]
    v_rcp_f32 v52, v52
    v_mfma_f32_16x16x32_bf16 v[68:71], v[216:219], v[56:59], v[68:71]
    v_rcp_f32 v53, v53
    v_rcp_f32 v54, v54
    v_mfma_f32_16x16x32_bf16 v[72:75], v[220:223], v[56:59], v[72:75]
    v_rcp_f32 v55, v55
    v_mfma_f32_16x16x32_bf16 v[76:79], v[224:227], v[56:59], v[76:79]
    v_exp_f32 v40, v40
    v_mfma_f32_16x16x32_bf16 v[80:83], v[228:231], v[56:59], v[80:83]
    v_exp_f32 v41, v41
    v_mfma_f32_16x16x32_bf16 v[132:135], v[208:211], v[120:123], v[132:135]
    v_exp_f32 v42, v42
    v_mfma_f32_16x16x32_bf16 v[136:139], v[212:215], v[120:123], v[136:139]
    v_exp_f32 v43, v43
    v_mfma_f32_16x16x32_bf16 v[140:143], v[216:219], v[120:123], v[140:143]
    v_exp_f32 v44, v44
    v_mfma_f32_16x16x32_bf16 v[144:147], v[220:223], v[120:123], v[144:147]
    v_exp_f32 v45, v45
    v_mfma_f32_16x16x32_bf16 v[148:151], v[224:227], v[120:123], v[148:151]
    v_exp_f32 v46, v46
    v_mfma_f32_16x16x32_bf16 v[152:155], v[228:231], v[120:123], v[152:155]
    v_exp_f32 v47, v47
    v_add_u32 v232, 61760, v232
    v_add_u32 v237, 61760, v237
    ds_read_b128 v[24:27], v240 offset:1280
    ds_read_b128 v[28:31], v240 offset:1344
    ds_read_b128 v[96:99], v240 offset:1280
    ds_read_b128 v[100:103], v240 offset:1344
    ds_read_b64_tr_b16 v[184:185], v232 offset:0
    ds_read_b64_tr_b16 v[186:187], v232 offset:1024
    ds_read_b64_tr_b16 v[188:189], v232 offset:2048
    ds_read_b64_tr_b16 v[190:191], v232 offset:3072
    ds_read_b64_tr_b16 v[192:193], v232 offset:4096
    ds_read_b64_tr_b16 v[194:195], v232 offset:5120
    ds_read_b64_tr_b16 v[196:197], v237 offset:0
    ds_read_b64_tr_b16 v[198:199], v237 offset:1024
    ds_read_b64_tr_b16 v[200:201], v237 offset:2048
    ds_read_b64_tr_b16 v[202:203], v237 offset:3072
    ds_read_b64_tr_b16 v[204:205], v237 offset:4096
    ds_read_b64_tr_b16 v[206:207], v237 offset:5120
    ds_read_b64_tr_b16 v[208:209], v233 offset:24704
    ds_read_b64_tr_b16 v[210:211], v233 offset:27808
    ds_read_b64_tr_b16 v[212:213], v233 offset:24712
    ds_read_b64_tr_b16 v[214:215], v233 offset:27816
    ds_read_b64_tr_b16 v[216:217], v233 offset:24768
    ds_read_b64_tr_b16 v[218:219], v233 offset:27872
    ds_read_b64_tr_b16 v[220:221], v233 offset:24776
    ds_read_b64_tr_b16 v[222:223], v233 offset:27880
    ds_read_b64_tr_b16 v[224:225], v233 offset:24832
    ds_read_b64_tr_b16 v[226:227], v233 offset:27936
    ds_read_b64_tr_b16 v[228:229], v233 offset:24840
    ds_read_b64_tr_b16 v[230:231], v233 offset:27944
    ds_read_b32 v5, v245
    v_pk_mul_f32 v[32:33], v[32:33], v[48:49]
    v_pk_mul_f32 v[34:35], v[34:35], v[50:51]
    v_pk_mul_f32 v[36:37], v[36:37], v[52:53]
    v_pk_mul_f32 v[38:39], v[38:39], v[54:55]
    v_pk_add_f32 v[40:41], v[40:41], s[62:63]
    v_pk_add_f32 v[42:43], v[42:43], s[62:63]
    v_pk_add_f32 v[44:45], v[44:45], s[62:63]
    v_pk_add_f32 v[46:47], v[46:47], s[62:63]
    v_pk_fma_f32 v[48:49], v[16:17], v[16:17], s[60:61]
    v_pk_fma_f32 v[50:51], v[18:19], v[18:19], s[60:61]
    v_pk_fma_f32 v[52:53], v[20:21], v[20:21], s[60:61]
    v_pk_fma_f32 v[54:55], v[22:23], v[22:23], s[60:61]
    v_pk_mul_f32 v[48:49], v[16:17], v[48:49] neg_lo:[1,0] neg_hi:[1,0]
    v_pk_mul_f32 v[50:51], v[18:19], v[50:51] neg_lo:[1,0] neg_hi:[1,0]
    v_pk_mul_f32 v[52:53], v[20:21], v[52:53] neg_lo:[1,0] neg_hi:[1,0]
    v_pk_mul_f32 v[54:55], v[22:23], v[54:55] neg_lo:[1,0] neg_hi:[1,0]
    v_rcp_f32 v40, v40
    s_waitcnt lgkmcnt(13)
    v_mfma_f32_16x16x32_bf16 v[24:27], v[184:187], v[84:87], v[24:27]
    v_cvt_pk_bf16_f32 v56, v32, v33
    v_cvt_pk_bf16_f32 v57, v34, v35
    v_mfma_f32_16x16x32_bf16 v[24:27], v[188:191], v[88:91], v[24:27]
    v_rcp_f32 v41, v41
    v_mfma_f32_16x16x32_bf16 v[24:27], v[192:195], v[92:95], v[24:27]
    v_cvt_pk_bf16_f32 v58, v36, v37
    v_cvt_pk_bf16_f32 v59, v38, v39
    v_mfma_f32_16x16x32_bf16 v[28:31], v[196:199], v[84:87], v[28:31]
    v_rcp_f32 v42, v42
    v_mfma_f32_16x16x32_bf16 v[28:31], v[200:203], v[88:91], v[28:31]
    v_rcp_f32 v43, v43
    v_mfma_f32_16x16x32_bf16 v[28:31], v[204:207], v[92:95], v[28:31]
    v_rcp_f32 v44, v44
    v_mfma_f32_16x16x32_bf16 v[96:99], v[184:187], v[156:159], v[96:99]
    v_rcp_f32 v45, v45
    v_mfma_f32_16x16x32_bf16 v[96:99], v[188:191], v[160:163], v[96:99]
    v_rcp_f32 v46, v46
    v_mfma_f32_16x16x32_bf16 v[96:99], v[192:195], v[164:167], v[96:99]
    v_rcp_f32 v47, v47
    v_mfma_f32_16x16x32_bf16 v[100:103], v[196:199], v[156:159], v[100:103]
    v_mfma_f32_16x16x32_bf16 v[100:103], v[200:203], v[160:163], v[100:103]
    v_exp_f32 v48, v48
    v_mfma_f32_16x16x32_bf16 v[100:103], v[204:207], v[164:167], v[100:103]
    v_exp_f32 v49, v49
    s_waitcnt lgkmcnt(0)
    v_mfma_f32_16x16x32_bf16 v[60:63], v[208:211], v[56:59], v[60:63]
    v_exp_f32 v50, v50
    v_mfma_f32_16x16x32_bf16 v[64:67], v[212:215], v[56:59], v[64:67]
    v_exp_f32 v51, v51
    v_mfma_f32_16x16x32_bf16 v[68:71], v[216:219], v[56:59], v[68:71]
    v_exp_f32 v52, v52
    v_mfma_f32_16x16x32_bf16 v[72:75], v[220:223], v[56:59], v[72:75]
    v_exp_f32 v53, v53
    v_mfma_f32_16x16x32_bf16 v[76:79], v[224:227], v[56:59], v[76:79]
    v_exp_f32 v54, v54
    v_mfma_f32_16x16x32_bf16 v[80:83], v[228:231], v[56:59], v[80:83]
    v_exp_f32 v55, v55
    v_cmp_le_u32 vcc, 7, v5
    s_cmp_eq_u64 vcc, -1
    s_cbranch_scc1 L_gate_N2_9_ok
L_gate_N2_9:
    ds_read_b32 v5, v245
    s_waitcnt lgkmcnt(0)
    v_cmp_le_u32 vcc, 7, v5
    s_cmp_eq_u64 vcc, -1
    s_cbranch_scc0 L_gate_N2_9
L_gate_N2_9_ok:
    s_nop 0
    ds_read_b128 v[32:35], v240 offset:1408
    ds_read_b128 v[36:39], v240 offset:1472
    ds_read_b64_tr_b16 v[184:185], v232 offset:12352
    ds_read_b64_tr_b16 v[186:187], v232 offset:13376
    ds_read_b64_tr_b16 v[188:189], v232 offset:14400
    ds_read_b64_tr_b16 v[190:191], v232 offset:15424
    ds_read_b64_tr_b16 v[192:193], v232 offset:16448
    ds_read_b64_tr_b16 v[194:195], v232 offset:17472
    ds_read_b64_tr_b16 v[196:197], v237 offset:12352
    ds_read_b64_tr_b16 v[198:199], v237 offset:13376
    ds_read_b64_tr_b16 v[200:201], v237 offset:14400
    ds_read_b64_tr_b16 v[202:203], v237 offset:15424
    ds_read_b64_tr_b16 v[204:205], v237 offset:16448
    ds_read_b64_tr_b16 v[206:207], v237 offset:17472
    ds_read_b64_tr_b16 v[208:209], v233 offset:37056
    ds_read_b64_tr_b16 v[210:211], v233 offset:40160
    ds_read_b64_tr_b16 v[212:213], v233 offset:37064
    ds_read_b64_tr_b16 v[214:215], v233 offset:40168
    ds_read_b64_tr_b16 v[216:217], v233 offset:37120
    ds_read_b64_tr_b16 v[218:219], v233 offset:40224
    ds_read_b64_tr_b16 v[220:221], v233 offset:37128
    ds_read_b64_tr_b16 v[222:223], v233 offset:40232
    ds_read_b64_tr_b16 v[224:225], v233 offset:37184
    ds_read_b64_tr_b16 v[226:227], v233 offset:40288
    ds_read_b64_tr_b16 v[228:229], v233 offset:37192
    ds_read_b64_tr_b16 v[230:231], v233 offset:40296
    v_pk_mul_f32 v[8:9], v[8:9], v[40:41]
    v_pk_mul_f32 v[10:11], v[10:11], v[42:43]
    v_pk_mul_f32 v[12:13], v[12:13], v[44:45]
    v_pk_mul_f32 v[14:15], v[14:15], v[46:47]
    v_pk_add_f32 v[48:49], v[48:49], s[62:63]
    v_pk_add_f32 v[50:51], v[50:51], s[62:63]
    v_pk_add_f32 v[52:53], v[52:53], s[62:63]
    v_pk_add_f32 v[54:55], v[54:55], s[62:63]
    v_pk_fma_f32 v[40:41], v[24:25], v[24:25], s[60:61]
    v_pk_fma_f32 v[42:43], v[26:27], v[26:27], s[60:61]
    v_pk_fma_f32 v[44:45], v[28:29], v[28:29], s[60:61]
    v_pk_fma_f32 v[46:47], v[30:31], v[30:31], s[60:61]
    v_pk_mul_f32 v[40:41], v[24:25], v[40:41] neg_lo:[1,0] neg_hi:[1,0]
    v_pk_mul_f32 v[42:43], v[26:27], v[42:43] neg_lo:[1,0] neg_hi:[1,0]
    v_pk_mul_f32 v[44:45], v[28:29], v[44:45] neg_lo:[1,0] neg_hi:[1,0]
    v_pk_mul_f32 v[46:47], v[30:31], v[46:47] neg_lo:[1,0] neg_hi:[1,0]
    v_pk_fma_f32 v[112:113], v[96:97], v[96:97], s[60:61]
    v_pk_fma_f32 v[114:115], v[98:99], v[98:99], s[60:61]
    v_pk_fma_f32 v[116:117], v[100:101], v[100:101], s[60:61]
    v_pk_fma_f32 v[118:119], v[102:103], v[102:103], s[60:61]
    v_pk_mul_f32 v[112:113], v[96:97], v[112:113] neg_lo:[1,0] neg_hi:[1,0]
    v_pk_mul_f32 v[114:115], v[98:99], v[114:115] neg_lo:[1,0] neg_hi:[1,0]
    v_pk_mul_f32 v[116:117], v[100:101], v[116:117] neg_lo:[1,0] neg_hi:[1,0]
    v_pk_mul_f32 v[118:119], v[102:103], v[118:119] neg_lo:[1,0] neg_hi:[1,0]
    v_rcp_f32 v48, v48
    s_waitcnt lgkmcnt(12)
    v_mfma_f32_16x16x32_bf16 v[32:35], v[184:187], v[84:87], v[32:35]
    v_cvt_pk_bf16_f32 v56, v8, v9
    v_cvt_pk_bf16_f32 v57, v10, v11
    v_rcp_f32 v49, v49
    v_mfma_f32_16x16x32_bf16 v[32:35], v[188:191], v[88:91], v[32:35]
    v_cvt_pk_bf16_f32 v58, v12, v13
    v_cvt_pk_bf16_f32 v59, v14, v15
    v_rcp_f32 v50, v50
    v_mfma_f32_16x16x32_bf16 v[32:35], v[192:195], v[92:95], v[32:35]
    v_rcp_f32 v51, v51
    v_rcp_f32 v52, v52
    v_mfma_f32_16x16x32_bf16 v[36:39], v[196:199], v[84:87], v[36:39]
    v_rcp_f32 v53, v53
    v_rcp_f32 v54, v54
    v_mfma_f32_16x16x32_bf16 v[36:39], v[200:203], v[88:91], v[36:39]
    v_rcp_f32 v55, v55
    v_exp_f32 v40, v40
    v_mfma_f32_16x16x32_bf16 v[36:39], v[204:207], v[92:95], v[36:39]
    v_exp_f32 v41, v41
    v_exp_f32 v42, v42
    v_exp_f32 v43, v43
    s_waitcnt lgkmcnt(0)
    v_mfma_f32_16x16x32_bf16 v[60:63], v[208:211], v[56:59], v[60:63]
    v_exp_f32 v44, v44
    v_exp_f32 v45, v45
    v_mfma_f32_16x16x32_bf16 v[64:67], v[212:215], v[56:59], v[64:67]
    v_exp_f32 v46, v46
    v_exp_f32 v47, v47
    v_mfma_f32_16x16x32_bf16 v[68:71], v[216:219], v[56:59], v[68:71]
    v_exp_f32 v112, v112
    v_exp_f32 v113, v113
    v_mfma_f32_16x16x32_bf16 v[72:75], v[220:223], v[56:59], v[72:75]
    v_exp_f32 v114, v114
    v_exp_f32 v115, v115
    v_mfma_f32_16x16x32_bf16 v[76:79], v[224:227], v[56:59], v[76:79]
    v_exp_f32 v116, v116
    v_exp_f32 v117, v117
    v_mfma_f32_16x16x32_bf16 v[80:83], v[228:231], v[56:59], v[80:83]
    v_exp_f32 v118, v118
    v_exp_f32 v119, v119
    ds_read_b64_tr_b16 v[208:209], v233 offset:49408
    ds_read_b64_tr_b16 v[210:211], v233 offset:52512
    ds_read_b64_tr_b16 v[212:213], v233 offset:49416
    ds_read_b64_tr_b16 v[214:215], v233 offset:52520
    ds_read_b64_tr_b16 v[216:217], v233 offset:49472
    ds_read_b64_tr_b16 v[218:219], v233 offset:52576
    ds_read_b64_tr_b16 v[220:221], v233 offset:49480
    ds_read_b64_tr_b16 v[222:223], v233 offset:52584
    ds_read_b64_tr_b16 v[224:225], v233 offset:49536
    ds_read_b64_tr_b16 v[226:227], v233 offset:52640
    ds_read_b64_tr_b16 v[228:229], v233 offset:49544
    ds_read_b64_tr_b16 v[230:231], v233 offset:52648
    buffer_load_dwordx4 v[184:187], v255, s[20:23], s55 offen offset:0
    buffer_load_dwordx4 v[188:191], v255, s[20:23], s55 offen offset:64
    buffer_load_dwordx4 v[192:195], v255, s[20:23], s55 offen offset:128
    buffer_load_dwordx4 v[196:199], v251, s[20:23], s55 offen offset:128
    s_setprio 3
    s_nop 0
    v_pk_mul_f32 v[16:17], v[16:17], v[48:49]
    v_pk_mul_f32 v[18:19], v[18:19], v[50:51]
    v_pk_mul_f32 v[20:21], v[20:21], v[52:53]
    v_pk_mul_f32 v[22:23], v[22:23], v[54:55]
    v_pk_add_f32 v[40:41], v[40:41], s[62:63]
    v_pk_add_f32 v[42:43], v[42:43], s[62:63]
    v_pk_add_f32 v[44:45], v[44:45], s[62:63]
    v_pk_add_f32 v[46:47], v[46:47], s[62:63]
    v_pk_add_f32 v[112:113], v[112:113], s[62:63]
    v_pk_add_f32 v[114:115], v[114:115], s[62:63]
    v_pk_add_f32 v[116:117], v[116:117], s[62:63]
    v_pk_add_f32 v[118:119], v[118:119], s[62:63]
    v_pk_fma_f32 v[48:49], v[32:33], v[32:33], s[60:61]
    v_pk_fma_f32 v[50:51], v[34:35], v[34:35], s[60:61]
    v_pk_fma_f32 v[52:53], v[36:37], v[36:37], s[60:61]
    v_pk_fma_f32 v[54:55], v[38:39], v[38:39], s[60:61]
    v_pk_mul_f32 v[48:49], v[32:33], v[48:49] neg_lo:[1,0] neg_hi:[1,0]
    v_pk_mul_f32 v[50:51], v[34:35], v[50:51] neg_lo:[1,0] neg_hi:[1,0]
    v_pk_mul_f32 v[52:53], v[36:37], v[52:53] neg_lo:[1,0] neg_hi:[1,0]
    v_pk_mul_f32 v[54:55], v[38:39], v[54:55] neg_lo:[1,0] neg_hi:[1,0]
    v_cvt_pk_bf16_f32 v56, v16, v17
    v_cvt_pk_bf16_f32 v57, v18, v19
    v_cvt_pk_bf16_f32 v58, v20, v21
    v_cvt_pk_bf16_f32 v59, v22, v23
    v_rcp_f32 v40, v40
    v_rcp_f32 v41, v41
    s_waitcnt lgkmcnt(0)
    v_mfma_f32_16x16x32_bf16 v[60:63], v[208:211], v[56:59], v[60:63]
    v_rcp_f32 v42, v42
    v_rcp_f32 v43, v43
    v_rcp_f32 v44, v44
    v_rcp_f32 v45, v45
    v_mfma_f32_16x16x32_bf16 v[64:67], v[212:215], v[56:59], v[64:67]
    v_rcp_f32 v46, v46
    v_rcp_f32 v47, v47
    v_exp_f32 v48, v48
    v_mfma_f32_16x16x32_bf16 v[68:71], v[216:219], v[56:59], v[68:71]
    v_exp_f32 v49, v49
    v_exp_f32 v50, v50
    v_exp_f32 v51, v51
    v_exp_f32 v52, v52
    v_mfma_f32_16x16x32_bf16 v[72:75], v[220:223], v[56:59], v[72:75]
    v_exp_f32 v53, v53
    v_exp_f32 v54, v54
    v_exp_f32 v55, v55
    v_rcp_f32 v112, v112
    v_mfma_f32_16x16x32_bf16 v[76:79], v[224:227], v[56:59], v[76:79]
    v_rcp_f32 v113, v113
    v_rcp_f32 v114, v114
    v_rcp_f32 v115, v115
    v_mfma_f32_16x16x32_bf16 v[80:83], v[228:231], v[56:59], v[80:83]
    v_rcp_f32 v116, v116
    v_rcp_f32 v117, v117
    v_rcp_f32 v118, v118
    v_rcp_f32_e64 v119, v119
    v_add_u32 v233, 61760, v233
    ds_read_b64_tr_b16 v[208:209], v233 offset:0
    ds_read_b64_tr_b16 v[210:211], v233 offset:3104
    ds_read_b64_tr_b16 v[212:213], v233 offset:8
    ds_read_b64_tr_b16 v[214:215], v233 offset:3112
    ds_read_b64_tr_b16 v[216:217], v233 offset:64
    ds_read_b64_tr_b16 v[218:219], v233 offset:3168
    ds_read_b64_tr_b16 v[220:221], v233 offset:72
    ds_read_b64_tr_b16 v[222:223], v233 offset:3176
    ds_read_b64_tr_b16 v[224:225], v233 offset:128
    ds_read_b64_tr_b16 v[226:227], v233 offset:3232
    ds_read_b64_tr_b16 v[228:229], v233 offset:136
    ds_read_b64_tr_b16 v[230:231], v233 offset:3240
    v_pk_mul_f32 v[24:25], v[24:25], v[40:41]
    v_pk_mul_f32 v[26:27], v[26:27], v[42:43]
    v_pk_mul_f32 v[28:29], v[28:29], v[44:45]
    v_pk_mul_f32 v[30:31], v[30:31], v[46:47]
    v_pk_add_f32 v[48:49], v[48:49], s[62:63]
    v_pk_add_f32 v[50:51], v[50:51], s[62:63]
    v_pk_add_f32 v[52:53], v[52:53], s[62:63]
    v_pk_add_f32 v[54:55], v[54:55], s[62:63]
    v_pk_mul_f32 v[96:97], v[96:97], v[112:113]
    v_pk_mul_f32 v[98:99], v[98:99], v[114:115]
    v_pk_mul_f32 v[100:101], v[100:101], v[116:117]
    v_pk_mul_f32 v[102:103], v[102:103], v[118:119]
    v_cvt_pk_bf16_f32 v56, v24, v25
    v_cvt_pk_bf16_f32 v57, v26, v27
    v_cvt_pk_bf16_f32 v58, v28, v29
    v_cvt_pk_bf16_f32 v59, v30, v31
    v_cvt_pk_bf16_f32 v120, v96, v97
    v_cvt_pk_bf16_f32 v121, v98, v99
    v_cvt_pk_bf16_f32 v122, v100, v101
    v_cvt_pk_bf16_f32 v123, v102, v103
    v_rcp_f32 v48, v48
    v_rcp_f32 v49, v49
    s_waitcnt lgkmcnt(0)
    v_mfma_f32_16x16x32_bf16 v[60:63], v[208:211], v[56:59], v[60:63]
    v_rcp_f32 v50, v50
    v_mfma_f32_16x16x32_bf16 v[64:67], v[212:215], v[56:59], v[64:67]
    v_mfma_f32_16x16x32_bf16 v[68:71], v[216:219], v[56:59], v[68:71]
    v_rcp_f32 v51, v51
    v_mfma_f32_16x16x32_bf16 v[72:75], v[220:223], v[56:59], v[72:75]
    v_mfma_f32_16x16x32_bf16 v[76:79], v[224:227], v[56:59], v[76:79]
    v_rcp_f32 v52, v52
    v_mfma_f32_16x16x32_bf16 v[80:83], v[228:231], v[56:59], v[80:83]
    v_mfma_f32_16x16x32_bf16 v[132:135], v[208:211], v[120:123], v[132:135]
    v_rcp_f32 v53, v53
    v_mfma_f32_16x16x32_bf16 v[136:139], v[212:215], v[120:123], v[136:139]
    v_mfma_f32_16x16x32_bf16 v[140:143], v[216:219], v[120:123], v[140:143]
    v_rcp_f32 v54, v54
    v_mfma_f32_16x16x32_bf16 v[144:147], v[220:223], v[120:123], v[144:147]
    v_mfma_f32_16x16x32_bf16 v[148:151], v[224:227], v[120:123], v[148:151]
    v_rcp_f32 v55, v55
    v_mfma_f32_16x16x32_bf16 v[152:155], v[228:231], v[120:123], v[152:155]
    s_mov_b64 exec, s[52:53]
    s_nop 2
    ds_write_b128 v238, v[132:135] offset:3072
    ds_write_b128 v238, v[136:139] offset:3328
    ds_write_b128 v238, v[140:143] offset:3584
    ds_write_b128 v238, v[144:147] offset:3840
    s_mov_b64 exec, -1
    v_mov_b32_e64 v4, 8
    ds_write_b32 v244, v4
    ds_read_b64_tr_b16 v[208:209], v233 offset:12352
    ds_read_b64_tr_b16 v[210:211], v233 offset:15456
    ds_read_b64_tr_b16 v[212:213], v233 offset:12360
    ds_read_b64_tr_b16 v[214:215], v233 offset:15464
    ds_read_b64_tr_b16 v[216:217], v233 offset:12416
    ds_read_b64_tr_b16 v[218:219], v233 offset:15520
    ds_read_b64_tr_b16 v[220:221], v233 offset:12424
    ds_read_b64_tr_b16 v[222:223], v233 offset:15528
    ds_read_b64_tr_b16 v[224:225], v233 offset:12480
    ds_read_b64_tr_b16 v[226:227], v233 offset:15584
    ds_read_b64_tr_b16 v[228:229], v233 offset:12488
    ds_read_b64_tr_b16 v[230:231], v233 offset:15592
    v_pk_mul_f32 v[32:33], v[32:33], v[48:49]
    v_pk_mul_f32 v[34:35], v[34:35], v[50:51]
    v_pk_mul_f32 v[36:37], v[36:37], v[52:53]
    v_pk_mul_f32 v[38:39], v[38:39], v[54:55]
    ds_read_b128 v[168:171], v241 offset:512
    ds_read_b128 v[172:175], v241 offset:528
    ds_read_b128 v[176:179], v241 offset:640
    ds_read_b128 v[180:183], v241 offset:656
    ds_read_b128 v[84:87], v241 offset:768
    ds_read_b128 v[88:91], v241 offset:784
    s_waitcnt vmcnt(0)
    v_cvt_pk_bf16_f32 v56, v32, v33
    v_cvt_pk_bf16_f32 v57, v34, v35
    v_cvt_pk_bf16_f32 v58, v36, v37
    v_cvt_pk_bf16_f32 v59, v38, v39
    v_lshlrev_b32 v8, 16, v184
    v_and_b32 v9, v7, v184
    s_waitcnt lgkmcnt(6)
    v_mfma_f32_16x16x32_bf16 v[60:63], v[208:211], v[56:59], v[60:63]
    v_lshlrev_b32 v10, 16, v185
    v_and_b32 v11, v7, v185
    v_lshlrev_b32 v12, 16, v186
    v_and_b32 v13, v7, v186
    v_mfma_f32_16x16x32_bf16 v[64:67], v[212:215], v[56:59], v[64:67]
    v_lshlrev_b32 v14, 16, v187
    v_and_b32 v15, v7, v187
    v_lshlrev_b32 v16, 16, v188
    v_mfma_f32_16x16x32_bf16 v[68:71], v[216:219], v[56:59], v[68:71]
    v_and_b32 v17, v7, v188
    v_lshlrev_b32 v18, 16, v189
    v_and_b32 v19, v7, v189
    v_lshlrev_b32 v20, 16, v190
    v_mfma_f32_16x16x32_bf16 v[72:75], v[220:223], v[56:59], v[72:75]
    v_and_b32 v21, v7, v190
    v_lshlrev_b32 v22, 16, v191
    v_and_b32 v23, v7, v191
    v_lshlrev_b32 v24, 16, v192
    v_mfma_f32_16x16x32_bf16 v[76:79], v[224:227], v[56:59], v[76:79]
    v_and_b32 v25, v7, v192
    v_lshlrev_b32 v26, 16, v193
    v_and_b32 v27, v7, v193
    v_mfma_f32_16x16x32_bf16 v[80:83], v[228:231], v[56:59], v[80:83]
    v_lshlrev_b32 v28, 16, v194
    v_and_b32 v29, v7, v194
    v_lshlrev_b32 v30, 16, v195
    v_and_b32 v31, v7, v195
    s_waitcnt lgkmcnt(0)
    v_lshlrev_b32 v96, 16, v196
    v_and_b32 v97, v7, v196
    v_lshlrev_b32 v98, 16, v197
    v_and_b32 v99, v7, v197
    v_lshlrev_b32 v100, 16, v198
    v_and_b32 v101, v7, v198
    v_lshlrev_b32 v102, 16, v199
    v_and_b32_e64 v103, v7, v199
    v_pk_fma_f32 v[8:9], v[60:61], v[168:169], v[8:9]
    v_pk_fma_f32 v[10:11], v[62:63], v[170:171], v[10:11]
    v_pk_fma_f32 v[12:13], v[64:65], v[172:173], v[12:13]
    v_pk_fma_f32 v[14:15], v[66:67], v[174:175], v[14:15]
    v_cvt_pk_bf16_f32 v208, v8, v9
    v_cvt_pk_bf16_f32 v209, v10, v11
    v_cvt_pk_bf16_f32 v210, v12, v13
    v_cvt_pk_bf16_f32 v211, v14, v15
    ds_write_b128 v254, v[208:211] offset:0
    v_pk_fma_f32 v[16:17], v[68:69], v[176:177], v[16:17]
    v_pk_fma_f32 v[18:19], v[70:71], v[178:179], v[18:19]
    v_pk_fma_f32 v[20:21], v[72:73], v[180:181], v[20:21]
    v_pk_fma_f32 v[22:23], v[74:75], v[182:183], v[22:23]
    v_cvt_pk_bf16_f32 v212, v16, v17
    v_cvt_pk_bf16_f32 v213, v18, v19
    v_cvt_pk_bf16_f32 v214, v20, v21
    v_cvt_pk_bf16_f32 v215, v22, v23
    ds_write_b128 v254, v[212:215] offset:64
    ds_read_b32 v5, v245
    v_pk_fma_f32 v[24:25], v[76:77], v[84:85], v[24:25]
    v_pk_fma_f32 v[26:27], v[78:79], v[86:87], v[26:27]
    v_pk_fma_f32 v[28:29], v[80:81], v[88:89], v[28:29]
    v_pk_fma_f32 v[30:31], v[82:83], v[90:91], v[30:31]
    v_cvt_pk_bf16_f32 v216, v24, v25
    v_cvt_pk_bf16_f32 v217, v26, v27
    v_cvt_pk_bf16_f32 v218, v28, v29
    v_cvt_pk_bf16_f32 v219, v30, v31
    ds_write_b128 v254, v[216:219] offset:128
    s_waitcnt lgkmcnt(0)
    ds_read_b128 v[184:187], v243 offset:0
    ds_read_b128 v[188:191], v243 offset:1024
    ds_read_b128 v[192:195], v243 offset:2048
    v_cmp_le_u32 vcc, 8, v5
    s_and_b32 s47, vcc_lo, 15
    s_cmp_eq_u32 s47, 15
    s_cbranch_scc0 L_mb2_slow
    ds_read_b128 v[8:11], v238 offset:1024
    ds_read_b128 v[12:15], v238 offset:1280
    ds_read_b128 v[16:19], v238 offset:2560
    ds_read_b128 v[20:23], v238 offset:2816
    ds_read_b128 v[24:27], v238 offset:5632
    ds_read_b128 v[28:31], v238 offset:5888
    s_waitcnt lgkmcnt(8)
    buffer_store_dwordx4 v[184:187], v248, s[36:39], s55 offen sc1
    s_waitcnt lgkmcnt(7)
    buffer_store_dwordx4 v[188:191], v249, s[36:39], s55 offen sc1
    s_waitcnt lgkmcnt(6)
    buffer_store_dwordx4 v[192:195], v250, s[36:39], s55 offen sc1
L_mb2_join:
    s_waitcnt lgkmcnt(4)
    v_pk_add_f32 v[148:149], v[148:149], v[8:9]
    v_pk_add_f32 v[150:151], v[150:151], v[10:11]
    v_pk_add_f32 v[152:153], v[152:153], v[12:13]
    v_pk_add_f32 v[154:155], v[154:155], v[14:15]
    s_waitcnt lgkmcnt(2)
    v_pk_add_f32 v[148:149], v[148:149], v[16:17]
    v_pk_add_f32 v[150:151], v[150:151], v[18:19]
    v_pk_add_f32 v[152:153], v[152:153], v[20:21]
    v_pk_add_f32 v[154:155], v[154:155], v[22:23]
    s_waitcnt lgkmcnt(0)
    s_nop 0
    v_pk_add_f32 v[148:149], v[148:149], v[24:25]
    v_pk_add_f32 v[150:151], v[150:151], v[26:27]
    v_pk_add_f32 v[152:153], v[152:153], v[28:29]
    v_pk_add_f32 v[154:155], v[154:155], v[30:31]
    v_pk_fma_f32 v[96:97], v[148:149], v[84:85], v[96:97]
    v_pk_fma_f32 v[98:99], v[150:151], v[86:87], v[98:99]
    v_pk_fma_f32 v[100:101], v[152:153], v[88:89], v[100:101]
    v_pk_fma_f32 v[102:103], v[154:155], v[90:91], v[102:103]
    v_cvt_pk_bf16_f32 v120, v96, v97
    v_cvt_pk_bf16_f32 v121, v98, v99
    v_cvt_pk_bf16_f32 v122, v100, v101
    v_cvt_pk_bf16_f32 v123, v102, v103
    buffer_store_dwordx4 v[120:123], v251, s[36:39], s55 offen offset:128 sc1
    s_endpgm
L_mb2_slow:
    s_waitcnt lgkmcnt(0)
    buffer_store_dwordx4 v[184:187], v248, s[36:39], s55 offen sc1
    buffer_store_dwordx4 v[188:191], v249, s[36:39], s55 offen sc1
    buffer_store_dwordx4 v[192:195], v250, s[36:39], s55 offen sc1
L_mb2:
    ds_read_b32 v5, v245
    s_waitcnt lgkmcnt(0)
    v_cmp_le_u32 vcc, 8, v5
    s_and_b32 s47, vcc_lo, 15
    s_cmp_eq_u32 s47, 15
    s_cbranch_scc0 L_mb2
    ds_read_b128 v[8:11], v238 offset:1024
    ds_read_b128 v[12:15], v238 offset:1280
    ds_read_b128 v[16:19], v238 offset:2560
    ds_read_b128 v[20:23], v238 offset:2816
    ds_read_b128 v[24:27], v238 offset:5632
    ds_read_b128 v[28:31], v238 offset:5888
    s_branch L_mb2_join
L_n3:
    ds_read_b128 v[16:19], v240 offset:128
    ds_read_b128 v[20:23], v240 offset:192
    ds_read_b64_tr_b16 v[184:185], v232 offset:12352
    ds_read_b64_tr_b16 v[186:187], v232 offset:13376
    ds_read_b64_tr_b16 v[188:189], v232 offset:14400
    ds_read_b64_tr_b16 v[190:191], v232 offset:15424
    ds_read_b64_tr_b16 v[192:193], v232 offset:16448
    ds_read_b64_tr_b16 v[194:195], v232 offset:17472
    ds_read_b64_tr_b16 v[196:197], v237 offset:12352
    ds_read_b64_tr_b16 v[198:199], v237 offset:13376
    ds_read_b64_tr_b16 v[200:201], v237 offset:14400
    ds_read_b64_tr_b16 v[202:203], v237 offset:15424
    ds_read_b64_tr_b16 v[204:205], v237 offset:16448
    ds_read_b64_tr_b16 v[206:207], v237 offset:17472
    s_mov_b32 exec_hi, 0xffff
    s_add_u32 m0, s57, 61760
    s_movk_i32 s59, 320
    buffer_load_dwordx4 v236, s[28:31], s59 offen lds
    s_add_u32 m0, s58, 24704
    s_mov_b32 s59, 12288
    buffer_load_dwordx4 v242, s[32:35], s59 offen lds
    s_add_u32 m0, s57, 74112
    s_movk_i32 s59, 384
    buffer_load_dwordx4 v236, s[28:31], s59 offen lds
    s_mov_b32 exec_hi, -1
    s_setprio 2
    v_pk_fma_f32 v[40:41], v[8:9], v[8:9], s[60:61]
    v_pk_fma_f32 v[42:43], v[10:11], v[10:11], s[60:61]
    v_pk_fma_f32 v[44:45], v[12:13], v[12:13], s[60:61]
    v_pk_fma_f32 v[46:47], v[14:15], v[14:15], s[60:61]
    v_pk_mul_f32 v[40:41], v[8:9], v[40:41] neg_lo:[1,0] neg_hi:[1,0]
    v_pk_mul_f32 v[42:43], v[10:11], v[42:43] neg_lo:[1,0] neg_hi:[1,0]
    v_pk_mul_f32 v[44:45], v[12:13], v[44:45] neg_lo:[1,0] neg_hi:[1,0]
    v_pk_mul_f32 v[46:47], v[14:15], v[46:47] neg_lo:[1,0] neg_hi:[1,0]
    v_exp_f32 v40, v40
    s_waitcnt lgkmcnt(0)
    v_mfma_f32_16x16x32_bf16 v[16:19], v[184:187], v[84:87], v[16:19]
    v_exp_f32 v41, v41
    v_mfma_f32_16x16x32_bf16 v[16:19], v[188:191], v[88:91], v[16:19]
    v_exp_f32 v42, v42
    v_mfma_f32_16x16x32_bf16 v[16:19], v[192:195], v[92:95], v[16:19]
    v_exp_f32 v43, v43
    v_exp_f32 v44, v44
    v_mfma_f32_16x16x32_bf16 v[20:23], v[196:199], v[84:87], v[20:23]
    v_exp_f32 v45, v45
    v_mfma_f32_16x16x32_bf16 v[20:23], v[200:203], v[88:91], v[20:23]
    v_exp_f32 v46, v46
    v_mfma_f32_16x16x32_bf16 v[20:23], v[204:207], v[92:95], v[20:23]
    v_exp_f32_e64 v47, v47
    ds_read_b128 v[24:27], v240 offset:256
    ds_read_b128 v[28:31], v240 offset:320
    ds_read_b64_tr_b16 v[184:185], v232 offset:24704
    ds_read_b64_tr_b16 v[186:187], v232 offset:25728
    ds_read_b64_tr_b16 v[188:189], v232 offset:26752
    ds_read_b64_tr_b16 v[190:191], v232 offset:27776
    ds_read_b64_tr_b16 v[192:193], v232 offset:28800
    ds_read_b64_tr_b16 v[194:195], v232 offset:29824
    ds_read_b64_tr_b16 v[196:197], v237 offset:24704
    ds_read_b64_tr_b16 v[198:199], v237 offset:25728
    ds_read_b64_tr_b16 v[200:201], v237 offset:26752
    ds_read_b64_tr_b16 v[202:203], v237 offset:27776
    ds_read_b64_tr_b16 v[204:205], v237 offset:28800
    ds_read_b64_tr_b16 v[206:207], v237 offset:29824
    ds_read_b128 v[60:63], v241 offset:0
    ds_read_b128 v[64:67], v241 offset:16
    ds_read_b128 v[68:71], v241 offset:128
    ds_read_b128 v[72:75], v241 offset:144
    ds_read_b128 v[76:79], v241 offset:256
    ds_read_b128 v[80:83], v241 offset:272
    s_mov_b32 exec_hi, 0xffff
    s_add_u32 m0, s58, 37056
    s_mov_b32 s59, 18432
    buffer_load_dwordx4 v242, s[32:35], s59 offen lds
    s_add_u32 m0, s57, 86464
    s_movk_i32 s59, 448
    buffer_load_dwordx4 v236, s[28:31], s59 offen lds
    s_add_u32 m0, s58, 49408
    s_mov_b32 s59, 24576
    buffer_load_dwordx4 v242, s[32:35], s59 offen lds
    s_mov_b32 exec_hi, -1
    v_pk_add_f32 v[40:41], v[40:41], s[62:63]
    v_pk_add_f32 v[42:43], v[42:43], s[62:63]
    v_pk_add_f32 v[44:45], v[44:45], s[62:63]
    v_pk_add_f32 v[46:47], v[46:47], s[62:63]
    v_pk_fma_f32 v[48:49], v[16:17], v[16:17], s[60:61]
    v_pk_fma_f32 v[50:51], v[18:19], v[18:19], s[60:61]
    v_pk_fma_f32 v[52:53], v[20:21], v[20:21], s[60:61]
    v_pk_fma_f32 v[54:55], v[22:23], v[22:23], s[60:61]
    v_pk_mul_f32 v[48:49], v[16:17], v[48:49] neg_lo:[1,0] neg_hi:[1,0]
    v_pk_mul_f32 v[50:51], v[18:19], v[50:51] neg_lo:[1,0] neg_hi:[1,0]
    v_pk_mul_f32 v[52:53], v[20:21], v[52:53] neg_lo:[1,0] neg_hi:[1,0]
    v_pk_mul_f32 v[54:55], v[22:23], v[54:55] neg_lo:[1,0] neg_hi:[1,0]
    v_rcp_f32 v40, v40
    s_waitcnt lgkmcnt(6)
    v_mfma_f32_16x16x32_bf16 v[24:27], v[184:187], v[84:87], v[24:27]
    v_rcp_f32 v41, v41
    v_rcp_f32 v42, v42
    v_rcp_f32 v43, v43
    v_mfma_f32_16x16x32_bf16 v[24:27], v[188:191], v[88:91], v[24:27]
    v_rcp_f32 v44, v44
    v_rcp_f32 v45, v45
    v_mfma_f32_16x16x32_bf16 v[24:27], v[192:195], v[92:95], v[24:27]
    v_rcp_f32 v46, v46
    v_rcp_f32 v47, v47
    v_exp_f32 v48, v48
    v_mfma_f32_16x16x32_bf16 v[28:31], v[196:199], v[84:87], v[28:31]
    v_exp_f32 v49, v49
    v_exp_f32 v50, v50
    v_mfma_f32_16x16x32_bf16 v[28:31], v[200:203], v[88:91], v[28:31]
    v_exp_f32 v51, v51
    v_exp_f32 v52, v52
    v_exp_f32 v53, v53
    v_mfma_f32_16x16x32_bf16 v[28:31], v[204:207], v[92:95], v[28:31]
    v_exp_f32 v54, v54
    v_exp_f32_e64 v55, v55
    ds_read_b128 v[32:35], v240 offset:384
    ds_read_b128 v[36:39], v240 offset:448
    ds_read_b128 v[96:99], v240 offset:384
    ds_read_b128 v[100:103], v240 offset:448
    ds_read_b64_tr_b16 v[184:185], v232 offset:37056
    ds_read_b64_tr_b16 v[186:187], v232 offset:38080
    ds_read_b64_tr_b16 v[188:189], v232 offset:39104
    ds_read_b64_tr_b16 v[190:191], v232 offset:40128
    ds_read_b64_tr_b16 v[192:193], v232 offset:41152
    ds_read_b64_tr_b16 v[194:195], v232 offset:42176
    ds_read_b64_tr_b16 v[196:197], v237 offset:37056
    ds_read_b64_tr_b16 v[198:199], v237 offset:38080
    ds_read_b64_tr_b16 v[200:201], v237 offset:39104
    ds_read_b64_tr_b16 v[202:203], v237 offset:40128
    ds_read_b64_tr_b16 v[204:205], v237 offset:41152
    ds_read_b64_tr_b16 v[206:207], v237 offset:42176
    ds_read_b64_tr_b16 v[208:209], v233 offset:0
    ds_read_b64_tr_b16 v[210:211], v233 offset:3104
    ds_read_b64_tr_b16 v[212:213], v233 offset:8
    ds_read_b64_tr_b16 v[214:215], v233 offset:3112
    ds_read_b64_tr_b16 v[216:217], v233 offset:64
    ds_read_b64_tr_b16 v[218:219], v233 offset:3168
    ds_read_b64_tr_b16 v[220:221], v233 offset:72
    ds_read_b64_tr_b16 v[222:223], v233 offset:3176
    ds_read_b64_tr_b16 v[224:225], v233 offset:128
    ds_read_b64_tr_b16 v[226:227], v233 offset:3232
    ds_read_b64_tr_b16 v[228:229], v233 offset:136
    ds_read_b64_tr_b16 v[230:231], v233 offset:3240
    s_waitcnt vmcnt(0)
    v_mov_b32 v4, 5
    ds_write_b32 v244, v4
    s_mov_b32 exec_hi, 0xffff
    s_add_u32 m0, s57, 98816
    s_movk_i32 s59, 512
    buffer_load_dwordx4 v236, s[28:31], s59 offen lds
    s_add_u32 m0, s58, 61760
    s_mov_b32 s59, 30720
    buffer_load_dwordx4 v242, s[32:35], s59 offen lds
    s_mov_b32 exec_hi, -1
    v_pk_mul_f32 v[8:9], v[8:9], v[40:41]
    v_pk_mul_f32 v[10:11], v[10:11], v[42:43]
    v_pk_mul_f32 v[12:13], v[12:13], v[44:45]
    v_pk_mul_f32 v[14:15], v[14:15], v[46:47]
    v_pk_add_f32 v[48:49], v[48:49], s[62:63]
    v_pk_add_f32 v[50:51], v[50:51], s[62:63]
    v_pk_add_f32 v[52:53], v[52:53], s[62:63]
    v_pk_add_f32 v[54:55], v[54:55], s[62:63]
    v_pk_fma_f32 v[40:41], v[24:25], v[24:25], s[60:61]
    v_pk_fma_f32 v[42:43], v[26:27], v[26:27], s[60:61]
    v_pk_fma_f32 v[44:45], v[28:29], v[28:29], s[60:61]
    v_pk_fma_f32 v[46:47], v[30:31], v[30:31], s[60:61]
    v_pk_mul_f32 v[40:41], v[24:25], v[40:41] neg_lo:[1,0] neg_hi:[1,0]
    v_pk_mul_f32 v[42:43], v[26:27], v[42:43] neg_lo:[1,0] neg_hi:[1,0]
    v_pk_mul_f32 v[44:45], v[28:29], v[44:45] neg_lo:[1,0] neg_hi:[1,0]
    v_pk_mul_f32 v[46:47], v[30:31], v[46:47] neg_lo:[1,0] neg_hi:[1,0]
    v_rcp_f32 v48, v48
    s_waitcnt lgkmcnt(13)
    v_mfma_f32_16x16x32_bf16 v[32:35], v[184:187], v[84:87], v[32:35]
    v_cvt_pk_bf16_f32 v56, v8, v9
    v_cvt_pk_bf16_f32 v57, v10, v11
    v_mfma_f32_16x16x32_bf16 v[32:35], v[188:191], v[88:91], v[32:35]
    v_rcp_f32 v49, v49
    v_mfma_f32_16x16x32_bf16 v[32:35], v[192:195], v[92:95], v[32:35]
    v_cvt_pk_bf16_f32 v58, v12, v13
    v_cvt_pk_bf16_f32 v59, v14, v15
    v_mfma_f32_16x16x32_bf16 v[36:39], v[196:199], v[84:87], v[36:39]
    v_rcp_f32 v50, v50
    v_mfma_f32_16x16x32_bf16 v[36:39], v[200:203], v[88:91], v[36:39]
    v_rcp_f32 v51, v51
    v_mfma_f32_16x16x32_bf16 v[36:39], v[204:207], v[92:95], v[36:39]
    v_rcp_f32 v52, v52
    v_mfma_f32_16x16x32_bf16 v[96:99], v[184:187], v[156:159], v[96:99]
    v_rcp_f32 v53, v53
    v_mfma_f32_16x16x32_bf16 v[96:99], v[188:191], v[160:163], v[96:99]
    v_rcp_f32 v54, v54
    v_mfma_f32_16x16x32_bf16 v[96:99], v[192:195], v[164:167], v[96:99]
    v_rcp_f32 v55, v55
    v_mfma_f32_16x16x32_bf16 v[100:103], v[196:199], v[156:159], v[100:103]
    v_mfma_f32_16x16x32_bf16 v[100:103], v[200:203], v[160:163], v[100:103]
    v_exp_f32 v40, v40
    v_mfma_f32_16x16x32_bf16 v[100:103], v[204:207], v[164:167], v[100:103]
    v_exp_f32 v41, v41
    s_waitcnt lgkmcnt(0)
    v_mfma_f32_16x16x32_bf16 v[60:63], v[208:211], v[56:59], v[60:63]
    v_exp_f32 v42, v42
    v_mfma_f32_16x16x32_bf16 v[64:67], v[212:215], v[56:59], v[64:67]
    v_exp_f32 v43, v43
    v_mfma_f32_16x16x32_bf16 v[68:71], v[216:219], v[56:59], v[68:71]
    v_exp_f32 v44, v44
    v_mfma_f32_16x16x32_bf16 v[72:75], v[220:223], v[56:59], v[72:75]
    v_exp_f32 v45, v45
    v_mfma_f32_16x16x32_bf16 v[76:79], v[224:227], v[56:59], v[76:79]
    v_exp_f32 v46, v46
    v_mfma_f32_16x16x32_bf16 v[80:83], v[228:231], v[56:59], v[80:83]
    v_exp_f32 v47, v47
    ds_read_b128 v[8:11], v240 offset:512
    ds_read_b128 v[12:15], v240 offset:576
    ds_read_b64_tr_b16 v[184:185], v232 offset:49408
    ds_read_b64_tr_b16 v[186:187], v232 offset:50432
    ds_read_b64_tr_b16 v[188:189], v232 offset:51456
    ds_read_b64_tr_b16 v[190:191], v232 offset:52480
    ds_read_b64_tr_b16 v[192:193], v232 offset:53504
    ds_read_b64_tr_b16 v[194:195], v232 offset:54528
    ds_read_b64_tr_b16 v[196:197], v237 offset:49408
    ds_read_b64_tr_b16 v[198:199], v237 offset:50432
    ds_read_b64_tr_b16 v[200:201], v237 offset:51456
    ds_read_b64_tr_b16 v[202:203], v237 offset:52480
    ds_read_b64_tr_b16 v[204:205], v237 offset:53504
    ds_read_b64_tr_b16 v[206:207], v237 offset:54528
    ds_read_b64_tr_b16 v[208:209], v233 offset:12352
    ds_read_b64_tr_b16 v[210:211], v233 offset:15456
    ds_read_b64_tr_b16 v[212:213], v233 offset:12360
    ds_read_b64_tr_b16 v[214:215], v233 offset:15464
    ds_read_b64_tr_b16 v[216:217], v233 offset:12416
    ds_read_b64_tr_b16 v[218:219], v233 offset:15520
    ds_read_b64_tr_b16 v[220:221], v233 offset:12424
    ds_read_b64_tr_b16 v[222:223], v233 offset:15528
    ds_read_b64_tr_b16 v[224:225], v233 offset:12480
    ds_read_b64_tr_b16 v[226:227], v233 offset:15584
    ds_read_b64_tr_b16 v[228:229], v233 offset:12488
    ds_read_b64_tr_b16 v[230:231], v233 offset:15592
    ds_read_b32 v5, v245
    s_mov_b32 exec_hi, 0xffff
    s_add_u32 m0, s57, 111168
    s_movk_i32 s59, 576
    buffer_load_dwordx4 v236, s[28:31], s59 offen lds
    s_add_u32 m0, s58, 74112
    s_mov_b32 s59, 36864
    buffer_load_dwordx4 v242, s[32:35], s59 offen lds
    s_mov_b32 exec_hi, -1
    s_setprio 1
    s_nop 0
    v_pk_mul_f32 v[16:17], v[16:17], v[48:49]
    v_pk_mul_f32 v[18:19], v[18:19], v[50:51]
    v_pk_mul_f32 v[20:21], v[20:21], v[52:53]
    v_pk_mul_f32 v[22:23], v[22:23], v[54:55]
    v_pk_add_f32 v[40:41], v[40:41], s[62:63]
    v_pk_add_f32 v[42:43], v[42:43], s[62:63]
    v_pk_add_f32 v[44:45], v[44:45], s[62:63]
    v_pk_add_f32 v[46:47], v[46:47], s[62:63]
    v_pk_fma_f32 v[48:49], v[32:33], v[32:33], s[60:61]
    v_pk_fma_f32 v[50:51], v[34:35], v[34:35], s[60:61]
    v_pk_fma_f32 v[52:53], v[36:37], v[36:37], s[60:61]
    v_pk_fma_f32 v[54:55], v[38:39], v[38:39], s[60:61]
    v_pk_mul_f32 v[48:49], v[32:33], v[48:49] neg_lo:[1,0] neg_hi:[1,0]
    v_pk_mul_f32 v[50:51], v[34:35], v[50:51] neg_lo:[1,0] neg_hi:[1,0]
    v_pk_mul_f32 v[52:53], v[36:37], v[52:53] neg_lo:[1,0] neg_hi:[1,0]
    v_pk_mul_f32 v[54:55], v[38:39], v[54:55] neg_lo:[1,0] neg_hi:[1,0]
    v_pk_fma_f32 v[112:113], v[96:97], v[96:97], s[60:61]
    v_pk_fma_f32 v[114:115], v[98:99], v[98:99], s[60:61]
    v_pk_fma_f32 v[116:117], v[100:101], v[100:101], s[60:61]
    v_pk_fma_f32 v[118:119], v[102:103], v[102:103], s[60:61]
    v_pk_mul_f32 v[112:113], v[96:97], v[112:113] neg_lo:[1,0] neg_hi:[1,0]
    v_pk_mul_f32 v[114:115], v[98:99], v[114:115] neg_lo:[1,0] neg_hi:[1,0]
    v_pk_mul_f32 v[116:117], v[100:101], v[116:117] neg_lo:[1,0] neg_hi:[1,0]
    v_pk_mul_f32 v[118:119], v[102:103], v[118:119] neg_lo:[1,0] neg_hi:[1,0]
    v_rcp_f32 v40, v40
    s_waitcnt lgkmcnt(13)
    v_mfma_f32_16x16x32_bf16 v[8:11], v[184:187], v[84:87], v[8:11]
    v_cvt_pk_bf16_f32 v56, v16, v17
    v_cvt_pk_bf16_f32 v57, v18, v19
    v_rcp_f32 v41, v41
    v_mfma_f32_16x16x32_bf16 v[8:11], v[188:191], v[88:91], v[8:11]
    v_cvt_pk_bf16_f32 v58, v20, v21
    v_cvt_pk_bf16_f32 v59, v22, v23
    v_rcp_f32 v42, v42
    v_mfma_f32_16x16x32_bf16 v[8:11], v[192:195], v[92:95], v[8:11]
    v_rcp_f32 v43, v43
    v_rcp_f32 v44, v44
    v_mfma_f32_16x16x32_bf16 v[12:15], v[196:199], v[84:87], v[12:15]
    v_rcp_f32 v45, v45
    v_rcp_f32 v46, v46
    v_mfma_f32_16x16x32_bf16 v[12:15], v[200:203], v[88:91], v[12:15]
    v_rcp_f32 v47, v47
    v_exp_f32 v48, v48
    v_mfma_f32_16x16x32_bf16 v[12:15], v[204:207], v[92:95], v[12:15]
    v_exp_f32 v49, v49
    v_exp_f32 v50, v50
    v_exp_f32 v51, v51
    s_waitcnt lgkmcnt(0)
    v_mfma_f32_16x16x32_bf16 v[60:63], v[208:211], v[56:59], v[60:63]
    v_exp_f32 v52, v52
    v_exp_f32 v53, v53
    v_mfma_f32_16x16x32_bf16 v[64:67], v[212:215], v[56:59], v[64:67]
    v_exp_f32 v54, v54
    v_exp_f32 v55, v55
    v_mfma_f32_16x16x32_bf16 v[68:71], v[216:219], v[56:59], v[68:71]
    v_exp_f32 v112, v112
    v_exp_f32 v113, v113
    v_mfma_f32_16x16x32_bf16 v[72:75], v[220:223], v[56:59], v[72:75]
    v_exp_f32 v114, v114
    v_exp_f32 v115, v115
    v_mfma_f32_16x16x32_bf16 v[76:79], v[224:227], v[56:59], v[76:79]
    v_exp_f32 v116, v116
    v_exp_f32 v117, v117
    v_mfma_f32_16x16x32_bf16 v[80:83], v[228:231], v[56:59], v[80:83]
    v_exp_f32 v118, v118
    v_exp_f32 v119, v119
    v_cmp_le_u32 vcc, 5, v5
    s_cmp_eq_u64 vcc, -1
    s_cbranch_scc1 L_gate_N3_3_ok
L_gate_N3_3:
    ds_read_b32 v5, v245
    s_waitcnt lgkmcnt(0)
    v_cmp_le_u32 vcc, 5, v5
    s_cmp_eq_u64 vcc, -1
    s_cbranch_scc0 L_gate_N3_3
L_gate_N3_3_ok:
    s_nop 0
    v_add_u32 v232, 61760, v232
    v_add_u32 v237, 61760, v237
    ds_read_b128 v[16:19], v240 offset:640
    ds_read_b128 v[20:23], v240 offset:704
    ds_read_b64_tr_b16 v[184:185], v232 offset:0
    ds_read_b64_tr_b16 v[186:187], v232 offset:1024
    ds_read_b64_tr_b16 v[188:189], v232 offset:2048
    ds_read_b64_tr_b16 v[190:191], v232 offset:3072
    ds_read_b64_tr_b16 v[192:193], v232 offset:4096
    ds_read_b64_tr_b16 v[194:195], v232 offset:5120
    ds_read_b64_tr_b16 v[196:197], v237 offset:0
    ds_read_b64_tr_b16 v[198:199], v237 offset:1024
    ds_read_b64_tr_b16 v[200:201], v237 offset:2048
    ds_read_b64_tr_b16 v[202:203], v237 offset:3072
    ds_read_b64_tr_b16 v[204:205], v237 offset:4096
    ds_read_b64_tr_b16 v[206:207], v237 offset:5120
    ds_read_b64_tr_b16 v[208:209], v233 offset:24704
    ds_read_b64_tr_b16 v[210:211], v233 offset:27808
    ds_read_b64_tr_b16 v[212:213], v233 offset:24712
    ds_read_b64_tr_b16 v[214:215], v233 offset:27816
    ds_read_b64_tr_b16 v[216:217], v233 offset:24768
    ds_read_b64_tr_b16 v[218:219], v233 offset:27872
    ds_read_b64_tr_b16 v[220:221], v233 offset:24776
    ds_read_b64_tr_b16 v[222:223], v233 offset:27880
    ds_read_b64_tr_b16 v[224:225], v233 offset:24832
    ds_read_b64_tr_b16 v[226:227], v233 offset:27936
    ds_read_b64_tr_b16 v[228:229], v233 offset:24840
    ds_read_b64_tr_b16 v[230:231], v233 offset:27944
    s_mov_b32 exec_hi, 0xffff
    s_add_u32 m0, s57, 123520
    s_movk_i32 s59, 640
    buffer_load_dwordx4 v236, s[28:31], s59 offen lds
    s_add_u32 m0, s58, 86464
    s_mov_b32 s59, 43008
    buffer_load_dwordx4 v242, s[32:35], s59 offen lds
    s_mov_b32 exec_hi, -1
    v_pk_mul_f32 v[24:25], v[24:25], v[40:41]
    v_pk_mul_f32 v[26:27], v[26:27], v[42:43]
    v_pk_mul_f32 v[28:29], v[28:29], v[44:45]
    v_pk_mul_f32 v[30:31], v[30:31], v[46:47]
    v_pk_add_f32 v[48:49], v[48:49], s[62:63]
    v_pk_add_f32 v[50:51], v[50:51], s[62:63]
    v_pk_add_f32 v[52:53], v[52:53], s[62:63]
    v_pk_add_f32 v[54:55], v[54:55], s[62:63]
    v_pk_add_f32 v[112:113], v[112:113], s[62:63]
    v_pk_add_f32 v[114:115], v[114:115], s[62:63]
    v_pk_add_f32 v[116:117], v[116:117], s[62:63]
    v_pk_add_f32 v[118:119], v[118:119], s[62:63]
    v_pk_fma_f32 v[40:41], v[8:9], v[8:9], s[60:61]
    v_pk_fma_f32 v[42:43], v[10:11], v[10:11], s[60:61]
    v_pk_fma_f32 v[44:45], v[12:13], v[12:13], s[60:61]
    v_pk_fma_f32 v[46:47], v[14:15], v[14:15], s[60:61]
    v_pk_mul_f32 v[40:41], v[8:9], v[40:41] neg_lo:[1,0] neg_hi:[1,0]
    v_pk_mul_f32 v[42:43], v[10:11], v[42:43] neg_lo:[1,0] neg_hi:[1,0]
    v_pk_mul_f32 v[44:45], v[12:13], v[44:45] neg_lo:[1,0] neg_hi:[1,0]
    v_pk_mul_f32 v[46:47], v[14:15], v[46:47] neg_lo:[1,0] neg_hi:[1,0]
    v_rcp_f32 v48, v48
    s_waitcnt lgkmcnt(12)
    v_mfma_f32_16x16x32_bf16 v[16:19], v[184:187], v[84:87], v[16:19]
    v_cvt_pk_bf16_f32 v56, v24, v25
    v_cvt_pk_bf16_f32 v57, v26, v27
    v_rcp_f32 v49, v49
    v_mfma_f32_16x16x32_bf16 v[16:19], v[188:191], v[88:91], v[16:19]
    v_cvt_pk_bf16_f32 v58, v28, v29
    v_cvt_pk_bf16_f32 v59, v30, v31
    v_rcp_f32 v50, v50
    v_mfma_f32_16x16x32_bf16 v[16:19], v[192:195], v[92:95], v[16:19]
    v_rcp_f32 v51, v51
    v_rcp_f32 v52, v52
    v_mfma_f32_16x16x32_bf16 v[20:23], v[196:199], v[84:87], v[20:23]
    v_rcp_f32 v53, v53
    v_rcp_f32 v54, v54
    v_mfma_f32_16x16x32_bf16 v[20:23], v[200:203], v[88:91], v[20:23]
    v_rcp_f32 v55, v55
    v_exp_f32 v40, v40
    v_mfma_f32_16x16x32_bf16 v[20:23], v[204:207], v[92:95], v[20:23]
    v_exp_f32 v41, v41
    v_exp_f32 v42, v42
    v_exp_f32 v43, v43
    s_waitcnt lgkmcnt(0)
    v_mfma_f32_16x16x32_bf16 v[60:63], v[208:211], v[56:59], v[60:63]
    v_exp_f32 v44, v44
    v_exp_f32 v45, v45
    v_mfma_f32_16x16x32_bf16 v[64:67], v[212:215], v[56:59], v[64:67]
    v_exp_f32 v46, v46
    v_exp_f32 v47, v47
    v_mfma_f32_16x16x32_bf16 v[68:71], v[216:219], v[56:59], v[68:71]
    v_rcp_f32 v112, v112
    v_rcp_f32 v113, v113
    v_mfma_f32_16x16x32_bf16 v[72:75], v[220:223], v[56:59], v[72:75]
    v_rcp_f32 v114, v114
    v_rcp_f32 v115, v115
    v_mfma_f32_16x16x32_bf16 v[76:79], v[224:227], v[56:59], v[76:79]
    v_rcp_f32 v116, v116
    v_rcp_f32 v117, v117
    v_mfma_f32_16x16x32_bf16 v[80:83], v[228:231], v[56:59], v[80:83]
    v_rcp_f32 v118, v118
    v_rcp_f32 v119, v119
    ds_read_b128 v[24:27], v240 offset:768
    ds_read_b128 v[28:31], v240 offset:832
    ds_read_b64_tr_b16 v[184:185], v232 offset:12352
    ds_read_b64_tr_b16 v[186:187], v232 offset:13376
    ds_read_b64_tr_b16 v[188:189], v232 offset:14400
    ds_read_b64_tr_b16 v[190:191], v232 offset:15424
    ds_read_b64_tr_b16 v[192:193], v232 offset:16448
    ds_read_b64_tr_b16 v[194:195], v232 offset:17472
    ds_read_b64_tr_b16 v[196:197], v237 offset:12352
    ds_read_b64_tr_b16 v[198:199], v237 offset:13376
    ds_read_b64_tr_b16 v[200:201], v237 offset:14400
    ds_read_b64_tr_b16 v[202:203], v237 offset:15424
    ds_read_b64_tr_b16 v[204:205], v237 offset:16448
    ds_read_b64_tr_b16 v[206:207], v237 offset:17472
    ds_read_b64_tr_b16 v[208:209], v233 offset:37056
    ds_read_b64_tr_b16 v[210:211], v233 offset:40160
    ds_read_b64_tr_b16 v[212:213], v233 offset:37064
    ds_read_b64_tr_b16 v[214:215], v233 offset:40168
    ds_read_b64_tr_b16 v[216:217], v233 offset:37120
    ds_read_b64_tr_b16 v[218:219], v233 offset:40224
    ds_read_b64_tr_b16 v[220:221], v233 offset:37128
    ds_read_b64_tr_b16 v[222:223], v233 offset:40232
    ds_read_b64_tr_b16 v[224:225], v233 offset:37184
    ds_read_b64_tr_b16 v[226:227], v233 offset:40288
    ds_read_b64_tr_b16 v[228:229], v233 offset:37192
    ds_read_b64_tr_b16 v[230:231], v233 offset:40296
    s_waitcnt vmcnt(0)
    v_mov_b32 v4, 6
    ds_write_b32 v244, v4
    s_mov_b32 exec_hi, 0xffff
    s_add_u32 m0, s57, 135872
    s_movk_i32 s59, 704
    buffer_load_dwordx4 v236, s[28:31], s59 offen lds
    s_add_u32 m0, s58, 98816
    s_mov_b32 s59, 49152
    buffer_load_dwordx4 v242, s[32:35], s59 offen lds
    s_mov_b32 exec_hi, -1
    buffer_load_dwordx4 v[248:251], v1, s[96:99], 0 offen offset:2048
    buffer_load_dwordx4 v[252:255], v1, s[96:99], 0 offen offset:3072
    v_pk_mul_f32 v[32:33], v[32:33], v[48:49]
    v_pk_mul_f32 v[34:35], v[34:35], v[50:51]
    v_pk_mul_f32 v[36:37], v[36:37], v[52:53]
    v_pk_mul_f32 v[38:39], v[38:39], v[54:55]
    v_pk_add_f32 v[40:41], v[40:41], s[62:63]
    v_pk_add_f32 v[42:43], v[42:43], s[62:63]
    v_pk_add_f32 v[44:45], v[44:45], s[62:63]
    v_pk_add_f32 v[46:47], v[46:47], s[62:63]
    v_pk_mul_f32 v[96:97], v[96:97], v[112:113]
    v_pk_mul_f32 v[98:99], v[98:99], v[114:115]
    v_pk_mul_f32 v[100:101], v[100:101], v[116:117]
    v_pk_mul_f32 v[102:103], v[102:103], v[118:119]
    v_pk_fma_f32 v[48:49], v[16:17], v[16:17], s[60:61]
    v_pk_fma_f32 v[50:51], v[18:19], v[18:19], s[60:61]
    v_pk_fma_f32 v[52:53], v[20:21], v[20:21], s[60:61]
    v_pk_fma_f32 v[54:55], v[22:23], v[22:23], s[60:61]
    v_pk_mul_f32 v[48:49], v[16:17], v[48:49] neg_lo:[1,0] neg_hi:[1,0]
    v_pk_mul_f32 v[50:51], v[18:19], v[50:51] neg_lo:[1,0] neg_hi:[1,0]
    v_pk_mul_f32 v[52:53], v[20:21], v[52:53] neg_lo:[1,0] neg_hi:[1,0]
    v_pk_mul_f32 v[54:55], v[22:23], v[54:55] neg_lo:[1,0] neg_hi:[1,0]
    v_rcp_f32 v40, v40
    s_waitcnt lgkmcnt(13)
    v_mfma_f32_16x16x32_bf16 v[24:27], v[184:187], v[84:87], v[24:27]
    v_cvt_pk_bf16_f32 v56, v32, v33
    v_cvt_pk_bf16_f32 v57, v34, v35
    v_mfma_f32_16x16x32_bf16 v[24:27], v[188:191], v[88:91], v[24:27]
    v_rcp_f32 v41, v41
    v_mfma_f32_16x16x32_bf16 v[24:27], v[192:195], v[92:95], v[24:27]
    v_cvt_pk_bf16_f32 v58, v36, v37
    v_cvt_pk_bf16_f32 v59, v38, v39
    v_mfma_f32_16x16x32_bf16 v[28:31], v[196:199], v[84:87], v[28:31]
    v_rcp_f32 v42, v42
    v_mfma_f32_16x16x32_bf16 v[28:31], v[200:203], v[88:91], v[28:31]
    v_cvt_pk_bf16_f32 v120, v96, v97
    v_cvt_pk_bf16_f32 v121, v98, v99
    v_mfma_f32_16x16x32_bf16 v[28:31], v[204:207], v[92:95], v[28:31]
    v_rcp_f32 v43, v43
    v_cvt_pk_bf16_f32 v122, v100, v101
    s_waitcnt lgkmcnt(0)
    v_mfma_f32_16x16x32_bf16 v[60:63], v[208:211], v[56:59], v[60:63]
    v_cvt_pk_bf16_f32 v123, v102, v103
    v_mfma_f32_16x16x32_bf16 v[64:67], v[212:215], v[56:59], v[64:67]
    v_rcp_f32 v44, v44
    v_mfma_f32_16x16x32_bf16 v[68:71], v[216:219], v[56:59], v[68:71]
    v_rcp_f32 v45, v45
    v_rcp_f32 v46, v46
    v_mfma_f32_16x16x32_bf16 v[72:75], v[220:223], v[56:59], v[72:75]
    v_rcp_f32 v47, v47
    v_mfma_f32_16x16x32_bf16 v[76:79], v[224:227], v[56:59], v[76:79]
    v_exp_f32 v48, v48
    v_mfma_f32_16x16x32_bf16 v[80:83], v[228:231], v[56:59], v[80:83]
    v_exp_f32 v49, v49
    v_mfma_f32_16x16x32_bf16 v[132:135], v[208:211], v[120:123], 0
    v_exp_f32 v50, v50
    v_mfma_f32_16x16x32_bf16 v[136:139], v[212:215], v[120:123], 0
    v_exp_f32 v51, v51
    v_mfma_f32_16x16x32_bf16 v[140:143], v[216:219], v[120:123], 0
    v_exp_f32 v52, v52
    v_mfma_f32_16x16x32_bf16 v[144:147], v[220:223], v[120:123], 0
    v_exp_f32 v53, v53
    v_mfma_f32_16x16x32_bf16 v[148:151], v[224:227], v[120:123], 0
    v_exp_f32 v54, v54
    v_mfma_f32_16x16x32_bf16 v[152:155], v[228:231], v[120:123], 0
    v_exp_f32 v55, v55
    ds_read_b128 v[32:35], v240 offset:896
    ds_read_b128 v[36:39], v240 offset:960
    ds_read_b128 v[96:99], v240 offset:896
    ds_read_b128 v[100:103], v240 offset:960
    ds_read_b64_tr_b16 v[184:185], v232 offset:24704
    ds_read_b64_tr_b16 v[186:187], v232 offset:25728
    ds_read_b64_tr_b16 v[188:189], v232 offset:26752
    ds_read_b64_tr_b16 v[190:191], v232 offset:27776
    ds_read_b64_tr_b16 v[192:193], v232 offset:28800
    ds_read_b64_tr_b16 v[194:195], v232 offset:29824
    ds_read_b64_tr_b16 v[196:197], v237 offset:24704
    ds_read_b64_tr_b16 v[198:199], v237 offset:25728
    ds_read_b64_tr_b16 v[200:201], v237 offset:26752
    ds_read_b64_tr_b16 v[202:203], v237 offset:27776
    ds_read_b64_tr_b16 v[204:205], v237 offset:28800
    ds_read_b64_tr_b16 v[206:207], v237 offset:29824
    ds_read_b64_tr_b16 v[208:209], v233 offset:49408
    ds_read_b64_tr_b16 v[210:211], v233 offset:52512
    ds_read_b64_tr_b16 v[212:213], v233 offset:49416
    ds_read_b64_tr_b16 v[214:215], v233 offset:52520
    ds_read_b64_tr_b16 v[216:217], v233 offset:49472
    ds_read_b64_tr_b16 v[218:219], v233 offset:52576
    ds_read_b64_tr_b16 v[220:221], v233 offset:49480
    ds_read_b64_tr_b16 v[222:223], v233 offset:52584
    ds_read_b64_tr_b16 v[224:225], v233 offset:49536
    ds_read_b64_tr_b16 v[226:227], v233 offset:52640
    ds_read_b64_tr_b16 v[228:229], v233 offset:49544
    ds_read_b64_tr_b16 v[230:231], v233 offset:52648
    ds_read_b32 v5, v245
    s_mov_b32 exec_hi, 0xffff
    s_add_u32 m0, s58, 111168
    s_mov_b32 s59, 55296
    buffer_load_dwordx4 v242, s[32:35], s59 offen lds
    s_add_u32 m0, s58, 123520
    s_mov_b32 s59, 61440
    buffer_load_dwordx4 v242, s[32:35], s59 offen lds
    s_mov_b32 exec_hi, -1
    s_nop 0
    v_pk_mul_f32 v[8:9], v[8:9], v[40:41]
    v_pk_mul_f32 v[10:11], v[10:11], v[42:43]
    v_pk_mul_f32 v[12:13], v[12:13], v[44:45]
    v_pk_mul_f32 v[14:15], v[14:15], v[46:47]
    v_pk_add_f32 v[48:49], v[48:49], s[62:63]
    v_pk_add_f32 v[50:51], v[50:51], s[62:63]
    v_pk_add_f32 v[52:53], v[52:53], s[62:63]
    v_pk_add_f32 v[54:55], v[54:55], s[62:63]
    v_pk_fma_f32 v[40:41], v[24:25], v[24:25], s[60:61]
    v_pk_fma_f32 v[42:43], v[26:27], v[26:27], s[60:61]
    v_pk_fma_f32 v[44:45], v[28:29], v[28:29], s[60:61]
    v_pk_fma_f32 v[46:47], v[30:31], v[30:31], s[60:61]
    v_pk_mul_f32 v[40:41], v[24:25], v[40:41] neg_lo:[1,0] neg_hi:[1,0]
    v_pk_mul_f32 v[42:43], v[26:27], v[42:43] neg_lo:[1,0] neg_hi:[1,0]
    v_pk_mul_f32 v[44:45], v[28:29], v[44:45] neg_lo:[1,0] neg_hi:[1,0]
    v_pk_mul_f32 v[46:47], v[30:31], v[46:47] neg_lo:[1,0] neg_hi:[1,0]
    v_rcp_f32 v48, v48
    s_waitcnt lgkmcnt(13)
    v_mfma_f32_16x16x32_bf16 v[32:35], v[184:187], v[84:87], v[32:35]
    v_cvt_pk_bf16_f32 v56, v8, v9
    v_cvt_pk_bf16_f32 v57, v10, v11
    v_mfma_f32_16x16x32_bf16 v[32:35], v[188:191], v[88:91], v[32:35]
    v_rcp_f32 v49, v49
    v_mfma_f32_16x16x32_bf16 v[32:35], v[192:195], v[92:95], v[32:35]
    v_cvt_pk_bf16_f32 v58, v12, v13
    v_cvt_pk_bf16_f32 v59, v14, v15
    v_mfma_f32_16x16x32_bf16 v[36:39], v[196:199], v[84:87], v[36:39]
    v_rcp_f32 v50, v50
    v_mfma_f32_16x16x32_bf16 v[36:39], v[200:203], v[88:91], v[36:39]
    v_rcp_f32 v51, v51
    v_mfma_f32_16x16x32_bf16 v[36:39], v[204:207], v[92:95], v[36:39]
    v_rcp_f32 v52, v52
    v_mfma_f32_16x16x32_bf16 v[96:99], v[184:187], v[156:159], v[96:99]
    v_rcp_f32 v53, v53
    v_mfma_f32_16x16x32_bf16 v[96:99], v[188:191], v[160:163], v[96:99]
    v_rcp_f32 v54, v54
    v_mfma_f32_16x16x32_bf16 v[96:99], v[192:195], v[164:167], v[96:99]
    v_rcp_f32 v55, v55
    v_mfma_f32_16x16x32_bf16 v[100:103], v[196:199], v[156:159], v[100:103]
    v_mfma_f32_16x16x32_bf16 v[100:103], v[200:203], v[160:163], v[100:103]
    v_exp_f32 v40, v40
    v_mfma_f32_16x16x32_bf16 v[100:103], v[204:207], v[164:167], v[100:103]
    v_exp_f32 v41, v41
    s_waitcnt lgkmcnt(0)
    v_mfma_f32_16x16x32_bf16 v[60:63], v[208:211], v[56:59], v[60:63]
    v_exp_f32 v42, v42
    v_mfma_f32_16x16x32_bf16 v[64:67], v[212:215], v[56:59], v[64:67]
    v_exp_f32 v43, v43
    v_mfma_f32_16x16x32_bf16 v[68:71], v[216:219], v[56:59], v[68:71]
    v_exp_f32 v44, v44
    v_mfma_f32_16x16x32_bf16 v[72:75], v[220:223], v[56:59], v[72:75]
    v_exp_f32 v45, v45
    v_mfma_f32_16x16x32_bf16 v[76:79], v[224:227], v[56:59], v[76:79]
    v_exp_f32 v46, v46
    v_mfma_f32_16x16x32_bf16 v[80:83], v[228:231], v[56:59], v[80:83]
    v_exp_f32 v47, v47
    v_cmp_le_u32 vcc, 6, v5
    s_cmp_eq_u64 vcc, -1
    s_cbranch_scc1 L_gate_N3_6_ok
L_gate_N3_6:
    ds_read_b32 v5, v245
    s_waitcnt lgkmcnt(0)
    v_cmp_le_u32 vcc, 6, v5
    s_cmp_eq_u64 vcc, -1
    s_cbranch_scc0 L_gate_N3_6
L_gate_N3_6_ok:
    s_nop 0
    ds_read_b128 v[8:11], v240 offset:1024
    ds_read_b128 v[12:15], v240 offset:1088
    ds_read_b64_tr_b16 v[184:185], v232 offset:37056
    ds_read_b64_tr_b16 v[186:187], v232 offset:38080
    ds_read_b64_tr_b16 v[188:189], v232 offset:39104
    ds_read_b64_tr_b16 v[190:191], v232 offset:40128
    ds_read_b64_tr_b16 v[192:193], v232 offset:41152
    ds_read_b64_tr_b16 v[194:195], v232 offset:42176
    ds_read_b64_tr_b16 v[196:197], v237 offset:37056
    ds_read_b64_tr_b16 v[198:199], v237 offset:38080
    ds_read_b64_tr_b16 v[200:201], v237 offset:39104
    ds_read_b64_tr_b16 v[202:203], v237 offset:40128
    ds_read_b64_tr_b16 v[204:205], v237 offset:41152
    ds_read_b64_tr_b16 v[206:207], v237 offset:42176
    v_add_u32 v233, 61760, v233
    ds_read_b64_tr_b16 v[208:209], v233 offset:0
    ds_read_b64_tr_b16 v[210:211], v233 offset:3104
    ds_read_b64_tr_b16 v[212:213], v233 offset:8
    ds_read_b64_tr_b16 v[214:215], v233 offset:3112
    ds_read_b64_tr_b16 v[216:217], v233 offset:64
    ds_read_b64_tr_b16 v[218:219], v233 offset:3168
    ds_read_b64_tr_b16 v[220:221], v233 offset:72
    ds_read_b64_tr_b16 v[222:223], v233 offset:3176
    ds_read_b64_tr_b16 v[224:225], v233 offset:128
    ds_read_b64_tr_b16 v[226:227], v233 offset:3232
    ds_read_b64_tr_b16 v[228:229], v233 offset:136
    ds_read_b64_tr_b16 v[230:231], v233 offset:3240
    s_mov_b32 exec_hi, 0xffff
    s_add_u32 m0, s58, 135872
    s_mov_b32 s59, 67584
    buffer_load_dwordx4 v242, s[32:35], s59 offen lds
    s_mov_b32 exec_hi, -1
    s_nop 0
    v_pk_mul_f32 v[16:17], v[16:17], v[48:49]
    v_pk_mul_f32 v[18:19], v[18:19], v[50:51]
    v_pk_mul_f32 v[20:21], v[20:21], v[52:53]
    v_pk_mul_f32 v[22:23], v[22:23], v[54:55]
    v_pk_add_f32 v[40:41], v[40:41], s[62:63]
    v_pk_add_f32 v[42:43], v[42:43], s[62:63]
    v_pk_add_f32 v[44:45], v[44:45], s[62:63]
    v_pk_add_f32 v[46:47], v[46:47], s[62:63]
    v_pk_fma_f32 v[48:49], v[32:33], v[32:33], s[60:61]
    v_pk_fma_f32 v[50:51], v[34:35], v[34:35], s[60:61]
    v_pk_fma_f32 v[52:53], v[36:37], v[36:37], s[60:61]
    v_pk_fma_f32 v[54:55], v[38:39], v[38:39], s[60:61]
    v_pk_mul_f32 v[48:49], v[32:33], v[48:49] neg_lo:[1,0] neg_hi:[1,0]
    v_pk_mul_f32 v[50:51], v[34:35], v[50:51] neg_lo:[1,0] neg_hi:[1,0]
    v_pk_mul_f32 v[52:53], v[36:37], v[52:53] neg_lo:[1,0] neg_hi:[1,0]
    v_pk_mul_f32 v[54:55], v[38:39], v[54:55] neg_lo:[1,0] neg_hi:[1,0]
    v_pk_fma_f32 v[112:113], v[96:97], v[96:97], s[60:61]
    v_pk_fma_f32 v[114:115], v[98:99], v[98:99], s[60:61]
    v_pk_fma_f32 v[116:117], v[100:101], v[100:101], s[60:61]
    v_pk_fma_f32 v[118:119], v[102:103], v[102:103], s[60:61]
    v_pk_mul_f32 v[112:113], v[96:97], v[112:113] neg_lo:[1,0] neg_hi:[1,0]
    v_pk_mul_f32 v[114:115], v[98:99], v[114:115] neg_lo:[1,0] neg_hi:[1,0]
    v_pk_mul_f32 v[116:117], v[100:101], v[116:117] neg_lo:[1,0] neg_hi:[1,0]
    v_pk_mul_f32 v[118:119], v[102:103], v[118:119] neg_lo:[1,0] neg_hi:[1,0]
    v_rcp_f32 v40, v40
    s_waitcnt lgkmcnt(12)
    v_mfma_f32_16x16x32_bf16 v[8:11], v[184:187], v[84:87], v[8:11]
    v_cvt_pk_bf16_f32 v56, v16, v17
    v_cvt_pk_bf16_f32 v57, v18, v19
    v_rcp_f32 v41, v41
    v_mfma_f32_16x16x32_bf16 v[8:11], v[188:191], v[88:91], v[8:11]
    v_cvt_pk_bf16_f32 v58, v20, v21
    v_cvt_pk_bf16_f32 v59, v22, v23
    v_rcp_f32 v42, v42
    v_mfma_f32_16x16x32_bf16 v[8:11], v[192:195], v[92:95], v[8:11]
    v_rcp_f32 v43, v43
    v_rcp_f32 v44, v44
    v_mfma_f32_16x16x32_bf16 v[12:15], v[196:199], v[84:87], v[12:15]
    v_rcp_f32 v45, v45
    v_rcp_f32 v46, v46
    v_mfma_f32_16x16x32_bf16 v[12:15], v[200:203], v[88:91], v[12:15]
    v_rcp_f32 v47, v47
    v_exp_f32 v48, v48
    v_mfma_f32_16x16x32_bf16 v[12:15], v[204:207], v[92:95], v[12:15]
    v_exp_f32 v49, v49
    v_exp_f32 v50, v50
    v_exp_f32 v51, v51
    s_waitcnt lgkmcnt(0)
    v_mfma_f32_16x16x32_bf16 v[60:63], v[208:211], v[56:59], v[60:63]
    v_exp_f32 v52, v52
    v_exp_f32 v53, v53
    v_mfma_f32_16x16x32_bf16 v[64:67], v[212:215], v[56:59], v[64:67]
    v_exp_f32 v54, v54
    v_exp_f32 v55, v55
    v_mfma_f32_16x16x32_bf16 v[68:71], v[216:219], v[56:59], v[68:71]
    v_exp_f32 v112, v112
    v_exp_f32 v113, v113
    v_mfma_f32_16x16x32_bf16 v[72:75], v[220:223], v[56:59], v[72:75]
    v_exp_f32 v114, v114
    v_exp_f32 v115, v115
    v_mfma_f32_16x16x32_bf16 v[76:79], v[224:227], v[56:59], v[76:79]
    v_exp_f32 v116, v116
    v_exp_f32 v117, v117
    v_mfma_f32_16x16x32_bf16 v[80:83], v[228:231], v[56:59], v[80:83]
    v_exp_f32 v118, v118
    v_exp_f32 v119, v119
    ds_read_b128 v[16:19], v240 offset:1152
    ds_read_b128 v[20:23], v240 offset:1216
    ds_read_b64_tr_b16 v[184:185], v232 offset:49408
    ds_read_b64_tr_b16 v[186:187], v232 offset:50432
    ds_read_b64_tr_b16 v[188:189], v232 offset:51456
    ds_read_b64_tr_b16 v[190:191], v232 offset:52480
    ds_read_b64_tr_b16 v[192:193], v232 offset:53504
    ds_read_b64_tr_b16 v[194:195], v232 offset:54528
    ds_read_b64_tr_b16 v[196:197], v237 offset:49408
    ds_read_b64_tr_b16 v[198:199], v237 offset:50432
    ds_read_b64_tr_b16 v[200:201], v237 offset:51456
    ds_read_b64_tr_b16 v[202:203], v237 offset:52480
    ds_read_b64_tr_b16 v[204:205], v237 offset:53504
    ds_read_b64_tr_b16 v[206:207], v237 offset:54528
    ds_read_b64_tr_b16 v[208:209], v233 offset:12352
    ds_read_b64_tr_b16 v[210:211], v233 offset:15456
    ds_read_b64_tr_b16 v[212:213], v233 offset:12360
    ds_read_b64_tr_b16 v[214:215], v233 offset:15464
    ds_read_b64_tr_b16 v[216:217], v233 offset:12416
    ds_read_b64_tr_b16 v[218:219], v233 offset:15520
    ds_read_b64_tr_b16 v[220:221], v233 offset:12424
    ds_read_b64_tr_b16 v[222:223], v233 offset:15528
    ds_read_b64_tr_b16 v[224:225], v233 offset:12480
    ds_read_b64_tr_b16 v[226:227], v233 offset:15584
    ds_read_b64_tr_b16 v[228:229], v233 offset:12488
    ds_read_b64_tr_b16 v[230:231], v233 offset:15592
    s_waitcnt vmcnt(0)
    v_mov_b32 v4, 7
    ds_write_b32 v244, v4
    v_pk_mul_f32 v[24:25], v[24:25], v[40:41]
    v_pk_mul_f32 v[26:27], v[26:27], v[42:43]
    v_pk_mul_f32 v[28:29], v[28:29], v[44:45]
    v_pk_mul_f32 v[30:31], v[30:31], v[46:47]
    v_pk_add_f32 v[48:49], v[48:49], s[62:63]
    v_pk_add_f32 v[50:51], v[50:51], s[62:63]
    v_pk_add_f32 v[52:53], v[52:53], s[62:63]
    v_pk_add_f32 v[54:55], v[54:55], s[62:63]
    v_pk_add_f32 v[112:113], v[112:113], s[62:63]
    v_pk_add_f32 v[114:115], v[114:115], s[62:63]
    v_pk_add_f32 v[116:117], v[116:117], s[62:63]
    v_pk_add_f32 v[118:119], v[118:119], s[62:63]
    v_pk_fma_f32 v[40:41], v[8:9], v[8:9], s[60:61]
    v_pk_fma_f32 v[42:43], v[10:11], v[10:11], s[60:61]
    v_pk_fma_f32 v[44:45], v[12:13], v[12:13], s[60:61]
    v_pk_fma_f32 v[46:47], v[14:15], v[14:15], s[60:61]
    v_pk_mul_f32 v[40:41], v[8:9], v[40:41] neg_lo:[1,0] neg_hi:[1,0]
    v_pk_mul_f32 v[42:43], v[10:11], v[42:43] neg_lo:[1,0] neg_hi:[1,0]
    v_pk_mul_f32 v[44:45], v[12:13], v[44:45] neg_lo:[1,0] neg_hi:[1,0]
    v_pk_mul_f32 v[46:47], v[14:15], v[46:47] neg_lo:[1,0] neg_hi:[1,0]
    v_rcp_f32 v48, v48
    s_waitcnt lgkmcnt(13)
    v_mfma_f32_16x16x32_bf16 v[16:19], v[184:187], v[84:87], v[16:19]
    v_cvt_pk_bf16_f32 v56, v24, v25
    v_cvt_pk_bf16_f32 v57, v26, v27
    v_rcp_f32 v49, v49
    v_mfma_f32_16x16x32_bf16 v[16:19], v[188:191], v[88:91], v[16:19]
    v_cvt_pk_bf16_f32 v58, v28, v29
    v_cvt_pk_bf16_f32 v59, v30, v31
    v_rcp_f32 v50, v50
    v_mfma_f32_16x16x32_bf16 v[16:19], v[192:195], v[92:95], v[16:19]
    v_rcp_f32 v51, v51
    v_rcp_f32 v52, v52
    v_mfma_f32_16x16x32_bf16 v[20:23], v[196:199], v[84:87], v[20:23]
    v_rcp_f32 v53, v53
    v_rcp_f32 v54, v54
    v_mfma_f32_16x16x32_bf16 v[20:23], v[200:203], v[88:91], v[20:23]
    v_rcp_f32 v55, v55
    v_exp_f32 v40, v40
    v_mfma_f32_16x16x32_bf16 v[20:23], v[204:207], v[92:95], v[20:23]
    v_exp_f32 v41, v41
    v_exp_f32 v42, v42
    v_exp_f32 v43, v43
    s_waitcnt lgkmcnt(0)
    v_mfma_f32_16x16x32_bf16 v[60:63], v[208:211], v[56:59], v[60:63]
    v_exp_f32 v44, v44
    v_exp_f32 v45, v45
    v_mfma_f32_16x16x32_bf16 v[64:67], v[212:215], v[56:59], v[64:67]
    v_exp_f32 v46, v46
    v_exp_f32 v47, v47
    v_mfma_f32_16x16x32_bf16 v[68:71], v[216:219], v[56:59], v[68:71]
    v_rcp_f32 v112, v112
    v_rcp_f32 v113, v113
    v_mfma_f32_16x16x32_bf16 v[72:75], v[220:223], v[56:59], v[72:75]
    v_rcp_f32 v114, v114
    v_rcp_f32 v115, v115
    v_mfma_f32_16x16x32_bf16 v[76:79], v[224:227], v[56:59], v[76:79]
    v_rcp_f32 v116, v116
    v_rcp_f32 v117, v117
    v_mfma_f32_16x16x32_bf16 v[80:83], v[228:231], v[56:59], v[80:83]
    v_rcp_f32 v118, v118
    v_rcp_f32 v119, v119
    v_add_u32 v232, 61760, v232
    v_add_u32 v237, 61760, v237
    ds_read_b128 v[24:27], v240 offset:1280
    ds_read_b128 v[28:31], v240 offset:1344
    ds_read_b64_tr_b16 v[184:185], v232 offset:0
    ds_read_b64_tr_b16 v[186:187], v232 offset:1024
    ds_read_b64_tr_b16 v[188:189], v232 offset:2048
    ds_read_b64_tr_b16 v[190:191], v232 offset:3072
    ds_read_b64_tr_b16 v[192:193], v232 offset:4096
    ds_read_b64_tr_b16 v[194:195], v232 offset:5120
    ds_read_b64_tr_b16 v[196:197], v237 offset:0
    ds_read_b64_tr_b16 v[198:199], v237 offset:1024
    ds_read_b64_tr_b16 v[200:201], v237 offset:2048
    ds_read_b64_tr_b16 v[202:203], v237 offset:3072
    ds_read_b64_tr_b16 v[204:205], v237 offset:4096
    ds_read_b64_tr_b16 v[206:207], v237 offset:5120
    ds_read_b64_tr_b16 v[208:209], v233 offset:24704
    ds_read_b64_tr_b16 v[210:211], v233 offset:27808
    ds_read_b64_tr_b16 v[212:213], v233 offset:24712
    ds_read_b64_tr_b16 v[214:215], v233 offset:27816
    ds_read_b64_tr_b16 v[216:217], v233 offset:24768
    ds_read_b64_tr_b16 v[218:219], v233 offset:27872
    ds_read_b64_tr_b16 v[220:221], v233 offset:24776
    ds_read_b64_tr_b16 v[222:223], v233 offset:27880
    ds_read_b64_tr_b16 v[224:225], v233 offset:24832
    ds_read_b64_tr_b16 v[226:227], v233 offset:27936
    ds_read_b64_tr_b16 v[228:229], v233 offset:24840
    ds_read_b64_tr_b16 v[230:231], v233 offset:27944
    ds_read_b32 v5, v245
    v_pk_mul_f32 v[32:33], v[32:33], v[48:49]
    v_pk_mul_f32 v[34:35], v[34:35], v[50:51]
    v_pk_mul_f32 v[36:37], v[36:37], v[52:53]
    v_pk_mul_f32 v[38:39], v[38:39], v[54:55]
    v_pk_add_f32 v[40:41], v[40:41], s[62:63]
    v_pk_add_f32 v[42:43], v[42:43], s[62:63]
    v_pk_add_f32 v[44:45], v[44:45], s[62:63]
    v_pk_add_f32 v[46:47], v[46:47], s[62:63]
    v_pk_mul_f32 v[96:97], v[96:97], v[112:113]
    v_pk_mul_f32 v[98:99], v[98:99], v[114:115]
    v_pk_mul_f32 v[100:101], v[100:101], v[116:117]
    v_pk_mul_f32 v[102:103], v[102:103], v[118:119]
    v_pk_fma_f32 v[48:49], v[16:17], v[16:17], s[60:61]
    v_pk_fma_f32 v[50:51], v[18:19], v[18:19], s[60:61]
    v_pk_fma_f32 v[52:53], v[20:21], v[20:21], s[60:61]
    v_pk_fma_f32 v[54:55], v[22:23], v[22:23], s[60:61]
    v_pk_mul_f32 v[48:49], v[16:17], v[48:49] neg_lo:[1,0] neg_hi:[1,0]
    v_pk_mul_f32 v[50:51], v[18:19], v[50:51] neg_lo:[1,0] neg_hi:[1,0]
    v_pk_mul_f32 v[52:53], v[20:21], v[52:53] neg_lo:[1,0] neg_hi:[1,0]
    v_pk_mul_f32 v[54:55], v[22:23], v[54:55] neg_lo:[1,0] neg_hi:[1,0]
    v_rcp_f32 v40, v40
    s_waitcnt lgkmcnt(13)
    v_mfma_f32_16x16x32_bf16 v[24:27], v[184:187], v[84:87], v[24:27]
    v_cvt_pk_bf16_f32 v56, v32, v33
    v_cvt_pk_bf16_f32 v57, v34, v35
    v_mfma_f32_16x16x32_bf16 v[24:27], v[188:191], v[88:91], v[24:27]
    v_rcp_f32 v41, v41
    v_mfma_f32_16x16x32_bf16 v[24:27], v[192:195], v[92:95], v[24:27]
    v_cvt_pk_bf16_f32 v58, v36, v37
    v_cvt_pk_bf16_f32 v59, v38, v39
    v_mfma_f32_16x16x32_bf16 v[28:31], v[196:199], v[84:87], v[28:31]
    v_rcp_f32 v42, v42
    v_mfma_f32_16x16x32_bf16 v[28:31], v[200:203], v[88:91], v[28:31]
    v_cvt_pk_bf16_f32 v120, v96, v97
    v_cvt_pk_bf16_f32 v121, v98, v99
    v_mfma_f32_16x16x32_bf16 v[28:31], v[204:207], v[92:95], v[28:31]
    v_rcp_f32 v43, v43
    v_cvt_pk_bf16_f32 v122, v100, v101
    s_waitcnt lgkmcnt(0)
    v_mfma_f32_16x16x32_bf16 v[60:63], v[208:211], v[56:59], v[60:63]
    v_cvt_pk_bf16_f32 v123, v102, v103
    v_mfma_f32_16x16x32_bf16 v[64:67], v[212:215], v[56:59], v[64:67]
    v_rcp_f32 v44, v44
    v_mfma_f32_16x16x32_bf16 v[68:71], v[216:219], v[56:59], v[68:71]
    v_rcp_f32 v45, v45
    v_rcp_f32 v46, v46
    v_mfma_f32_16x16x32_bf16 v[72:75], v[220:223], v[56:59], v[72:75]
    v_rcp_f32 v47, v47
    v_mfma_f32_16x16x32_bf16 v[76:79], v[224:227], v[56:59], v[76:79]
    v_exp_f32 v48, v48
    v_mfma_f32_16x16x32_bf16 v[80:83], v[228:231], v[56:59], v[80:83]
    v_exp_f32 v49, v49
    v_mfma_f32_16x16x32_bf16 v[132:135], v[208:211], v[120:123], v[132:135]
    v_exp_f32 v50, v50
    v_mfma_f32_16x16x32_bf16 v[136:139], v[212:215], v[120:123], v[136:139]
    v_exp_f32 v51, v51
    v_mfma_f32_16x16x32_bf16 v[140:143], v[216:219], v[120:123], v[140:143]
    v_exp_f32 v52, v52
    v_mfma_f32_16x16x32_bf16 v[144:147], v[220:223], v[120:123], v[144:147]
    v_exp_f32 v53, v53
    v_mfma_f32_16x16x32_bf16 v[148:151], v[224:227], v[120:123], v[148:151]
    v_exp_f32 v54, v54
    v_mfma_f32_16x16x32_bf16 v[152:155], v[228:231], v[120:123], v[152:155]
    v_exp_f32 v55, v55
    v_cmp_le_u32 vcc, 7, v5
    s_cmp_eq_u64 vcc, -1
    s_cbranch_scc1 L_gate_N3_9_ok
L_gate_N3_9:
    ds_read_b32 v5, v245
    s_waitcnt lgkmcnt(0)
    v_cmp_le_u32 vcc, 7, v5
    s_cmp_eq_u64 vcc, -1
    s_cbranch_scc0 L_gate_N3_9
L_gate_N3_9_ok:
    s_nop 0
    ds_read_b128 v[32:35], v240 offset:1408
    ds_read_b128 v[36:39], v240 offset:1472
    ds_read_b128 v[96:99], v240 offset:1408
    ds_read_b128 v[100:103], v240 offset:1472
    ds_read_b64_tr_b16 v[184:185], v232 offset:12352
    ds_read_b64_tr_b16 v[186:187], v232 offset:13376
    ds_read_b64_tr_b16 v[188:189], v232 offset:14400
    ds_read_b64_tr_b16 v[190:191], v232 offset:15424
    ds_read_b64_tr_b16 v[192:193], v232 offset:16448
    ds_read_b64_tr_b16 v[194:195], v232 offset:17472
    ds_read_b64_tr_b16 v[196:197], v237 offset:12352
    ds_read_b64_tr_b16 v[198:199], v237 offset:13376
    ds_read_b64_tr_b16 v[200:201], v237 offset:14400
    ds_read_b64_tr_b16 v[202:203], v237 offset:15424
    ds_read_b64_tr_b16 v[204:205], v237 offset:16448
    ds_read_b64_tr_b16 v[206:207], v237 offset:17472
    ds_read_b64_tr_b16 v[208:209], v233 offset:37056
    ds_read_b64_tr_b16 v[210:211], v233 offset:40160
    ds_read_b64_tr_b16 v[212:213], v233 offset:37064
    ds_read_b64_tr_b16 v[214:215], v233 offset:40168
    ds_read_b64_tr_b16 v[216:217], v233 offset:37120
    ds_read_b64_tr_b16 v[218:219], v233 offset:40224
    ds_read_b64_tr_b16 v[220:221], v233 offset:37128
    ds_read_b64_tr_b16 v[222:223], v233 offset:40232
    ds_read_b64_tr_b16 v[224:225], v233 offset:37184
    ds_read_b64_tr_b16 v[226:227], v233 offset:40288
    ds_read_b64_tr_b16 v[228:229], v233 offset:37192
    ds_read_b64_tr_b16 v[230:231], v233 offset:40296
    v_pk_mul_f32 v[8:9], v[8:9], v[40:41]
    v_pk_mul_f32 v[10:11], v[10:11], v[42:43]
    v_pk_mul_f32 v[12:13], v[12:13], v[44:45]
    v_pk_mul_f32 v[14:15], v[14:15], v[46:47]
    v_pk_add_f32 v[48:49], v[48:49], s[62:63]
    v_pk_add_f32 v[50:51], v[50:51], s[62:63]
    v_pk_add_f32 v[52:53], v[52:53], s[62:63]
    v_pk_add_f32 v[54:55], v[54:55], s[62:63]
    v_pk_fma_f32 v[40:41], v[24:25], v[24:25], s[60:61]
    v_pk_fma_f32 v[42:43], v[26:27], v[26:27], s[60:61]
    v_pk_fma_f32 v[44:45], v[28:29], v[28:29], s[60:61]
    v_pk_fma_f32 v[46:47], v[30:31], v[30:31], s[60:61]
    v_pk_mul_f32 v[40:41], v[24:25], v[40:41] neg_lo:[1,0] neg_hi:[1,0]
    v_pk_mul_f32 v[42:43], v[26:27], v[42:43] neg_lo:[1,0] neg_hi:[1,0]
    v_pk_mul_f32 v[44:45], v[28:29], v[44:45] neg_lo:[1,0] neg_hi:[1,0]
    v_pk_mul_f32 v[46:47], v[30:31], v[46:47] neg_lo:[1,0] neg_hi:[1,0]
    v_rcp_f32 v48, v48
    s_waitcnt lgkmcnt(12)
    v_mfma_f32_16x16x32_bf16 v[32:35], v[184:187], v[84:87], v[32:35]
    v_cvt_pk_bf16_f32 v56, v8, v9
    v_cvt_pk_bf16_f32 v57, v10, v11
    v_mfma_f32_16x16x32_bf16 v[32:35], v[188:191], v[88:91], v[32:35]
    v_rcp_f32 v49, v49
    v_mfma_f32_16x16x32_bf16 v[32:35], v[192:195], v[92:95], v[32:35]
    v_cvt_pk_bf16_f32 v58, v12, v13
    v_cvt_pk_bf16_f32 v59, v14, v15
    v_mfma_f32_16x16x32_bf16 v[36:39], v[196:199], v[84:87], v[36:39]
    v_rcp_f32 v50, v50
    v_mfma_f32_16x16x32_bf16 v[36:39], v[200:203], v[88:91], v[36:39]
    v_rcp_f32 v51, v51
    v_mfma_f32_16x16x32_bf16 v[36:39], v[204:207], v[92:95], v[36:39]
    v_rcp_f32 v52, v52
    v_mfma_f32_16x16x32_bf16 v[96:99], v[184:187], v[156:159], v[96:99]
    v_rcp_f32 v53, v53
    v_mfma_f32_16x16x32_bf16 v[96:99], v[188:191], v[160:163], v[96:99]
    v_rcp_f32 v54, v54
    v_mfma_f32_16x16x32_bf16 v[96:99], v[192:195], v[164:167], v[96:99]
    v_rcp_f32 v55, v55
    v_mfma_f32_16x16x32_bf16 v[100:103], v[196:199], v[156:159], v[100:103]
    v_mfma_f32_16x16x32_bf16 v[100:103], v[200:203], v[160:163], v[100:103]
    v_exp_f32 v40, v40
    v_mfma_f32_16x16x32_bf16 v[100:103], v[204:207], v[164:167], v[100:103]
    v_exp_f32 v41, v41
    s_waitcnt lgkmcnt(0)
    v_mfma_f32_16x16x32_bf16 v[60:63], v[208:211], v[56:59], v[60:63]
    v_exp_f32 v42, v42
    v_mfma_f32_16x16x32_bf16 v[64:67], v[212:215], v[56:59], v[64:67]
    v_exp_f32 v43, v43
    v_mfma_f32_16x16x32_bf16 v[68:71], v[216:219], v[56:59], v[68:71]
    v_exp_f32 v44, v44
    v_mfma_f32_16x16x32_bf16 v[72:75], v[220:223], v[56:59], v[72:75]
    v_exp_f32 v45, v45
    v_mfma_f32_16x16x32_bf16 v[76:79], v[224:227], v[56:59], v[76:79]
    v_exp_f32 v46, v46
    v_mfma_f32_16x16x32_bf16 v[80:83], v[228:231], v[56:59], v[80:83]
    v_exp_f32 v47, v47
    ds_read_b64_tr_b16 v[208:209], v233 offset:49408
    ds_read_b64_tr_b16 v[210:211], v233 offset:52512
    ds_read_b64_tr_b16 v[212:213], v233 offset:49416
    ds_read_b64_tr_b16 v[214:215], v233 offset:52520
    ds_read_b64_tr_b16 v[216:217], v233 offset:49472
    ds_read_b64_tr_b16 v[218:219], v233 offset:52576
    ds_read_b64_tr_b16 v[220:221], v233 offset:49480
    ds_read_b64_tr_b16 v[222:223], v233 offset:52584
    ds_read_b64_tr_b16 v[224:225], v233 offset:49536
    ds_read_b64_tr_b16 v[226:227], v233 offset:52640
    ds_read_b64_tr_b16 v[228:229], v233 offset:49544
    ds_read_b64_tr_b16 v[230:231], v233 offset:52648
    buffer_load_dwordx4 v[184:187], v255, s[20:23], s55 offen offset:0
    buffer_load_dwordx4 v[188:191], v255, s[20:23], s55 offen offset:64
    buffer_load_dwordx4 v[192:195], v255, s[20:23], s55 offen offset:128
    s_setprio 3
    s_nop 0
    v_pk_mul_f32 v[16:17], v[16:17], v[48:49]
    v_pk_mul_f32 v[18:19], v[18:19], v[50:51]
    v_pk_mul_f32 v[20:21], v[20:21], v[52:53]
    v_pk_mul_f32 v[22:23], v[22:23], v[54:55]
    v_pk_add_f32 v[40:41], v[40:41], s[62:63]
    v_pk_add_f32 v[42:43], v[42:43], s[62:63]
    v_pk_add_f32 v[44:45], v[44:45], s[62:63]
    v_pk_add_f32 v[46:47], v[46:47], s[62:63]
    v_pk_fma_f32 v[48:49], v[32:33], v[32:33], s[60:61]
    v_pk_fma_f32 v[50:51], v[34:35], v[34:35], s[60:61]
    v_pk_fma_f32 v[52:53], v[36:37], v[36:37], s[60:61]
    v_pk_fma_f32 v[54:55], v[38:39], v[38:39], s[60:61]
    v_pk_mul_f32 v[48:49], v[32:33], v[48:49] neg_lo:[1,0] neg_hi:[1,0]
    v_pk_mul_f32 v[50:51], v[34:35], v[50:51] neg_lo:[1,0] neg_hi:[1,0]
    v_pk_mul_f32 v[52:53], v[36:37], v[52:53] neg_lo:[1,0] neg_hi:[1,0]
    v_pk_mul_f32 v[54:55], v[38:39], v[54:55] neg_lo:[1,0] neg_hi:[1,0]
    v_pk_fma_f32 v[112:113], v[96:97], v[96:97], s[60:61]
    v_pk_fma_f32 v[114:115], v[98:99], v[98:99], s[60:61]
    v_pk_fma_f32 v[116:117], v[100:101], v[100:101], s[60:61]
    v_pk_fma_f32 v[118:119], v[102:103], v[102:103], s[60:61]
    v_pk_mul_f32 v[112:113], v[96:97], v[112:113] neg_lo:[1,0] neg_hi:[1,0]
    v_pk_mul_f32 v[114:115], v[98:99], v[114:115] neg_lo:[1,0] neg_hi:[1,0]
    v_pk_mul_f32 v[116:117], v[100:101], v[116:117] neg_lo:[1,0] neg_hi:[1,0]
    v_pk_mul_f32 v[118:119], v[102:103], v[118:119] neg_lo:[1,0] neg_hi:[1,0]
    v_cvt_pk_bf16_f32 v56, v16, v17
    v_cvt_pk_bf16_f32 v57, v18, v19
    v_cvt_pk_bf16_f32 v58, v20, v21
    v_cvt_pk_bf16_f32 v59, v22, v23
    v_rcp_f32 v40, v40
    v_rcp_f32 v41, v41
    s_waitcnt lgkmcnt(0)
    v_mfma_f32_16x16x32_bf16 v[60:63], v[208:211], v[56:59], v[60:63]
    v_rcp_f32 v42, v42
    v_rcp_f32 v43, v43
    v_rcp_f32 v44, v44
    v_rcp_f32 v45, v45
    v_mfma_f32_16x16x32_bf16 v[64:67], v[212:215], v[56:59], v[64:67]
    v_rcp_f32 v46, v46
    v_rcp_f32 v47, v47
    v_exp_f32 v48, v48
    v_mfma_f32_16x16x32_bf16 v[68:71], v[216:219], v[56:59], v[68:71]
    v_exp_f32 v49, v49
    v_exp_f32 v50, v50
    v_exp_f32 v51, v51
    v_exp_f32 v52, v52
    v_mfma_f32_16x16x32_bf16 v[72:75], v[220:223], v[56:59], v[72:75]
    v_exp_f32 v53, v53
    v_exp_f32 v54, v54
    v_exp_f32 v55, v55
    v_exp_f32 v112, v112
    v_mfma_f32_16x16x32_bf16 v[76:79], v[224:227], v[56:59], v[76:79]
    v_exp_f32 v113, v113
    v_exp_f32 v114, v114
    v_exp_f32 v115, v115
    v_mfma_f32_16x16x32_bf16 v[80:83], v[228:231], v[56:59], v[80:83]
    v_exp_f32 v116, v116
    v_exp_f32 v117, v117
    v_exp_f32 v118, v118
    v_exp_f32_e64 v119, v119
    v_add_u32 v233, 61760, v233
    ds_read_b64_tr_b16 v[208:209], v233 offset:0
    ds_read_b64_tr_b16 v[210:211], v233 offset:3104
    ds_read_b64_tr_b16 v[212:213], v233 offset:8
    ds_read_b64_tr_b16 v[214:215], v233 offset:3112
    ds_read_b64_tr_b16 v[216:217], v233 offset:64
    ds_read_b64_tr_b16 v[218:219], v233 offset:3168
    ds_read_b64_tr_b16 v[220:221], v233 offset:72
    ds_read_b64_tr_b16 v[222:223], v233 offset:3176
    ds_read_b64_tr_b16 v[224:225], v233 offset:128
    ds_read_b64_tr_b16 v[226:227], v233 offset:3232
    ds_read_b64_tr_b16 v[228:229], v233 offset:136
    ds_read_b64_tr_b16 v[230:231], v233 offset:3240
    v_pk_mul_f32 v[24:25], v[24:25], v[40:41]
    v_pk_mul_f32 v[26:27], v[26:27], v[42:43]
    v_pk_mul_f32 v[28:29], v[28:29], v[44:45]
    v_pk_mul_f32 v[30:31], v[30:31], v[46:47]
    v_pk_add_f32 v[48:49], v[48:49], s[62:63]
    v_pk_add_f32 v[50:51], v[50:51], s[62:63]
    v_pk_add_f32 v[52:53], v[52:53], s[62:63]
    v_pk_add_f32 v[54:55], v[54:55], s[62:63]
    v_pk_add_f32 v[112:113], v[112:113], s[62:63]
    v_pk_add_f32 v[114:115], v[114:115], s[62:63]
    v_pk_add_f32 v[116:117], v[116:117], s[62:63]
    v_pk_add_f32 v[118:119], v[118:119], s[62:63]
    v_cvt_pk_bf16_f32 v56, v24, v25
    v_cvt_pk_bf16_f32 v57, v26, v27
    v_cvt_pk_bf16_f32 v58, v28, v29
    v_cvt_pk_bf16_f32 v59, v30, v31
    v_rcp_f32 v48, v48
    v_rcp_f32 v49, v49
    s_waitcnt lgkmcnt(0)
    v_mfma_f32_16x16x32_bf16 v[60:63], v[208:211], v[56:59], v[60:63]
    v_rcp_f32 v50, v50
    v_rcp_f32 v51, v51
    v_mfma_f32_16x16x32_bf16 v[64:67], v[212:215], v[56:59], v[64:67]
    v_rcp_f32 v52, v52
    v_rcp_f32 v53, v53
    v_rcp_f32 v54, v54
    v_mfma_f32_16x16x32_bf16 v[68:71], v[216:219], v[56:59], v[68:71]
    v_rcp_f32 v55, v55
    v_rcp_f32 v112, v112
    v_mfma_f32_16x16x32_bf16 v[72:75], v[220:223], v[56:59], v[72:75]
    v_rcp_f32 v113, v113
    v_rcp_f32 v114, v114
    v_mfma_f32_16x16x32_bf16 v[76:79], v[224:227], v[56:59], v[76:79]
    v_rcp_f32 v115, v115
    v_rcp_f32 v116, v116
    v_rcp_f32 v117, v117
    v_mfma_f32_16x16x32_bf16 v[80:83], v[228:231], v[56:59], v[80:83]
    v_rcp_f32 v118, v118
    v_rcp_f32_e64 v119, v119
    ds_read_b64_tr_b16 v[208:209], v233 offset:12352
    ds_read_b64_tr_b16 v[210:211], v233 offset:15456
    ds_read_b64_tr_b16 v[212:213], v233 offset:12360
    ds_read_b64_tr_b16 v[214:215], v233 offset:15464
    ds_read_b64_tr_b16 v[216:217], v233 offset:12416
    ds_read_b64_tr_b16 v[218:219], v233 offset:15520
    ds_read_b64_tr_b16 v[220:221], v233 offset:12424
    ds_read_b64_tr_b16 v[222:223], v233 offset:15528
    ds_read_b64_tr_b16 v[224:225], v233 offset:12480
    ds_read_b64_tr_b16 v[226:227], v233 offset:15584
    ds_read_b64_tr_b16 v[228:229], v233 offset:12488
    ds_read_b64_tr_b16 v[230:231], v233 offset:15592
    v_pk_mul_f32 v[32:33], v[32:33], v[48:49]
    v_pk_mul_f32 v[34:35], v[34:35], v[50:51]
    v_pk_mul_f32 v[36:37], v[36:37], v[52:53]
    v_pk_mul_f32 v[38:39], v[38:39], v[54:55]
    v_pk_mul_f32 v[96:97], v[96:97], v[112:113]
    v_pk_mul_f32 v[98:99], v[98:99], v[114:115]
    v_pk_mul_f32 v[100:101], v[100:101], v[116:117]
    v_pk_mul_f32 v[102:103], v[102:103], v[118:119]
    ds_read_b128 v[168:171], v241 offset:512
    ds_read_b128 v[172:175], v241 offset:528
    ds_read_b128 v[176:179], v241 offset:640
    ds_read_b128 v[180:183], v241 offset:656
    ds_read_b128 v[84:87], v241 offset:768
    ds_read_b128 v[88:91], v241 offset:784
    s_waitcnt vmcnt(0)
    v_cvt_pk_bf16_f32 v56, v32, v33
    v_cvt_pk_bf16_f32 v57, v34, v35
    v_cvt_pk_bf16_f32 v58, v36, v37
    v_cvt_pk_bf16_f32 v59, v38, v39
    v_cvt_pk_bf16_f32 v120, v96, v97
    v_cvt_pk_bf16_f32 v121, v98, v99
    v_cvt_pk_bf16_f32 v122, v100, v101
    v_cvt_pk_bf16_f32 v123, v102, v103
    v_lshlrev_b32 v8, 16, v184
    v_and_b32 v9, v7, v184
    s_waitcnt lgkmcnt(6)
    v_mfma_f32_16x16x32_bf16 v[60:63], v[208:211], v[56:59], v[60:63]
    v_lshlrev_b32 v10, 16, v185
    v_and_b32 v11, v7, v185
    v_mfma_f32_16x16x32_bf16 v[64:67], v[212:215], v[56:59], v[64:67]
    v_lshlrev_b32 v12, 16, v186
    v_and_b32 v13, v7, v186
    v_mfma_f32_16x16x32_bf16 v[68:71], v[216:219], v[56:59], v[68:71]
    v_lshlrev_b32 v14, 16, v187
    v_and_b32 v15, v7, v187
    v_mfma_f32_16x16x32_bf16 v[72:75], v[220:223], v[56:59], v[72:75]
    v_lshlrev_b32 v16, 16, v188
    v_mfma_f32_16x16x32_bf16 v[76:79], v[224:227], v[56:59], v[76:79]
    v_and_b32 v17, v7, v188
    v_lshlrev_b32 v18, 16, v189
    v_mfma_f32_16x16x32_bf16 v[80:83], v[228:231], v[56:59], v[80:83]
    v_and_b32 v19, v7, v189
    v_lshlrev_b32 v20, 16, v190
    v_mfma_f32_16x16x32_bf16 v[132:135], v[208:211], v[120:123], v[132:135]
    v_and_b32 v21, v7, v190
    v_lshlrev_b32 v22, 16, v191
    v_mfma_f32_16x16x32_bf16 v[136:139], v[212:215], v[120:123], v[136:139]
    v_and_b32 v23, v7, v191
    v_lshlrev_b32 v24, 16, v192
    v_mfma_f32_16x16x32_bf16 v[140:143], v[216:219], v[120:123], v[140:143]
    v_and_b32 v25, v7, v192
    v_lshlrev_b32 v26, 16, v193
    v_mfma_f32_16x16x32_bf16 v[144:147], v[220:223], v[120:123], v[144:147]
    v_and_b32 v27, v7, v193
    v_mfma_f32_16x16x32_bf16 v[148:151], v[224:227], v[120:123], v[148:151]
    v_lshlrev_b32 v28, 16, v194
    v_and_b32 v29, v7, v194
    v_mfma_f32_16x16x32_bf16 v[152:155], v[228:231], v[120:123], v[152:155]
    v_lshlrev_b32 v30, 16, v195
    v_and_b32 v31, v7, v195
    s_mov_b64 exec, s[52:53]
    s_nop 2
    ds_write_b128 v238, v[132:135] offset:4608
    ds_write_b128 v238, v[136:139] offset:4864
    ds_write_b128 v238, v[140:143] offset:5120
    ds_write_b128 v238, v[144:147] offset:5376
    ds_write_b128 v238, v[148:151] offset:5632
    ds_write_b128 v238, v[152:155] offset:5888
    s_mov_b64 exec, -1
    v_mov_b32 v4, 8
    ds_write_b32 v244, v4
    s_waitcnt lgkmcnt(0)
    s_nop 3
    v_pk_fma_f32 v[8:9], v[60:61], v[168:169], v[8:9]
    v_pk_fma_f32 v[10:11], v[62:63], v[170:171], v[10:11]
    v_pk_fma_f32 v[12:13], v[64:65], v[172:173], v[12:13]
    v_pk_fma_f32 v[14:15], v[66:67], v[174:175], v[14:15]
    v_cvt_pk_bf16_f32 v208, v8, v9
    v_cvt_pk_bf16_f32 v209, v10, v11
    v_cvt_pk_bf16_f32 v210, v12, v13
    v_cvt_pk_bf16_f32 v211, v14, v15
    ds_write_b128 v254, v[208:211] offset:0
    v_pk_fma_f32 v[16:17], v[68:69], v[176:177], v[16:17]
    v_pk_fma_f32 v[18:19], v[70:71], v[178:179], v[18:19]
    v_pk_fma_f32 v[20:21], v[72:73], v[180:181], v[20:21]
    v_pk_fma_f32 v[22:23], v[74:75], v[182:183], v[22:23]
    v_cvt_pk_bf16_f32 v212, v16, v17
    v_cvt_pk_bf16_f32 v213, v18, v19
    v_cvt_pk_bf16_f32 v214, v20, v21
    v_cvt_pk_bf16_f32 v215, v22, v23
    ds_write_b128 v254, v[212:215] offset:64
    v_pk_fma_f32 v[24:25], v[76:77], v[84:85], v[24:25]
    v_pk_fma_f32 v[26:27], v[78:79], v[86:87], v[26:27]
    v_pk_fma_f32 v[28:29], v[80:81], v[88:89], v[28:29]
    v_pk_fma_f32 v[30:31], v[82:83], v[90:91], v[30:31]
    v_cvt_pk_bf16_f32 v216, v24, v25
    v_cvt_pk_bf16_f32 v217, v26, v27
    v_cvt_pk_bf16_f32 v218, v28, v29
    v_cvt_pk_bf16_f32 v219, v30, v31
    ds_write_b128 v254, v[216:219] offset:128
    s_waitcnt lgkmcnt(0)
    ds_read_b128 v[184:187], v243 offset:0
    ds_read_b128 v[188:191], v243 offset:1024
    ds_read_b128 v[192:195], v243 offset:2048
    s_waitcnt lgkmcnt(2)
    buffer_store_dwordx4 v[184:187], v248, s[36:39], s55 offen sc1
    s_waitcnt lgkmcnt(1)
    buffer_store_dwordx4 v[188:191], v249, s[36:39], s55 offen sc1
    s_waitcnt lgkmcnt(0)
    buffer_store_dwordx4 v[192:195], v250, s[36:39], s55 offen sc1
    s_endpgm
L_end:
    s_endpgm
L_code_end:
.p2align 7
.type L_tab,@object
L_tab:
.long 0,6144,62792,118344,8,6160,62800,118352,16,6176,62808,118360,24,6192,62816,118368
.long 64,6336,62824,118376,72,6352,62832,118384,80,6368,62840,118392,88,6384,62848,118400
.long 128,6528,62856,118408,136,6544,62864,118416,144,6560,62872,118424,152,6576,62880,118432
.long 192,6720,62888,118440,200,6736,62896,118448,208,6752,62904,118456,216,6768,62912,118464
.long 288,6920,66264,121816,296,6936,66272,121824,304,6952,66280,121832,312,6968,66288,121840
.long 352,7112,66296,121848,360,7128,66304,121856,368,7144,66312,121864,376,7160,66320,121872
.long 416,7304,66328,121880,424,7320,66336,121888,432,7336,66344,121896,440,7352,66352,121904
.long 480,7496,66360,121912,488,7512,66368,121920,496,7528,66376,121928,504,7544,66384,121936
.long 512,7696,69736,125288,520,7712,69744,125296,528,7728,69752,125304,536,7744,69760,125312
.long 576,7888,69768,125320,584,7904,69776,125328,592,7920,69784,125336,600,7936,69792,125344
.long 640,8080,69800,125352,648,8096,69808,125360,656,8112,69816,125368,664,8128,69824,125376
.long 704,8272,69832,125384,712,8288,69840,125392,720,8304,69848,125400,728,8320,69856,125408
.long 800,8472,73208,128760,808,8488,73216,128768,816,8504,73224,128776,824,8520,73232,128784
.long 864,8664,73240,128792,872,8680,73248,128800,880,8696,73256,128808,888,8712,73264,128816
.long 928,8856,73272,128824,936,8872,73280,128832,944,8888,73288,128840,952,8904,73296,128848
.long 992,9048,73304,128856,1000,9064,73312,128864,1008,9080,73320,128872,1016,9096,73328,128880
.long 0,32,150784,61760,16,40,150800,61776,32,48,150816,61792,48,56,150832,61808
.long 768,96,150784,61824,784,104,150800,61840,800,112,150816,61856,816,120,150832,63536
.long 1536,160,150784,62664,1552,168,150800,62680,1568,176,150816,62696,1584,184,150832,62712
.long 2304,224,150784,62728,2320,232,150800,62744,2336,240,150816,62760,2352,248,150832,63672
.long 3104,256,150848,61768,3120,264,150864,61784,3072,272,150880,61800,3088,280,150896,61816
.long 3872,320,150848,61832,3888,328,150864,61848,3840,336,150880,61864,3856,344,150896,63544
.long 4640,384,150848,62672,4656,392,150864,62688,4608,400,150880,62704,4624,408,150896,62720
.long 5408,448,150848,62736,5424,456,150864,62752,5376,464,150880,62768,5392,472,150896,63680
.long 6144,544,150912,61872,6160,552,150928,61888,6176,560,150944,61904,6192,568,150960,61920
.long 6912,608,150912,61936,6928,616,150928,61952,6944,624,150944,61968,6960,632,150960,63648
.long 7680,672,150912,62776,7696,680,150928,62792,7712,688,150944,62808,7728,696,150960,62824
.long 8448,736,150912,62840,8464,744,150928,62856,8480,752,150944,62872,8496,760,150960,63784
.long 9248,768,150976,61880,9264,776,150992,61896,9216,784,151008,61912,9232,792,151024,61928
.long 10016,832,150976,61944,10032,840,150992,61960,9984,848,151008,61976,10000,856,151024,63656
.long 10784,896,150976,62784,10800,904,150992,62800,10752,912,151008,62816,10768,920,151024,62832
.long 11552,960,150976,62848,11568,968,150992,62864,11520,976,151008,62880,11536,984,151024,63792
.long 387456,388512,389520,561024,387472,388528,389504,561216,387488,388480,389552,561408,387504,388496,389536,561600
.long 387520,388576,389584,1073741824,387536,388592,389568,1073741824,387552,388544,389616,1073741824,387568,388560,389600,1073741824
.long 387584,388656,389648,1073741824,387600,388640,389632,1073741824,387616,388624,389680,1073741824,387632,388608,389664,1073741824
.long 387648,388720,389712,1073741824,387664,388704,389696,1073741824,387680,388688,389744,1073741824,387696,388672,389728,1073741824
.long 387712,388784,430112,561040,387728,388768,430128,561232,387744,388752,430080,561424,387760,388736,430096,561616
.long 387776,388848,430176,1073741824,387792,388832,430192,1073741824,387808,388816,430144,1073741824,387824,388800,430160,1073741824
.long 387856,388912,430240,1073741824,387840,388896,430256,1073741824,387888,388880,430208,1073741824,387872,388864,430224,1073741824
.long 387920,388976,430304,1073741824,387904,388960,430320,1073741824,387952,388944,430272,1073741824,387936,388928,430288,1073741824
.long 387984,388992,430368,561056,387968,389008,430384,561248,388016,389024,430336,561440,388000,389040,430352,561632
.long 388048,389056,430432,1073741824,388032,389072,430448,1073741824,388080,389088,430400,1073741824,388064,389104,430416,1073741824
.long 388112,389120,430512,1073741824,388096,389136,430496,1073741824,388144,389152,430480,1073741824,388128,389168,430464,1073741824
.long 388176,389184,430576,1073741824,388160,389200,430560,1073741824,388208,389216,430544,1073741824,388192,389232,430528,1073741824
.long 388256,389248,430640,561072,388272,389264,430624,561264,388224,389280,430608,561456,388240,389296,430592,561648
.long 388320,389312,430704,1073741824,388336,389328,430688,1073741824,388288,389344,430672,1073741824,388304,389360,430656,1073741824
.long 388384,389392,430768,1073741824,388400,389376,430752,1073741824,388352,389424,430736,1073741824,388368,389408,430720,1073741824
.long 388448,389456,430832,1073741824,388464,389440,430816,1073741824,388416,389488,430800,1073741824,388432,389472,430784,1073741824
.long 0,0,24576,387456,0,0,24768,387648,0,0,24976,387840,0,0,25168,388032
.long 0,0,25376,388224,0,0,25568,388416,0,0,25776,388608,0,0,25968,388800
.long 0,0,26112,388992,0,0,26304,389184,0,0,26512,389376,0,0,26704,389568
.long 0,0,26912,430080,0,0,27104,430272,0,0,27312,430464,0,0,27504,430656
.long 0,0,24592,387472,0,0,24784,387664,0,0,24960,387856,0,0,25152,388048
.long 0,0,25392,388240,0,0,25584,388432,0,0,25760,388624,0,0,25952,388816
.long 0,0,26128,389008,0,0,26320,389200,0,0,26496,389392,0,0,26688,389584
.long 0,0,26928,430096,0,0,27120,430288,0,0,27296,430480,0,0,27488,430672
.long 0,0,24608,387488,0,0,24800,387680,0,0,25008,387872,0,0,25200,388064
.long 0,0,25344,388256,0,0,25536,388448,0,0,25744,388640,0,0,25936,388832
.long 0,0,26144,389024,0,0,26336,389216,0,0,26544,389408,0,0,26736,389600
.long 0,0,26880,430112,0,0,27072,430304,0,0,27280,430496,0,0,27472,430688
.long 0,0,24624,387504,0,0,24816,387696,0,0,24992,387888,0,0,25184,388080
.long 0,0,25360,388272,0,0,25552,388464,0,0,25728,388656,0,0,25920,388848
.long 0,0,26160,389040,0,0,26352,389232,0,0,26528,389424,0,0,26720,389616
.long 0,0,26896,430128,0,0,27088,430320,0,0,27264,430512,0,0,27456,430704
.long 0,6144,62920,118472,8,6160,62928,118480,16,6176,62936,118488,24,6192,62944,118496
.long 64,6336,62952,118504,72,6352,62960,118512,80,6368,62968,118520,88,6384,62976,118528
.long 128,6528,62984,118536,136,6544,62992,118544,144,6560,63000,118552,152,6576,63008,118560
.long 192,6720,63016,118568,200,6736,63024,118576,208,6752,63032,118584,216,6768,63040,118592
.long 288,6920,66392,121944,296,6936,66400,121952,304,6952,66408,121960,312,6968,66416,121968
.long 352,7112,66424,121976,360,7128,66432,121984,368,7144,66440,121992,376,7160,66448,122000
.long 416,7304,66456,122008,424,7320,66464,122016,432,7336,66472,122024,440,7352,66480,122032
.long 480,7496,66488,122040,488,7512,66496,122048,496,7528,66504,122056,504,7544,66512,122064
.long 512,7696,69864,125416,520,7712,69872,125424,528,7728,69880,125432,536,7744,69888,125440
.long 576,7888,69896,125448,584,7904,69904,125456,592,7920,69912,125464,600,7936,69920,125472
.long 640,8080,69928,125480,648,8096,69936,125488,656,8112,69944,125496,664,8128,69952,125504
.long 704,8272,69960,125512,712,8288,69968,125520,720,8304,69976,125528,728,8320,69984,125536
.long 800,8472,73336,128888,808,8488,73344,128896,816,8504,73352,128904,824,8520,73360,128912
.long 864,8664,73368,128920,872,8680,73376,128928,880,8696,73384,128936,888,8712,73392,128944
.long 928,8856,73400,128952,936,8872,73408,128960,944,8888,73416,128968,952,8904,73424,128976
.long 992,9048,73432,128984,1000,9064,73440,128992,1008,9080,73448,129000,1016,9096,73456,129008
.long 9248,32,150784,65232,9264,40,150800,65248,9216,48,150816,65264,9232,56,150832,65280
.long 10016,96,150784,65296,10032,104,150800,65312,9984,112,150816,65328,10000,120,150832,67008
.long 10784,160,150784,66136,10800,168,150800,66152,10752,176,150816,66168,10768,184,150832,66184
.long 11552,224,150784,66200,11568,232,150800,66216,11520,240,150816,66232,11536,248,150832,67144
.long 12288,256,150848,65240,12304,264,150864,65256,12320,272,150880,65272,12336,280,150896,65288
.long 13056,320,150848,65304,13072,328,150864,65320,13088,336,150880,65336,13104,344,150896,67016
.long 13824,384,150848,66144,13840,392,150864,66160,13856,400,150880,66176,13872,408,150896,66192
.long 14592,448,150848,66208,14608,456,150864,66224,14624,464,150880,66240,14640,472,150896,67152
.long 15392,544,150912,65344,15408,552,150928,65360,15360,560,150944,65376,15376,568,150960,65392
.long 16160,608,150912,65408,16176,616,150928,65424,16128,624,150944,65440,16144,632,150960,67120
.long 16928,672,150912,66248,16944,680,150928,66264,16896,688,150944,66280,16912,696,150960,66296
.long 17696,736,150912,66312,17712,744,150928,66328,17664,752,150944,66344,17680,760,150960,67256
.long 18432,768,150976,65352,18448,776,150992,65368,18464,784,151008,65384,18480,792,151024,65400
.long 19200,832,150976,65416,19216,840,150992,65432,19232,848,151008,65448,19248,856,151024,67128
.long 19968,896,150976,66256,19984,904,150992,66272,20000,912,151008,66288,20016,920,151024,66304
.long 20736,960,150976,66320,20752,968,150992,66336,20768,976,151008,66352,20784,984,151024,67264
.long 430848,431904,473232,561024,430864,431920,473216,561216,430880,431872,473264,561408,430896,431888,473248,561600
.long 430912,431968,473296,1073741824,430928,431984,473280,1073741824,430944,431936,473328,1073741824,430960,431952,473312,1073741824
.long 430976,432048,473360,1073741824,430992,432032,473344,1073741824,431008,432016,473392,1073741824,431024,432000,473376,1073741824
.long 431040,432112,473424,1073741824,431056,432096,473408,1073741824,431072,432080,473456,1073741824,431088,432064,473440,1073741824
.long 431104,432176,473504,561040,431120,432160,473520,561232,431136,432144,473472,561424,431152,432128,473488,561616
.long 431168,432240,473568,1073741824,431184,432224,473584,1073741824,431200,432208,473536,1073741824,431216,432192,473552,1073741824
.long 431248,432304,473632,1073741824,431232,432288,473648,1073741824,431280,432272,473600,1073741824,431264,432256,473616,1073741824
.long 431312,432368,473696,1073741824,431296,432352,473712,1073741824,431344,432336,473664,1073741824,431328,432320,473680,1073741824
.long 431376,432384,473760,561056,431360,432400,473776,561248,431408,432416,473728,561440,431392,432432,473744,561632
.long 431440,432448,473824,1073741824,431424,432464,473840,1073741824,431472,432480,473792,1073741824,431456,432496,473808,1073741824
.long 431504,432512,473904,1073741824,431488,432528,473888,1073741824,431536,432544,473872,1073741824,431520,432560,473856,1073741824
.long 431568,432576,473968,1073741824,431552,432592,473952,1073741824,431600,432608,473936,1073741824,431584,432624,473920,1073741824
.long 431648,432640,474032,561072,431664,432656,474016,561264,431616,432672,474000,561456,431632,432688,473984,561648
.long 431712,432704,474096,1073741824,431728,432720,474080,1073741824,431680,432736,474064,1073741824,431696,432752,474048,1073741824
.long 431776,473104,474160,1073741824,431792,473088,474144,1073741824,431744,473136,474128,1073741824,431760,473120,474112,1073741824
.long 431840,473168,474224,1073741824,431856,473152,474208,1073741824,431808,473200,474192,1073741824,431824,473184,474176,1073741824
.long 0,0,27648,430848,0,0,27840,431040,0,0,28048,431232,0,0,28240,431424
.long 0,0,28448,431616,0,0,28640,431808,0,0,28848,432000,0,0,29040,432192
.long 0,0,29184,432384,0,0,29376,432576,0,0,29584,473088,0,0,29776,473280
.long 0,0,29984,473472,0,0,30176,473664,0,0,30384,473856,0,0,30576,474048
.long 0,0,27664,430864,0,0,27856,431056,0,0,28032,431248,0,0,28224,431440
.long 0,0,28464,431632,0,0,28656,431824,0,0,28832,432016,0,0,29024,432208
.long 0,0,29200,432400,0,0,29392,432592,0,0,29568,473104,0,0,29760,473296
.long 0,0,30000,473488,0,0,30192,473680,0,0,30368,473872,0,0,30560,474064
.long 0,0,27680,430880,0,0,27872,431072,0,0,28080,431264,0,0,28272,431456
.long 0,0,28416,431648,0,0,28608,431840,0,0,28816,432032,0,0,29008,432224
.long 0,0,29216,432416,0,0,29408,432608,0,0,29616,473120,0,0,29808,473312
.long 0,0,29952,473504,0,0,30144,473696,0,0,30352,473888,0,0,30544,474080
.long 0,0,27696,430896,0,0,27888,431088,0,0,28064,431280,0,0,28256,431472
.long 0,0,28432,431664,0,0,28624,431856,0,0,28800,432048,0,0,28992,432240
.long 0,0,29232,432432,0,0,29424,432624,0,0,29600,473136,0,0,29792,473328
.long 0,0,29968,473520,0,0,30160,473712,0,0,30336,473904,0,0,30528,474096
.long 0,6144,63048,118600,8,6160,63056,118608,16,6176,63064,118616,24,6192,63072,118624
.long 64,6336,63080,118632,72,6352,63088,118640,80,6368,63096,118648,88,6384,63104,118656
.long 128,6528,63112,118664,136,6544,63120,118672,144,6560,63128,118680,152,6576,63136,118688
.long 192,6720,63144,118696,200,6736,63152,118704,208,6752,63160,118712,216,6768,63168,118720
.long 288,6920,66520,122072,296,6936,66528,122080,304,6952,66536,122088,312,6968,66544,122096
.long 352,7112,66552,122104,360,7128,66560,122112,368,7144,66568,122120,376,7160,66576,122128
.long 416,7304,66584,122136,424,7320,66592,122144,432,7336,66600,122152,440,7352,66608,122160
.long 480,7496,66616,122168,488,7512,66624,122176,496,7528,66632,122184,504,7544,66640,122192
.long 512,7696,69992,125544,520,7712,70000,125552,528,7728,70008,125560,536,7744,70016,125568
.long 576,7888,70024,125576,584,7904,70032,125584,592,7920,70040,125592,600,7936,70048,125600
.long 640,8080,70056,125608,648,8096,70064,125616,656,8112,70072,125624,664,8128,70080,125632
.long 704,8272,70088,125640,712,8288,70096,125648,720,8304,70104,125656,728,8320,70112,125664
.long 800,8472,73464,129016,808,8488,73472,129024,816,8504,73480,129032,824,8520,73488,129040
.long 864,8664,73496,129048,872,8680,73504,129056,880,8696,73512,129064,888,8712,73520,129072
.long 928,8856,73528,129080,936,8872,73536,129088,944,8888,73544,129096,952,8904,73552,129104
.long 992,9048,73560,129112,1000,9064,73568,129120,1008,9080,73576,129128,1016,9096,73584,129136
.long 18432,32,150784,68704,18448,40,150800,68720,18464,48,150816,68736,18480,56,150832,68752
.long 19200,96,150784,68768,19216,104,150800,68784,19232,112,150816,68800,19248,120,150832,70480
.long 19968,160,150784,69608,19984,168,150800,69624,20000,176,150816,69640,20016,184,150832,69656
.long 20736,224,150784,69672,20752,232,150800,69688,20768,240,150816,69704,20784,248,150832,70616
.long 21536,256,150848,68712,21552,264,150864,68728,21504,272,150880,68744,21520,280,150896,68760
.long 22304,320,150848,68776,22320,328,150864,68792,22272,336,150880,68808,22288,344,150896,70488
.long 23072,384,150848,69616,23088,392,150864,69632,23040,400,150880,69648,23056,408,150896,69664
.long 23840,448,150848,69680,23856,456,150864,69696,23808,464,150880,69712,23824,472,150896,70624
.long 24576,544,150912,68816,24592,552,150928,68832,24608,560,150944,68848,24624,568,150960,68864
.long 25344,608,150912,68880,25360,616,150928,68896,25376,624,150944,68912,25392,632,150960,70592
.long 26112,672,150912,69720,26128,680,150928,69736,26144,688,150944,69752,26160,696,150960,69768
.long 26880,736,150912,69784,26896,744,150928,69800,26912,752,150944,69816,26928,760,150960,70728
.long 27680,768,150976,68824,27696,776,150992,68840,27648,784,151008,68856,27664,792,151024,68872
.long 28448,832,150976,68888,28464,840,150992,68904,28416,848,151008,68920,28432,856,151024,70600
.long 29216,896,150976,69728,29232,904,150992,69744,29184,912,151008,69760,29200,920,151024,69776
.long 29984,960,150976,69792,30000,968,150992,69808,29952,976,151008,69824,29968,984,151024,70736
.long 474240,475296,516624,561024,474256,475312,516608,561216,474272,475264,516656,561408,474288,475280,516640,561600
.long 474304,475360,516688,1073741824,474320,475376,516672,1073741824,474336,475328,516720,1073741824,474352,475344,516704,1073741824
.long 474368,475440,516752,1073741824,474384,475424,516736,1073741824,474400,475408,516784,1073741824,474416,475392,516768,1073741824
.long 474432,475504,516816,1073741824,474448,475488,516800,1073741824,474464,475472,516848,1073741824,474480,475456,516832,1073741824
.long 474496,475568,516896,561040,474512,475552,516912,561232,474528,475536,516864,561424,474544,475520,516880,561616
.long 474560,475632,516960,1073741824,474576,475616,516976,1073741824,474592,475600,516928,1073741824,474608,475584,516944,1073741824
.long 474640,475696,517024,1073741824,474624,475680,517040,1073741824,474672,475664,516992,1073741824,474656,475648,517008,1073741824
.long 474704,475760,517088,1073741824,474688,475744,517104,1073741824,474736,475728,517056,1073741824,474720,475712,517072,1073741824
.long 474768,516096,517152,561056,474752,516112,517168,561248,474800,516128,517120,561440,474784,516144,517136,561632
.long 474832,516160,517216,1073741824,474816,516176,517232,1073741824,474864,516192,517184,1073741824,474848,516208,517200,1073741824
.long 474896,516224,517296,1073741824,474880,516240,517280,1073741824,474928,516256,517264,1073741824,474912,516272,517248,1073741824
.long 474960,516288,517360,1073741824,474944,516304,517344,1073741824,474992,516320,517328,1073741824,474976,516336,517312,1073741824
.long 475040,516352,517424,561072,475056,516368,517408,561264,475008,516384,517392,561456,475024,516400,517376,561648
.long 475104,516416,517488,1073741824,475120,516432,517472,1073741824,475072,516448,517456,1073741824,475088,516464,517440,1073741824
.long 475168,516496,517552,1073741824,475184,516480,517536,1073741824,475136,516528,517520,1073741824,475152,516512,517504,1073741824
.long 475232,516560,517616,1073741824,475248,516544,517600,1073741824,475200,516592,517584,1073741824,475216,516576,517568,1073741824
.long 0,0,30720,474240,0,0,30912,474432,0,0,31120,474624,0,0,31312,474816
.long 0,0,31520,475008,0,0,31712,475200,0,0,31920,475392,0,0,32112,475584
.long 0,0,32256,516096,0,0,32448,516288,0,0,32656,516480,0,0,32848,516672
.long 0,0,33056,516864,0,0,33248,517056,0,0,33456,517248,0,0,33648,517440
.long 0,0,30736,474256,0,0,30928,474448,0,0,31104,474640,0,0,31296,474832
.long 0,0,31536,475024,0,0,31728,475216,0,0,31904,475408,0,0,32096,475600
.long 0,0,32272,516112,0,0,32464,516304,0,0,32640,516496,0,0,32832,516688
.long 0,0,33072,516880,0,0,33264,517072,0,0,33440,517264,0,0,33632,517456
.long 0,0,30752,474272,0,0,30944,474464,0,0,31152,474656,0,0,31344,474848
.long 0,0,31488,475040,0,0,31680,475232,0,0,31888,475424,0,0,32080,475616
.long 0,0,32288,516128,0,0,32480,516320,0,0,32688,516512,0,0,32880,516704
.long 0,0,33024,516896,0,0,33216,517088,0,0,33424,517280,0,0,33616,517472
.long 0,0,30768,474288,0,0,30960,474480,0,0,31136,474672,0,0,31328,474864
.long 0,0,31504,475056,0,0,31696,475248,0,0,31872,475440,0,0,32064,475632
.long 0,0,32304,516144,0,0,32496,516336,0,0,32672,516528,0,0,32864,516720
.long 0,0,33040,516912,0,0,33232,517104,0,0,33408,517296,0,0,33600,517488
.long 0,6144,63176,118728,8,6160,63184,118736,16,6176,63192,118744,24,6192,63200,118752
.long 64,6336,63208,118760,72,6352,63216,118768,80,6368,63224,118776,88,6384,63232,118784
.long 128,6528,63240,118792,136,6544,63248,118800,144,6560,63256,118808,152,6576,63264,118816
.long 192,6720,63272,118824,200,6736,63280,118832,208,6752,63288,118840,216,6768,63296,118848
.long 288,6920,66648,122200,296,6936,66656,122208,304,6952,66664,122216,312,6968,66672,122224
.long 352,7112,66680,122232,360,7128,66688,122240,368,7144,66696,122248,376,7160,66704,122256
.long 416,7304,66712,122264,424,7320,66720,122272,432,7336,66728,122280,440,7352,66736,122288
.long 480,7496,66744,122296,488,7512,66752,122304,496,7528,66760,122312,504,7544,66768,122320
.long 512,7696,70120,125672,520,7712,70128,125680,528,7728,70136,125688,536,7744,70144,125696
.long 576,7888,70152,125704,584,7904,70160,125712,592,7920,70168,125720,600,7936,70176,125728
.long 640,8080,70184,125736,648,8096,70192,125744,656,8112,70200,125752,664,8128,70208,125760
.long 704,8272,70216,125768,712,8288,70224,125776,720,8304,70232,125784,728,8320,70240,125792
.long 800,8472,73592,129144,808,8488,73600,129152,816,8504,73608,129160,824,8520,73616,129168
.long 864,8664,73624,129176,872,8680,73632,129184,880,8696,73640,129192,888,8712,73648,129200
.long 928,8856,73656,129208,936,8872,73664,129216,944,8888,73672,129224,952,8904,73680,129232
.long 992,9048,73688,129240,1000,9064,73696,129248,1008,9080,73704,129256,1016,9096,73712,129264
.long 27680,32,150784,72176,27696,40,150800,72192,27648,48,150816,72208,27664,56,150832,72224
.long 28448,96,150784,72240,28464,104,150800,72256,28416,112,150816,72272,28432,120,150832,73952
.long 29216,160,150784,73080,29232,168,150800,73096,29184,176,150816,73112,29200,184,150832,73128
.long 29984,224,150784,73144,30000,232,150800,73160,29952,240,150816,73176,29968,248,150832,74088
.long 30720,256,150848,72184,30736,264,150864,72200,30752,272,150880,72216,30768,280,150896,72232
.long 31488,320,150848,72248,31504,328,150864,72264,31520,336,150880,72280,31536,344,150896,73960
.long 32256,384,150848,73088,32272,392,150864,73104,32288,400,150880,73120,32304,408,150896,73136
.long 33024,448,150848,73152,33040,456,150864,73168,33056,464,150880,73184,33072,472,150896,74096
.long 33824,544,150912,72288,33840,552,150928,72304,33792,560,150944,72320,33808,568,150960,72336
.long 34592,608,150912,72352,34608,616,150928,72368,34560,624,150944,72384,34576,632,150960,74064
.long 35360,672,150912,73192,35376,680,150928,73208,35328,688,150944,73224,35344,696,150960,73240
.long 36128,736,150912,73256,36144,744,150928,73272,36096,752,150944,73288,36112,760,150960,74200
.long 36864,768,150976,72296,36880,776,150992,72312,36896,784,151008,72328,36912,792,151024,72344
.long 37632,832,150976,72360,37648,840,150992,72376,37664,848,151008,72392,37680,856,151024,74072
.long 38400,896,150976,73200,38416,904,150992,73216,38432,912,151008,73232,38448,920,151024,73248
.long 39168,960,150976,73264,39184,968,150992,73280,39200,976,151008,73296,39216,984,151024,74208
.long 517632,518688,560016,561024,517648,518704,560000,561216,517664,518656,560048,561408,517680,518672,560032,561600
.long 517696,518752,560080,1073741824,517712,518768,560064,1073741824,517728,518720,560112,1073741824,517744,518736,560096,1073741824
.long 517760,559152,560144,1073741824,517776,559136,560128,1073741824,517792,559120,560176,1073741824,517808,559104,560160,1073741824
.long 517824,559216,560208,1073741824,517840,559200,560192,1073741824,517856,559184,560240,1073741824,517872,559168,560224,1073741824
.long 517888,559280,560288,561040,517904,559264,560304,561232,517920,559248,560256,561424,517936,559232,560272,561616
.long 517952,559344,560352,1073741824,517968,559328,560368,1073741824,517984,559312,560320,1073741824,518000,559296,560336,1073741824
.long 518032,559408,560416,1073741824,518016,559392,560432,1073741824,518064,559376,560384,1073741824,518048,559360,560400,1073741824
.long 518096,559472,560480,1073741824,518080,559456,560496,1073741824,518128,559440,560448,1073741824,518112,559424,560464,1073741824
.long 518160,559488,560544,561056,518144,559504,560560,561248,518192,559520,560512,561440,518176,559536,560528,561632
.long 518224,559552,560608,1073741824,518208,559568,560624,1073741824,518256,559584,560576,1073741824,518240,559600,560592,1073741824
.long 518288,559616,560688,1073741824,518272,559632,560672,1073741824,518320,559648,560656,1073741824,518304,559664,560640,1073741824
.long 518352,559680,560752,1073741824,518336,559696,560736,1073741824,518384,559712,560720,1073741824,518368,559728,560704,1073741824
.long 518432,559744,560816,561072,518448,559760,560800,561264,518400,559776,560784,561456,518416,559792,560768,561648
.long 518496,559808,560880,1073741824,518512,559824,560864,1073741824,518464,559840,560848,1073741824,518480,559856,560832,1073741824
.long 518560,559888,560944,1073741824,518576,559872,560928,1073741824,518528,559920,560912,1073741824,518544,559904,560896,1073741824
.long 518624,559952,561008,1073741824,518640,559936,560992,1073741824,518592,559984,560976,1073741824,518608,559968,560960,1073741824
.long 0,0,33792,517632,0,0,33984,517824,0,0,34192,518016,0,0,34384,518208
.long 0,0,34592,518400,0,0,34784,518592,0,0,34992,559104,0,0,35184,559296
.long 0,0,35328,559488,0,0,35520,559680,0,0,35728,559872,0,0,35920,560064
.long 0,0,36128,560256,0,0,36320,560448,0,0,36528,560640,0,0,36720,560832
.long 0,0,33808,517648,0,0,34000,517840,0,0,34176,518032,0,0,34368,518224
.long 0,0,34608,518416,0,0,34800,518608,0,0,34976,559120,0,0,35168,559312
.long 0,0,35344,559504,0,0,35536,559696,0,0,35712,559888,0,0,35904,560080
.long 0,0,36144,560272,0,0,36336,560464,0,0,36512,560656,0,0,36704,560848
.long 0,0,33824,517664,0,0,34016,517856,0,0,34224,518048,0,0,34416,518240
.long 0,0,34560,518432,0,0,34752,518624,0,0,34960,559136,0,0,35152,559328
.long 0,0,35360,559520,0,0,35552,559712,0,0,35760,559904,0,0,35952,560096
.long 0,0,36096,560288,0,0,36288,560480,0,0,36496,560672,0,0,36688,560864
.long 0,0,33840,517680,0,0,34032,517872,0,0,34208,518064,0,0,34400,518256
.long 0,0,34576,518448,0,0,34768,518640,0,0,34944,559152,0,0,35136,559344
.long 0,0,35376,559536,0,0,35568,559728,0,0,35744,559920,0,0,35936,560112
.long 0,0,36112,560304,0,0,36304,560496,0,0,36480,560688,0,0,36672,560880
.long 0,6144,61760,103424,8,6160,61768,103432,16,6152,61776,103440,24,6168,61784,103448
.long 64,6336,61792,103456,72,6352,61800,103464,80,6344,61808,103472,88,6360,61816,103480
.long 128,6528,61824,103488,136,6544,61832,103496,144,6536,61840,103504,152,6552,61848,103512
.long 192,6720,61856,103520,200,6736,61864,103528,208,6728,61872,103536,216,6744,61880,103544
.long 32,6176,61888,103552,40,6192,61896,103560,48,6184,61904,103568,56,6200,61912,103576
.long 96,6368,61920,103584,104,6384,61928,103592,112,6376,61936,103600,120,6392,61944,103608
.long 160,6560,61952,103616,168,6576,61960,103624,176,6568,61968,103632,184,6584,61976,103640
.long 224,6752,61984,103648,232,6768,61992,103656,240,6760,62000,103664,248,6776,62008,103672
.long 288,6920,65232,106896,296,6936,65240,106904,304,6928,65248,106912,312,6944,65256,106920
.long 352,7112,65264,106928,360,7128,65272,106936,368,7120,65280,106944,376,7136,65288,106952
.long 416,7304,65296,106960,424,7320,65304,106968,432,7312,65312,106976,440,7328,65320,106984
.long 480,7496,65328,106992,488,7512,65336,107000,496,7504,65344,107008,504,7520,65352,107016
.long 256,6952,65360,107024,264,6968,65368,107032,272,6960,65376,107040,280,6976,65384,107048
.long 320,7144,65392,107056,328,7160,65400,107064,336,7152,65408,107072,344,7168,65416,107080
.long 384,7336,65424,107088,392,7352,65432,107096,400,7344,65440,107104,408,7360,65448,107112
.long 448,7528,65456,107120,456,7544,65464,107128,464,7536,65472,107136,472,7552,65480,107144
.long 36864,0,0,75648,36880,0,0,75664,36896,0,0,75680,36912,0,0,75696
.long 37632,0,0,75712,37648,0,0,75728,37664,0,0,75744,37680,0,0,77424
.long 38400,0,0,76552,38416,0,0,76568,38432,0,0,76584,38448,0,0,76600
.long 39168,0,0,76616,39184,0,0,76632,39200,0,0,76648,39216,0,0,77560
.long 39968,0,0,75656,39984,0,0,75672,39936,0,0,75688,39952,0,0,75704
.long 40736,0,0,75720,40752,0,0,75736,40704,0,0,75752,40720,0,0,77432
.long 41504,0,0,76560,41520,0,0,76576,41472,0,0,76592,41488,0,0,76608
.long 42272,0,0,76624,42288,0,0,76640,42240,0,0,76656,42256,0,0,77568
.long 43008,0,0,75760,43024,0,0,75776,43040,0,0,75792,43056,0,0,75808
.long 43776,0,0,75824,43792,0,0,75840,43808,0,0,75856,43824,0,0,77536
.long 44544,0,0,76664,44560,0,0,76680,44576,0,0,76696,44592,0,0,76712
.long 45312,0,0,76728,45328,0,0,76744,45344,0,0,76760,45360,0,0,77672
.long 46112,0,0,75768,46128,0,0,75784,46080,0,0,75800,46096,0,0,75816
.long 46880,0,0,75832,46896,0,0,75848,46848,0,0,75864,46864,0,0,77544
.long 47648,0,0,76672,47664,0,0,76688,47616,0,0,76704,47632,0,0,76720
.long 48416,0,0,76736,48432,0,0,76752,48384,0,0,76768,48400,0,0,77680
.long 0,1056,2064,43392,16,1072,2048,43408,32,1024,2096,43424,48,1040,2080,43440
.long 64,1120,2128,43456,80,1136,2112,43472,96,1088,2160,43488,112,1104,2144,43504
.long 128,1200,2192,43520,144,1184,2176,43536,160,1168,2224,43552,176,1152,2208,43568
.long 192,1264,2256,43584,208,1248,2240,43600,224,1232,2288,43616,240,1216,2272,43632
.long 256,1328,2336,43648,272,1312,2352,43664,288,1296,2304,43680,304,1280,2320,43696
.long 320,1392,2400,43712,336,1376,2416,43728,352,1360,2368,43744,368,1344,2384,43760
.long 400,1456,2464,43792,384,1440,2480,43776,432,1424,2432,43824,416,1408,2448,43808
.long 464,1520,2528,43856,448,1504,2544,43840,496,1488,2496,43888,480,1472,2512,43872
.long 528,1536,2592,43920,512,1552,2608,43904,560,1568,2560,43952,544,1584,2576,43936
.long 592,1600,2656,43984,576,1616,2672,43968,624,1632,2624,44016,608,1648,2640,44000
.long 656,1664,43056,44048,640,1680,43040,44032,688,1696,43024,44080,672,1712,43008,44064
.long 720,1728,43120,44112,704,1744,43104,44096,752,1760,43088,44144,736,1776,43072,44128
.long 800,1792,43184,44192,816,1808,43168,44208,768,1824,43152,44160,784,1840,43136,44176
.long 864,1856,43248,44256,880,1872,43232,44272,832,1888,43216,44224,848,1904,43200,44240
.long 928,1936,43312,44320,944,1920,43296,44336,896,1968,43280,44288,912,1952,43264,44304
.long 992,2000,43376,44384,1008,1984,43360,44400,960,2032,43344,44352,976,2016,43328,44368
.long 44448,45456,0,0,44464,45440,192,192,44416,45488,400,384,44432,45472,592,576
.long 44512,45520,800,768,44528,45504,992,960,44480,45552,1200,1152,44496,45536,1392,1344
.long 44592,45584,1536,1536,44576,45568,1728,1728,44560,45616,1936,1920,44544,45600,2128,2112
.long 44656,45648,2336,2304,44640,45632,2528,2496,44624,45680,2736,43008,44608,45664,2928,43200
.long 44720,86048,3072,43392,44704,86064,3264,43584,44688,86016,3472,43776,44672,86032,3664,43968
.long 44784,86112,3872,44160,44768,86128,4064,44352,44752,86080,4272,44544,44736,86096,4464,44736
.long 44848,86176,4608,44928,44832,86192,4800,45120,44816,86144,5008,45312,44800,86160,5200,45504
.long 44912,86240,5408,86016,44896,86256,5600,86208,44880,86208,5808,86400,44864,86224,6000,86592
.long 44928,86304,16,16,44944,86320,208,208,44960,86272,384,400,44976,86288,576,592
.long 44992,86368,816,784,45008,86384,1008,976,45024,86336,1184,1168,45040,86352,1376,1360
.long 45056,86448,1552,1552,45072,86432,1744,1744,45088,86416,1920,1936,45104,86400,2112,2128
.long 45120,86512,2352,2320,45136,86496,2544,2512,45152,86480,2720,43024,45168,86464,2912,43216
.long 45184,86576,3088,43408,45200,86560,3280,43600,45216,86544,3456,43792,45232,86528,3648,43984
.long 45248,86640,3888,44176,45264,86624,4080,44368,45280,86608,4256,44560,45296,86592,4448,44752
.long 45328,86704,4624,44944,45312,86688,4816,45136,45360,86672,4992,45328,45344,86656,5184,45520
.long 45392,86768,5424,86032,45376,86752,5616,86224,45424,86736,5792,86416,45408,86720,5984,86608
.long 0,6144,62016,103680,8,6160,62024,103688,16,6152,62032,103696,24,6168,62040,103704
.long 64,6336,62048,103712,72,6352,62056,103720,80,6344,62064,103728,88,6360,62072,103736
.long 128,6528,62080,103744,136,6544,62088,103752,144,6536,62096,103760,152,6552,62104,103768
.long 192,6720,62112,103776,200,6736,62120,103784,208,6728,62128,103792,216,6744,62136,103800
.long 32,6176,62144,103808,40,6192,62152,103816,48,6184,62160,103824,56,6200,62168,103832
.long 96,6368,62176,103840,104,6384,62184,103848,112,6376,62192,103856,120,6392,62200,103864
.long 160,6560,62208,103872,168,6576,62216,103880,176,6568,62224,103888,184,6584,62232,103896
.long 224,6752,62240,103904,232,6768,62248,103912,240,6760,62256,103920,248,6776,62264,103928
.long 288,6920,65488,107152,296,6936,65496,107160,304,6928,65504,107168,312,6944,65512,107176
.long 352,7112,65520,107184,360,7128,65528,107192,368,7120,65536,107200,376,7136,65544,107208
.long 416,7304,65552,107216,424,7320,65560,107224,432,7312,65568,107232,440,7328,65576,107240
.long 480,7496,65584,107248,488,7512,65592,107256,496,7504,65600,107264,504,7520,65608,107272
.long 256,6952,65616,107280,264,6968,65624,107288,272,6960,65632,107296,280,6976,65640,107304
.long 320,7144,65648,107312,328,7160,65656,107320,336,7152,65664,107328,344,7168,65672,107336
.long 384,7336,65680,107344,392,7352,65688,107352,400,7344,65696,107360,408,7360,65704,107368
.long 448,7528,65712,107376,456,7544,65720,107384,464,7536,65728,107392,472,7552,65736,107400
.long 46112,0,0,79120,46128,0,0,79136,46080,0,0,79152,46096,0,0,79168
.long 46880,0,0,79184,46896,0,0,79200,46848,0,0,79216,46864,0,0,80896
.long 47648,0,0,80024,47664,0,0,80040,47616,0,0,80056,47632,0,0,80072
.long 48416,0,0,80088,48432,0,0,80104,48384,0,0,80120,48400,0,0,81032
.long 49152,0,0,79128,49168,0,0,79144,49184,0,0,79160,49200,0,0,79176
.long 49920,0,0,79192,49936,0,0,79208,49952,0,0,79224,49968,0,0,80904
.long 50688,0,0,80032,50704,0,0,80048,50720,0,0,80064,50736,0,0,80080
.long 51456,0,0,80096,51472,0,0,80112,51488,0,0,80128,51504,0,0,81040
.long 52256,0,0,79232,52272,0,0,79248,52224,0,0,79264,52240,0,0,79280
.long 53024,0,0,79296,53040,0,0,79312,52992,0,0,79328,53008,0,0,81008
.long 53792,0,0,80136,53808,0,0,80152,53760,0,0,80168,53776,0,0,80184
.long 54560,0,0,80200,54576,0,0,80216,54528,0,0,80232,54544,0,0,81144
.long 55296,0,0,79240,55312,0,0,79256,55328,0,0,79272,55344,0,0,79288
.long 56064,0,0,79304,56080,0,0,79320,56096,0,0,79336,56112,0,0,81016
.long 56832,0,0,80144,56848,0,0,80160,56864,0,0,80176,56880,0,0,80192
.long 57600,0,0,80208,57616,0,0,80224,57632,0,0,80240,57648,0,0,81152
.long 86784,87840,129168,130176,86800,87856,129152,130192,86816,87808,129200,130208,86832,87824,129184,130224
.long 86848,87904,129232,130240,86864,87920,129216,130256,86880,87872,129264,130272,86896,87888,129248,130288
.long 86912,87984,129296,130304,86928,87968,129280,130320,86944,87952,129328,130336,86960,87936,129312,130352
.long 86976,88048,129360,130368,86992,88032,129344,130384,87008,88016,129392,130400,87024,88000,129376,130416
.long 87040,88112,129440,130432,87056,88096,129456,130448,87072,88080,129408,130464,87088,88064,129424,130480
.long 87104,88176,129504,130496,87120,88160,129520,130512,87136,88144,129472,130528,87152,88128,129488,130544
.long 87184,88240,129568,130576,87168,88224,129584,130560,87216,88208,129536,130608,87200,88192,129552,130592
.long 87248,88304,129632,130640,87232,88288,129648,130624,87280,88272,129600,130672,87264,88256,129616,130656
.long 87312,88320,129696,130704,87296,88336,129712,130688,87344,88352,129664,130736,87328,88368,129680,130720
.long 87376,88384,129760,130768,87360,88400,129776,130752,87408,88416,129728,130800,87392,88432,129744,130784
.long 87440,88448,129840,130832,87424,88464,129824,130816,87472,88480,129808,130864,87456,88496,129792,130848
.long 87504,88512,129904,130896,87488,88528,129888,130880,87536,88544,129872,130928,87520,88560,129856,130912
.long 87584,88576,129968,130976,87600,88592,129952,130992,87552,88608,129936,130944,87568,88624,129920,130960
.long 87648,88640,130032,131040,87664,88656,130016,131056,87616,88672,130000,131008,87632,88688,129984,131024
.long 87712,129040,130096,131104,87728,129024,130080,131120,87680,129072,130064,131072,87696,129056,130048,131088
.long 87776,129104,130160,131168,87792,129088,130144,131184,87744,129136,130128,131136,87760,129120,130112,131152
.long 131232,172560,6144,86784,131248,172544,6336,86976,131200,172592,6544,87168,131216,172576,6736,87360
.long 131296,172624,6944,87552,131312,172608,7136,87744,131264,172656,7344,87936,131280,172640,7536,88128
.long 131376,172688,7680,88320,131360,172672,7872,88512,131344,172720,8080,129024,131328,172704,8272,129216
.long 131440,172752,8480,129408,131424,172736,8672,129600,131408,172784,8880,129792,131392,172768,9072,129984
.long 131504,172832,9216,130176,131488,172848,9408,130368,131472,172800,9616,130560,131456,172816,9808,130752
.long 131568,172896,10016,130944,131552,172912,10208,131136,131536,172864,10416,131328,131520,172880,10608,131520
.long 131632,172960,10752,172032,131616,172976,10944,172224,131600,172928,11152,172416,131584,172944,11344,172608
.long 131696,173024,11552,172800,131680,173040,11744,172992,131664,172992,11952,173184,131648,173008,12144,173376
.long 172032,173088,6160,86800,172048,173104,6352,86992,172064,173056,6528,87184,172080,173072,6720,87376
.long 172096,173152,6960,87568,172112,173168,7152,87760,172128,173120,7328,87952,172144,173136,7520,88144
.long 172160,173232,7696,88336,172176,173216,7888,88528,172192,173200,8064,129040,172208,173184,8256,129232
.long 172224,173296,8496,129424,172240,173280,8688,129616,172256,173264,8864,129808,172272,173248,9056,130000
.long 172288,173360,9232,130192,172304,173344,9424,130384,172320,173328,9600,130576,172336,173312,9792,130768
.long 172352,173424,10032,130960,172368,173408,10224,131152,172384,173392,10400,131344,172400,173376,10592,131536
.long 172432,173488,10768,172048,172416,173472,10960,172240,172464,173456,11136,172432,172448,173440,11328,172624
.long 172496,173552,11568,172816,172480,173536,11760,173008,172528,173520,11936,173200,172512,173504,12128,173392
.long 0,6144,62272,103936,8,6160,62280,103944,16,6152,62288,103952,24,6168,62296,103960
.long 64,6336,62304,103968,72,6352,62312,103976,80,6344,62320,103984,88,6360,62328,103992
.long 128,6528,62336,104000,136,6544,62344,104008,144,6536,62352,104016,152,6552,62360,104024
.long 192,6720,62368,104032,200,6736,62376,104040,208,6728,62384,104048,216,6744,62392,104056
.long 32,6176,62400,104064,40,6192,62408,104072,48,6184,62416,104080,56,6200,62424,104088
.long 96,6368,62432,104096,104,6384,62440,104104,112,6376,62448,104112,120,6392,62456,104120
.long 160,6560,62464,104128,168,6576,62472,104136,176,6568,62480,104144,184,6584,62488,104152
.long 224,6752,62496,104160,232,6768,62504,104168,240,6760,62512,104176,248,6776,62520,104184
.long 288,6920,65744,107408,296,6936,65752,107416,304,6928,65760,107424,312,6944,65768,107432
.long 352,7112,65776,107440,360,7128,65784,107448,368,7120,65792,107456,376,7136,65800,107464
.long 416,7304,65808,107472,424,7320,65816,107480,432,7312,65824,107488,440,7328,65832,107496
.long 480,7496,65840,107504,488,7512,65848,107512,496,7504,65856,107520,504,7520,65864,107528
.long 256,6952,65872,107536,264,6968,65880,107544,272,6960,65888,107552,280,6976,65896,107560
.long 320,7144,65904,107568,328,7160,65912,107576,336,7152,65920,107584,344,7168,65928,107592
.long 384,7336,65936,107600,392,7352,65944,107608,400,7344,65952,107616,408,7360,65960,107624
.long 448,7528,65968,107632,456,7544,65976,107640,464,7536,65984,107648,472,7552,65992,107656
.long 55296,0,0,82592,55312,0,0,82608,55328,0,0,82624,55344,0,0,82640
.long 56064,0,0,82656,56080,0,0,82672,56096,0,0,82688,56112,0,0,84368
.long 56832,0,0,83496,56848,0,0,83512,56864,0,0,83528,56880,0,0,83544
.long 57600,0,0,83560,57616,0,0,83576,57632,0,0,83592,57648,0,0,84504
.long 58400,0,0,82600,58416,0,0,82616,58368,0,0,82632,58384,0,0,82648
.long 59168,0,0,82664,59184,0,0,82680,59136,0,0,82696,59152,0,0,84376
.long 59936,0,0,83504,59952,0,0,83520,59904,0,0,83536,59920,0,0,83552
.long 60704,0,0,83568,60720,0,0,83584,60672,0,0,83600,60688,0,0,84512
.long 61440,0,0,82704,61456,0,0,82720,61472,0,0,82736,61488,0,0,82752
.long 62208,0,0,82768,62224,0,0,82784,62240,0,0,82800,62256,0,0,84480
.long 62976,0,0,83608,62992,0,0,83624,63008,0,0,83640,63024,0,0,83656
.long 63744,0,0,83672,63760,0,0,83688,63776,0,0,83704,63792,0,0,84616
.long 64544,0,0,82712,64560,0,0,82728,64512,0,0,82744,64528,0,0,82760
.long 65312,0,0,82776,65328,0,0,82792,65280,0,0,82808,65296,0,0,84488
.long 66080,0,0,83616,66096,0,0,83632,66048,0,0,83648,66064,0,0,83664
.long 66848,0,0,83680,66864,0,0,83696,66816,0,0,83712,66832,0,0,84624
.long 173568,174624,215952,216960,173584,174640,215936,216976,173600,174592,215984,216992,173616,174608,215968,217008
.long 173632,174688,216016,217024,173648,174704,216000,217040,173664,174656,216048,217056,173680,174672,216032,217072
.long 173696,215088,216080,217088,173712,215072,216064,217104,173728,215056,216112,217120,173744,215040,216096,217136
.long 173760,215152,216144,217152,173776,215136,216128,217168,173792,215120,216176,217184,173808,215104,216160,217200
.long 173824,215216,216224,217216,173840,215200,216240,217232,173856,215184,216192,217248,173872,215168,216208,217264
.long 173888,215280,216288,217280,173904,215264,216304,217296,173920,215248,216256,217312,173936,215232,216272,217328
.long 173968,215344,216352,217360,173952,215328,216368,217344,174000,215312,216320,217392,173984,215296,216336,217376
.long 174032,215408,216416,217424,174016,215392,216432,217408,174064,215376,216384,217456,174048,215360,216400,217440
.long 174096,215424,216480,217488,174080,215440,216496,217472,174128,215456,216448,217520,174112,215472,216464,217504
.long 174160,215488,216544,217552,174144,215504,216560,217536,174192,215520,216512,217584,174176,215536,216528,217568
.long 174224,215552,216624,217616,174208,215568,216608,217600,174256,215584,216592,217648,174240,215600,216576,217632
.long 174288,215616,216688,217680,174272,215632,216672,217664,174320,215648,216656,217712,174304,215664,216640,217696
.long 174368,215680,216752,258080,174384,215696,216736,258096,174336,215712,216720,258048,174352,215728,216704,258064
.long 174432,215744,216816,258144,174448,215760,216800,258160,174400,215776,216784,258112,174416,215792,216768,258128
.long 174496,215824,216880,258208,174512,215808,216864,258224,174464,215856,216848,258176,174480,215840,216832,258192
.long 174560,215888,216944,258272,174576,215872,216928,258288,174528,215920,216912,258240,174544,215904,216896,258256
.long 258336,259344,12288,173568,258352,259328,12480,173760,258304,259376,12688,173952,258320,259360,12880,174144
.long 258400,259408,13088,174336,258416,259392,13280,174528,258368,259440,13488,215040,258384,259424,13680,215232
.long 258480,259472,13824,215424,258464,259456,14016,215616,258448,259504,14224,215808,258432,259488,14416,216000
.long 258544,259536,14624,216192,258528,259520,14816,216384,258512,259568,15024,216576,258496,259552,15216,216768
.long 258608,259616,15360,216960,258592,259632,15552,217152,258576,259584,15760,217344,258560,259600,15952,217536
.long 258672,259680,16160,258048,258656,259696,16352,258240,258640,259648,16560,258432,258624,259664,16752,258624
.long 258736,259744,16896,258816,258720,259760,17088,259008,258704,259712,17296,259200,258688,259728,17488,259392
.long 258800,259808,17696,259584,258784,259824,17888,259776,258768,259776,18096,259968,258752,259792,18288,260160
.long 258816,259872,12304,173584,258832,259888,12496,173776,258848,259840,12672,173968,258864,259856,12864,174160
.long 258880,259936,13104,174352,258896,259952,13296,174544,258912,259904,13472,215056,258928,259920,13664,215248
.long 258944,260016,13840,215440,258960,260000,14032,215632,258976,259984,14208,215824,258992,259968,14400,216016
.long 259008,260080,14640,216208,259024,260064,14832,216400,259040,260048,15008,216592,259056,260032,15200,216784
.long 259072,260144,15376,216976,259088,260128,15568,217168,259104,260112,15744,217360,259120,260096,15936,217552
.long 259136,260208,16176,258064,259152,260192,16368,258256,259168,260176,16544,258448,259184,260160,16736,258640
.long 259216,260272,16912,258832,259200,260256,17104,259024,259248,260240,17280,259216,259232,260224,17472,259408
.long 259280,260336,17712,259600,259264,260320,17904,259792,259312,260304,18080,259984,259296,260288,18272,260176
.long 0,6144,62528,104192,8,6160,62536,104200,16,6152,62544,104208,24,6168,62552,104216
.long 64,6336,62560,104224,72,6352,62568,104232,80,6344,62576,104240,88,6360,62584,104248
.long 128,6528,62592,104256,136,6544,62600,104264,144,6536,62608,104272,152,6552,62616,104280
.long 192,6720,62624,104288,200,6736,62632,104296,208,6728,62640,104304,216,6744,62648,104312
.long 32,6176,62664,104328,40,6192,62672,104336,48,6184,62680,104344,56,6200,62688,104352
.long 96,6368,62696,104360,104,6384,62704,104368,112,6376,62712,104376,120,6392,62720,104384
.long 160,6560,62728,104392,168,6576,62736,104400,176,6568,62744,104408,184,6584,62752,104416
.long 224,6752,62760,104424,232,6768,62768,104432,240,6760,62776,104440,248,6776,62784,104448
.long 288,6920,66000,107664,296,6936,66008,107672,304,6928,66016,107680,312,6944,66024,107688
.long 352,7112,66032,107696,360,7128,66040,107704,368,7120,66048,107712,376,7136,66056,107720
.long 416,7304,66064,107728,424,7320,66072,107736,432,7312,66080,107744,440,7328,66088,107752
.long 480,7496,66096,107760,488,7512,66104,107768,496,7504,66112,107776,504,7520,66120,107784
.long 256,6952,66136,107800,264,6968,66144,107808,272,6960,66152,107816,280,6976,66160,107824
.long 320,7144,66168,107832,328,7160,66176,107840,336,7152,66184,107848,344,7168,66192,107856
.long 384,7336,66200,107864,392,7352,66208,107872,400,7344,66216,107880,408,7360,66224,107888
.long 448,7528,66232,107896,456,7544,66240,107904,464,7536,66248,107912,472,7552,66256,107920
.long 64544,0,0,86064,64560,0,0,86080,64512,0,0,86096,64528,0,0,86112
.long 65312,0,0,86128,65328,0,0,86144,65280,0,0,86160,65296,0,0,87840
.long 66080,0,0,86968,66096,0,0,86984,66048,0,0,87000,66064,0,0,87016
.long 66848,0,0,87032,66864,0,0,87048,66816,0,0,87064,66832,0,0,87976
.long 67584,0,0,86072,67600,0,0,86088,67616,0,0,86104,67632,0,0,86120
.long 68352,0,0,86136,68368,0,0,86152,68384,0,0,86168,68400,0,0,87848
.long 69120,0,0,86976,69136,0,0,86992,69152,0,0,87008,69168,0,0,87024
.long 69888,0,0,87040,69904,0,0,87056,69920,0,0,87072,69936,0,0,87984
.long 70688,0,0,86176,70704,0,0,86192,70656,0,0,86208,70672,0,0,86224
.long 71456,0,0,86240,71472,0,0,86256,71424,0,0,86272,71440,0,0,87952
.long 72224,0,0,87080,72240,0,0,87096,72192,0,0,87112,72208,0,0,87128
.long 72992,0,0,87144,73008,0,0,87160,72960,0,0,87176,72976,0,0,88088
.long 73728,0,0,86184,73744,0,0,86200,73760,0,0,86216,73776,0,0,86232
.long 74496,0,0,86248,74512,0,0,86264,74528,0,0,86280,74544,0,0,87960
.long 75264,0,0,87088,75280,0,0,87104,75296,0,0,87120,75312,0,0,87136
.long 76032,0,0,87152,76048,0,0,87168,76064,0,0,87184,76080,0,0,88096
.long 260352,301728,302736,344064,260368,301744,302720,344080,260384,301696,302768,344096,260400,301712,302752,344112
.long 260416,301792,302800,344128,260432,301808,302784,344144,260448,301760,302832,344160,260464,301776,302816,344176
.long 260480,301872,302864,344192,260496,301856,302848,344208,260512,301840,302896,344224,260528,301824,302880,344240
.long 260544,301936,302928,344256,260560,301920,302912,344272,260576,301904,302960,344288,260592,301888,302944,344304
.long 260608,302000,303008,344320,260624,301984,303024,344336,260640,301968,302976,344352,260656,301952,302992,344368
.long 260672,302064,303072,344384,260688,302048,303088,344400,260704,302032,303040,344416,260720,302016,303056,344432
.long 301072,302128,303136,344464,301056,302112,303152,344448,301104,302096,303104,344496,301088,302080,303120,344480
.long 301136,302192,303200,344528,301120,302176,303216,344512,301168,302160,303168,344560,301152,302144,303184,344544
.long 301200,302208,303264,344592,301184,302224,303280,344576,301232,302240,303232,344624,301216,302256,303248,344608
.long 301264,302272,303328,344656,301248,302288,303344,344640,301296,302304,303296,344688,301280,302320,303312,344672
.long 301328,302336,303408,344720,301312,302352,303392,344704,301360,302368,303376,344752,301344,302384,303360,344736
.long 301392,302400,303472,344784,301376,302416,303456,344768,301424,302432,303440,344816,301408,302448,303424,344800
.long 301472,302464,303536,344864,301488,302480,303520,344880,301440,302496,303504,344832,301456,302512,303488,344848
.long 301536,302528,303600,344928,301552,302544,303584,344944,301504,302560,303568,344896,301520,302576,303552,344912
.long 301600,302608,303664,344992,301616,302592,303648,345008,301568,302640,303632,344960,301584,302624,303616,344976
.long 301664,302672,303728,345056,301680,302656,303712,345072,301632,302704,303696,345024,301648,302688,303680,345040
.long 345120,346128,18432,260352,345136,346112,18624,260544,345088,346160,18832,301056,345104,346144,19024,301248
.long 345184,346192,19232,301440,345200,346176,19424,301632,345152,346224,19632,301824,345168,346208,19824,302016
.long 345264,346256,19968,302208,345248,346240,20160,302400,345232,346288,20368,302592,345216,346272,20560,302784
.long 345328,346320,20768,302976,345312,346304,20960,303168,345296,346352,21168,303360,345280,346336,21360,303552
.long 345392,346400,21504,344064,345376,346416,21696,344256,345360,346368,21904,344448,345344,346384,22096,344640
.long 345456,346464,22304,344832,345440,346480,22496,345024,345424,346432,22704,345216,345408,346448,22896,345408
.long 345520,346528,23040,345600,345504,346544,23232,345792,345488,346496,23440,345984,345472,346512,23632,346176
.long 345584,346592,23840,346368,345568,346608,24032,346560,345552,346560,24240,387072,345536,346576,24432,387264
.long 345600,346656,18448,260368,345616,346672,18640,260560,345632,346624,18816,301072,345648,346640,19008,301264
.long 345664,346720,19248,301456,345680,346736,19440,301648,345696,346688,19616,301840,345712,346704,19808,302032
.long 345728,387120,19984,302224,345744,387104,20176,302416,345760,387088,20352,302608,345776,387072,20544,302800
.long 345792,387184,20784,302992,345808,387168,20976,303184,345824,387152,21152,303376,345840,387136,21344,303568
.long 345856,387248,21520,344080,345872,387232,21712,344272,345888,387216,21888,344464,345904,387200,22080,344656
.long 345920,387312,22320,344848,345936,387296,22512,345040,345952,387280,22688,345232,345968,387264,22880,345424
.long 346000,387376,23056,345616,345984,387360,23248,345808,346032,387344,23424,346000,346016,387328,23616,346192
.long 346064,387440,23856,346384,346048,387424,24048,346576,346096,387408,24224,387088,346080,387392,24416,387280
L_tab_end:
.size L_tab, L_tab_end-L_tab
.section .rodata,"a"
.p2align 6
.amdhsa_kernel standalone__modern_conv_block_convnext__vision_kernel
  .amdhsa_next_free_vgpr 256
  .amdhsa_next_free_sgpr 102
  .amdhsa_accum_offset 256
  .amdhsa_group_segment_fixed_size 0
  .amdhsa_kernarg_size 80
  .amdhsa_user_sgpr_count 2
  .amdhsa_user_sgpr_kernarg_segment_ptr 1
  .amdhsa_system_sgpr_workgroup_id_x 1
.end_amdhsa_kernel
```
